```python
import torch

def _softmax(x, axis=-1):
    return torch.softmax(x, dim=axis)
def _gelu(x):
    return torch.nn.functional.gelu(x, approximate="tanh")
def _silu(x):
    return torch.nn.functional.silu(x)
def _sigmoid(x):
    return torch.sigmoid(x)
def _layernorm(x, axis=-1, eps=1e-5):
    m = x.mean(dim=axis, keepdim=True)
    v = x.var(dim=axis, keepdim=True, unbiased=False)
    return (x - m) / torch.sqrt(v + eps)
def _scatter_add(tgt, idx, src, axis=0):
    return tgt.clone().index_add_(axis, idx, src)
def _segment_sum(src, seg, n):
    out = torch.zeros((n,) + src.shape[1:], dtype=src.dtype)
    return out.index_add_(0, seg, src)
def _pad(x, pw):
    flat = tuple(v for pair in reversed(pw) for v in pair)
    return torch.nn.functional.pad(x, flat)

kernel_name = 'sequential_preLN__ssm_conv_h3__glu_gated_reglu__prompt'

def setup_inputs():

    _w = (lambda a: (lambda t: t.to(torch.bfloat16) if t.is_floating_point() else t)(torch.as_tensor(a)))
    def _A_setup():
        B, S, D = 1, 2048, 640
        ks = 4
        return {
            "q": _w((lambda *s: torch.randn(*s, dtype=torch.bfloat16) * 0.05)(B, S, D)),
            "k": _w((lambda *s: torch.randn(*s, dtype=torch.bfloat16) * 0.2)(B, S, D)),
            "v": _w((lambda *s: torch.randn(*s, dtype=torch.bfloat16) * 0.2)(B, S, D)),
            "shift_k": _w((lambda *s: torch.randn(*s, dtype=torch.bfloat16) * 0.2)(D, ks) * 0.5),
            "ssm_k": _w((lambda *s: torch.randn(*s, dtype=torch.bfloat16) * 0.4)(D, S) * (1.0 / S ** 0.5)),
            "ssm_D": _w((lambda *s: torch.randn(*s, dtype=torch.bfloat16) * 0.2)(D)),
        }
    _A_in = _A_setup()

    def _B_setup():
        B, S, D, F = 1, 2048, 640, 1728
        return {
            "x": _w((lambda *s: torch.randn(*s, dtype=torch.bfloat16) * 0.05)(B, S, D)),
            "W_gate": _w((lambda *s: torch.randn(*s, dtype=torch.bfloat16) * 0.2)(D, F) * (2.0 / D) ** 0.5),
            "W_up": _w((lambda *s: torch.randn(*s, dtype=torch.bfloat16) * 0.2)(D, F) * (2.0 / D) ** 0.5),
            "W_down": _w((lambda *s: torch.randn(*s, dtype=torch.bfloat16) * 0.2)(F, D) * (1.0 / F) ** 0.5),
        }
    _B_in = _B_setup()

    return {
        "A_q": _A_in["q"],
        "A_k": _A_in["k"],
        "A_v": _A_in["v"],
        "A_shift_k": _A_in["shift_k"],
        "A_ssm_k": _A_in["ssm_k"],
        "A_ssm_D": _A_in["ssm_D"],
        "B_x": _B_in["x"],
        "B_W_gate": _B_in["W_gate"],
        "B_W_up": _B_in["W_up"],
        "B_W_down": _B_in["W_down"],
    }

def reference(A_q, A_k, A_v, A_shift_k, A_ssm_k, A_ssm_D, B_x, B_W_gate, B_W_up, B_W_down):
    def _A_ref(q, k, v, shift_k, ssm_k, ssm_D):
        B, S, D = q.shape
        ks = shift_k.shape[-1]
        k_pad = _pad(k, ((0, 0), (ks - 1, 0), (0, 0)))
        k_shift = torch.zeros_like(k)
        for t in range(ks):
            k_shift = k_shift + k_pad[:, t:t + S, :] * shift_k[:, ks - 1 - t][None, None, :]
        kv = k_shift * v
        L = 2 * S
        kv_pad = _pad(kv, ((0, 0), (0, S), (0, 0)))
        kf_pad = _pad(ssm_k, ((0, 0), (0, S)))
        kv_f = (lambda x, axes=(-2,-1): torch.fft.rfft2(x.float(), dim=axes))(kv_pad[:, None, :, :], axes=(1, 2))
        kf_f = (lambda x, axes=(-2,-1): torch.fft.rfft2(x.float(), dim=axes))(kf_pad[:, None, :], axes=(1, 2))
        kf_f = (lambda x, *d: x.permute(*d))(kf_f, 1, 2, 0)
        y_f = kv_f * kf_f[None, :, :, :]
        y = (lambda x, s, axes=(-2,-1): torch.fft.irfft2(x, s=s, dim=axes).to(torch.bfloat16))(y_f, (1, L), axes=(1, 2))[:, 0, :S, :]
        y = y + kv * ssm_D[None, None, :]
        return q * y

    def _B_ref(x, W_gate, W_up, W_down):
        gate = torch.einsum("bsd,df->bsf", x, W_gate)
        up = torch.einsum("bsd,df->bsf", x, W_up)
        gate = gate * (lambda x, dt: x.to(dt))(gate > 0, gate.dtype)
        h = gate * up
        return torch.einsum("bsf,fd->bsd", h, W_down)

    x = A_q
    h = x + _A_ref(_layernorm(x, axis=-1), A_k, A_v, A_shift_k, A_ssm_k, A_ssm_D)
    h2 = h + _B_ref(_layernorm(h, axis=-1), B_W_gate, B_W_up, B_W_down)
    return h2
```

```asm
; @launch kernel=k1_all_kernel grid=(256,1,1) block=(512,1,1) lds=163840
.amdgcn_target "amdgcn-amd-amdhsa--gfx950"
.text
.globl k1_all_kernel
.p2align 8
.type k1_all_kernel,@function
k1_all_kernel:
    s_cmp_ge_u32 s2, 256
    s_cbranch_scc1 K_EXIT
    s_load_dwordx2 s[12:13], s[0:1], 8
    s_load_dwordx2 s[16:17], s[0:1], 16
    s_load_dwordx2 s[44:45], s[0:1], 96
    s_getpc_b64 s[4:5]
K_PC:
    v_lshrrev_b32 v4, 6, v0
    v_lshrrev_b32 v5, 5, v0
    s_lshr_b32 s6, s2, 3
    s_lshl_b32 s6, s6, 11
    v_readfirstlane_b32 s3, v4
    v_lshl_add_u32 v5, v5, 7, s6
    v_min_u32 v5, TEXT_END-K_PC-4, v5
    global_load_dword v19, v5, s[4:5]
    s_sub_u32 s94, s2, 16
    s_and_b32 s94, s94, 255
    s_and_b32 s58, s94, 7
    s_lshr_b32 s59, s94, 3
    s_cmp_ge_u32 s3, 4
    s_cbranch_scc1 K_E4
    s_cmp_ge_u32 s59, 20
    s_cbranch_scc1 K_NR
    v_bfe_u32 v8, v0, 4, 2
    v_and_b32 v9, 15, v0
    v_lshlrev_b32 v10, 2, v8
    v_xor_b32 v9, v9, v10
    v_mul_u32_u24 v16, 80, v8
    v_add_lshl_u32 v16, v16, v9, 4
    v_xor_b32 v17, 32, v16
    s_mul_i32 s58, s58, 20
    s_add_u32 s58, s58, s59
    s_lshl2_add_u32 s58, s58, s3
    s_mul_i32 s59, s58, 52429
    s_lshr_b32 s59, s59, 18
    s_mul_i32 s33, s59, 5
    s_sub_u32 s58, s58, s33
    s_mul_i32 s33, s59, 20480
    s_mul_i32 s30, s3, 9216
    s_mov_b32 s14, 0x280000
    s_mov_b32 s15, 0x20000
    s_mov_b64 s[18:19], s[14:15]
    s_lshl_b32 s42, s58, 8
    s_add_u32 s29, s33, s42
    s_sub_u32 s28, s29, 5120
    s_cselect_b32 s28, 0x7fffffff, s28
    s_add_u32 s40, s29, 4096
    s_add_u32 s41, s40, 4096
    s_add_u32 s42, s41, 4096
    s_add_u32 m0, s30, 1024
    s_waitcnt lgkmcnt(0)
    buffer_load_dwordx4 v16, s[12:15], s29 offen offset:0 nt lds
    buffer_load_dwordx4 v17, s[12:15], s40 offen offset:1024 nt lds
    buffer_load_dwordx4 v17, s[12:15], s41 offen offset:2048 nt lds
    buffer_load_dwordx4 v16, s[12:15], s42 offen offset:3072 nt lds
    s_add_u32 m0, s30, 5120
    s_nop 0
    buffer_load_dwordx4 v16, s[16:19], s29 offen offset:0 nt lds
    buffer_load_dwordx4 v16, s[16:19], s40 offen offset:1024 nt lds
    buffer_load_dwordx4 v17, s[16:19], s41 offen offset:2048 nt lds
    buffer_load_dwordx4 v17, s[16:19], s42 offen offset:3072 nt lds
    s_mov_b32 m0, s30
    s_nop 0
    buffer_load_dwordx4 v16, s[12:15], s28 offen nt lds
    s_load_dwordx2 s[20:21], s[0:1], 24
    s_load_dwordx4 s[36:39], s[0:1], 32
    s_load_dwordx2 s[46:47], s[0:1], 80
    s_branch K_KV0
K_E4:
    s_load_dwordx2 s[46:47], s[0:1], 80
    v_and_b32 v3, 63, v0
    v_mov_b32 v12, 0
    v_mov_b32 v20, 161856
    s_cmp_eq_u32 s3, 4
    s_cbranch_scc1 K_W4
    s_load_dwordx2 s[24:25], s[0:1], 0
    v_lshl_add_u32 v9, v3, 2, v20
    s_mov_b64 exec, 0xffff
    ds_write_b32 v9, v12
    s_mov_b64 exec, -1
    s_waitcnt lgkmcnt(0)
    s_barrier
    s_branch K_X
K_W4:
    s_memrealtime s[4:5]
    s_and_b32 s43, s2, 15
    s_lshl_b32 s43, s43, 8
    s_add_u32 s43, s43, 8192
    s_cmp_eq_u32 s94, 255
    s_cbranch_scc1 K_MAST
    s_waitcnt lgkmcnt(0)
    s_add_u32 s48, s44, 0x530000
    s_addc_u32 s49, s45, 0
    s_mov_b32 s50, 0x4000
    s_mov_b32 s51, 0x20000
    buffer_load_dwordx2 v[24:25], v12, s[48:51], s43 offen sc1
    s_barrier
    s_branch K_W4P
K_MAST:
    v_and_b32 v21, 15, v3
    v_lshlrev_b32 v21, 8, v21
    v_lshrrev_b32 v22, 4, v3
    v_lshl_add_u32 v21, v22, 4, v21
    s_mov_b32 s43, 8192
    s_waitcnt lgkmcnt(0)
    s_add_u32 s48, s44, 0x530000
    s_addc_u32 s49, s45, 0
    s_mov_b32 s50, 0x4000
    s_mov_b32 s51, 0x20000
    s_or_b32 s4, s4, 1
    v_mov_b32 v24, s4
    v_sub_u32 v25, -2, v24
    v_add_u32 v25, 1, v25
    s_mov_b64 exec, 0xffff
    buffer_store_dwordx2 v[24:25], v21, s[48:51], s43 offen sc1
    s_mov_b64 exec, -1
    s_barrier
    s_branch K_MASTP
K_NR:
    s_load_dwordx4 s[52:55], s[0:1], 56
    s_load_dwordx2 s[56:57], s[0:1], 72
    s_load_dwordx2 s[46:47], s[0:1], 80
    s_barrier
    s_branch K_PK
K_KV0:
    v_and_b32 v3, 63, v0
    v_lshrrev_b32 v25, 3, v3
    v_lshlrev_b32 v25, 5, v25
    v_and_b32 v9, 3, v3
    v_lshl_add_u32 v25, v9, 3, v25
    s_mov_b32 s22, 0x1400
    s_mov_b32 s23, 0x20000
    s_lshl_b32 s42, s58, 10
    v_mov_b32 v12, 0
    v_mov_b32 v13, 0
    v_lshlrev_b32 v2, 4, v3
    v_mov_b32 v1, 161856
    s_waitcnt lgkmcnt(0)
    buffer_load_dwordx2 v[32:33], v25, s[20:23], s42 offen offset:0
    buffer_load_dwordx2 v[34:35], v25, s[20:23], s42 offen offset:256
    buffer_load_dwordx2 v[36:37], v25, s[20:23], s42 offen offset:512
    buffer_load_dwordx2 v[38:39], v25, s[20:23], s42 offen offset:768
    s_barrier
    s_mov_b32 s8, s44
    s_mov_b32 s9, s45
    s_mov_b32 s10, 0x500000
    s_mov_b32 s11, 0x20000
    v_bfe_u32 v9, v3, 2, 2
    v_xor_b32 v9, 3, v9
    v_bfe_u32 v10, v3, 1, 1
    v_lshlrev_b32 v10, 3, v10
    v_lshl_add_u32 v10, v8, 4, v10
    v_mul_u32_u24 v9, 0x140, v9
    v_xor_b32 v10, v10, v9
    v_and_b32 v11, 1, v3
    v_mul_u32_u24 v11, 0x820, v11
    v_xor_b32 v10, v10, v11
    v_add_u32 v104, s30, v10
    v_xor_b32 v105, 64, v104
    v_xor_b32 v106, 128, v104
    v_xor_b32 v107, 192, v104
    v_xor_b32 v108, 32, v104
    v_xor_b32 v109, 32, v105
    v_xor_b32 v110, 32, v106
    v_xor_b32 v111, 32, v107
    s_lshl_b32 s29, s58, 12
    s_add_u32 s29, s29, s33
    s_lshl_b32 s4, s94, 2
    s_add_u32 s4, s4, s3
    s_mov_b32 s12, s36
    s_mov_b32 s13, s37
    s_mov_b32 s14, 0x280000
    s_mov_b32 s15, 0x20000
    s_mov_b32 s36, s38
    s_mov_b32 s37, s39
    s_mov_b32 s38, 0x500
    s_mov_b32 s39, 0x20000
    s_lshl_b32 s6, s4, 12
    s_lshl_b32 s7, s4, 1
    s_mul_i32 s28, s3, 8288
    s_add_u32 s28, s28, 96288
    s_waitcnt vmcnt(0)
    s_mov_b64 exec, 1
    ds_inc_u32 v1, v1 offset:0
    s_mov_b64 exec, -1
    ds_read_b64_tr_b16 v[40:41], v108 offset:2048
    ds_read_b64_tr_b16 v[42:43], v104 offset:1024
    ds_read_b64_tr_b16 v[44:45], v104 offset:0
    ds_read_b64_tr_b16 v[46:47], v104 offset:6144
    ds_read_b64_tr_b16 v[48:49], v104 offset:5120
    ds_read_b64_tr_b16 v[50:51], v109 offset:2048
    ds_read_b64_tr_b16 v[52:53], v105 offset:1024
    ds_read_b64_tr_b16 v[54:55], v105 offset:0
    ds_read_b64_tr_b16 v[56:57], v105 offset:6144
    ds_read_b64_tr_b16 v[58:59], v105 offset:5120
    ds_read_b64_tr_b16 v[60:61], v110 offset:2048
    ds_read_b64_tr_b16 v[62:63], v106 offset:1024
    ds_read_b64_tr_b16 v[64:65], v106 offset:0
    ds_read_b64_tr_b16 v[66:67], v106 offset:6144
    ds_read_b64_tr_b16 v[68:69], v106 offset:5120
    s_waitcnt lgkmcnt(10)
    ds_read_b64_tr_b16 v[70:71], v111 offset:2048
    ds_read_b64_tr_b16 v[72:73], v107 offset:1024
    ds_read_b64_tr_b16 v[74:75], v107 offset:0
    ds_read_b64_tr_b16 v[76:77], v107 offset:6144
    ds_read_b64_tr_b16 v[78:79], v107 offset:5120
    v_dot2_f32_bf16 v86, v41, v33, 0
    v_dot2_f32_bf16 v88, v42, v33, 0
    v_dot2_f32_bf16 v90, v43, v33, 0
    v_dot2_f32_bf16 v92, v44, v33, 0
    v_alignbit_b32 v80, v41, v40, 16
    v_alignbit_b32 v81, v42, v41, 16
    v_alignbit_b32 v82, v43, v42, 16
    v_alignbit_b32 v83, v44, v43, 16
    v_alignbit_b32 v84, v45, v44, 16
    v_dot2_f32_bf16 v86, v40, v32, v86
    v_dot2_f32_bf16 v88, v41, v32, v88
    v_dot2_f32_bf16 v90, v42, v32, v90
    v_dot2_f32_bf16 v92, v43, v32, v92
    v_dot2_f32_bf16 v87, v81, v33, 0
    v_dot2_f32_bf16 v89, v82, v33, 0
    v_dot2_f32_bf16 v91, v83, v33, 0
    v_dot2_f32_bf16 v93, v84, v33, 0
    v_lshlrev_b32 v94, 16, v46
    v_and_b32 v95, 0xffff0000, v46
    v_lshlrev_b32 v96, 16, v47
    v_and_b32 v97, 0xffff0000, v47
    v_lshlrev_b32 v98, 16, v48
    v_and_b32 v99, 0xffff0000, v48
    v_lshlrev_b32 v100, 16, v49
    v_and_b32 v101, 0xffff0000, v49
    v_dot2_f32_bf16 v87, v80, v32, v87
    v_dot2_f32_bf16 v89, v81, v32, v89
    v_dot2_f32_bf16 v91, v82, v32, v91
    v_dot2_f32_bf16 v93, v83, v32, v93
    v_pk_mul_f32 v[86:87], v[86:87], v[94:95]
    v_pk_mul_f32 v[88:89], v[88:89], v[96:97]
    v_pk_mul_f32 v[90:91], v[90:91], v[98:99]
    v_pk_mul_f32 v[92:93], v[92:93], v[100:101]
    v_cvt_pk_bf16_f32 v112, v86, v87
    v_cvt_pk_bf16_f32 v113, v88, v89
    v_cvt_pk_bf16_f32 v114, v90, v91
    v_cvt_pk_bf16_f32 v115, v92, v93
    buffer_store_dwordx4 v[112:115], v2, s[8:11], s29 offen offset:0 sc1
    s_waitcnt lgkmcnt(10)
    v_dot2_f32_bf16 v86, v51, v35, 0
    v_dot2_f32_bf16 v88, v52, v35, 0
    v_dot2_f32_bf16 v90, v53, v35, 0
    v_dot2_f32_bf16 v92, v54, v35, 0
    v_alignbit_b32 v80, v51, v50, 16
    v_alignbit_b32 v81, v52, v51, 16
    v_alignbit_b32 v82, v53, v52, 16
    v_alignbit_b32 v83, v54, v53, 16
    v_alignbit_b32 v84, v55, v54, 16
    v_dot2_f32_bf16 v86, v50, v34, v86
    v_dot2_f32_bf16 v88, v51, v34, v88
    v_dot2_f32_bf16 v90, v52, v34, v90
    v_dot2_f32_bf16 v92, v53, v34, v92
    v_dot2_f32_bf16 v87, v81, v35, 0
    v_dot2_f32_bf16 v89, v82, v35, 0
    v_dot2_f32_bf16 v91, v83, v35, 0
    v_dot2_f32_bf16 v93, v84, v35, 0
    v_lshlrev_b32 v94, 16, v56
    v_and_b32 v95, 0xffff0000, v56
    v_lshlrev_b32 v96, 16, v57
    v_and_b32 v97, 0xffff0000, v57
    v_lshlrev_b32 v98, 16, v58
    v_and_b32 v99, 0xffff0000, v58
    v_lshlrev_b32 v100, 16, v59
    v_and_b32 v101, 0xffff0000, v59
    v_dot2_f32_bf16 v87, v80, v34, v87
    v_dot2_f32_bf16 v89, v81, v34, v89
    v_dot2_f32_bf16 v91, v82, v34, v91
    v_dot2_f32_bf16 v93, v83, v34, v93
    v_pk_mul_f32 v[86:87], v[86:87], v[94:95]
    v_pk_mul_f32 v[88:89], v[88:89], v[96:97]
    v_pk_mul_f32 v[90:91], v[90:91], v[98:99]
    v_pk_mul_f32 v[92:93], v[92:93], v[100:101]
    v_cvt_pk_bf16_f32 v116, v86, v87
    v_cvt_pk_bf16_f32 v117, v88, v89
    v_cvt_pk_bf16_f32 v118, v90, v91
    v_cvt_pk_bf16_f32 v119, v92, v93
    buffer_store_dwordx4 v[116:119], v2, s[8:11], s29 offen offset:1024 sc1
    s_waitcnt lgkmcnt(5)
    v_dot2_f32_bf16 v86, v61, v37, 0
    v_dot2_f32_bf16 v88, v62, v37, 0
    v_dot2_f32_bf16 v90, v63, v37, 0
    v_dot2_f32_bf16 v92, v64, v37, 0
    v_alignbit_b32 v80, v61, v60, 16
    v_alignbit_b32 v81, v62, v61, 16
    v_alignbit_b32 v82, v63, v62, 16
    v_alignbit_b32 v83, v64, v63, 16
    v_alignbit_b32 v84, v65, v64, 16
    v_dot2_f32_bf16 v86, v60, v36, v86
    v_dot2_f32_bf16 v88, v61, v36, v88
    v_dot2_f32_bf16 v90, v62, v36, v90
    v_dot2_f32_bf16 v92, v63, v36, v92
    v_dot2_f32_bf16 v87, v81, v37, 0
    v_dot2_f32_bf16 v89, v82, v37, 0
    v_dot2_f32_bf16 v91, v83, v37, 0
    v_dot2_f32_bf16 v93, v84, v37, 0
    v_lshlrev_b32 v94, 16, v66
    v_and_b32 v95, 0xffff0000, v66
    v_lshlrev_b32 v96, 16, v67
    v_and_b32 v97, 0xffff0000, v67
    v_lshlrev_b32 v98, 16, v68
    v_and_b32 v99, 0xffff0000, v68
    v_lshlrev_b32 v100, 16, v69
    v_and_b32 v101, 0xffff0000, v69
    v_dot2_f32_bf16 v87, v80, v36, v87
    v_dot2_f32_bf16 v89, v81, v36, v89
    v_dot2_f32_bf16 v91, v82, v36, v91
    v_dot2_f32_bf16 v93, v83, v36, v93
    v_pk_mul_f32 v[86:87], v[86:87], v[94:95]
    v_pk_mul_f32 v[88:89], v[88:89], v[96:97]
    v_pk_mul_f32 v[90:91], v[90:91], v[98:99]
    v_pk_mul_f32 v[92:93], v[92:93], v[100:101]
    v_cvt_pk_bf16_f32 v120, v86, v87
    v_cvt_pk_bf16_f32 v121, v88, v89
    v_cvt_pk_bf16_f32 v122, v90, v91
    v_cvt_pk_bf16_f32 v123, v92, v93
    buffer_store_dwordx4 v[120:123], v2, s[8:11], s29 offen offset:2048 sc1
    s_waitcnt lgkmcnt(0)
    v_dot2_f32_bf16 v86, v71, v39, 0
    v_dot2_f32_bf16 v88, v72, v39, 0
    v_dot2_f32_bf16 v90, v73, v39, 0
    v_dot2_f32_bf16 v92, v74, v39, 0
    v_alignbit_b32 v80, v71, v70, 16
    v_alignbit_b32 v81, v72, v71, 16
    v_alignbit_b32 v82, v73, v72, 16
    v_alignbit_b32 v83, v74, v73, 16
    v_alignbit_b32 v84, v75, v74, 16
    v_dot2_f32_bf16 v86, v70, v38, v86
    v_dot2_f32_bf16 v88, v71, v38, v88
    v_dot2_f32_bf16 v90, v72, v38, v90
    v_dot2_f32_bf16 v92, v73, v38, v92
    v_dot2_f32_bf16 v87, v81, v39, 0
    v_dot2_f32_bf16 v89, v82, v39, 0
    v_dot2_f32_bf16 v91, v83, v39, 0
    v_dot2_f32_bf16 v93, v84, v39, 0
    v_lshlrev_b32 v94, 16, v76
    v_and_b32 v95, 0xffff0000, v76
    v_lshlrev_b32 v96, 16, v77
    v_and_b32 v97, 0xffff0000, v77
    v_lshlrev_b32 v98, 16, v78
    v_and_b32 v99, 0xffff0000, v78
    v_lshlrev_b32 v100, 16, v79
    v_and_b32 v101, 0xffff0000, v79
    v_dot2_f32_bf16 v87, v80, v38, v87
    v_dot2_f32_bf16 v89, v81, v38, v89
    v_dot2_f32_bf16 v91, v82, v38, v91
    v_dot2_f32_bf16 v93, v83, v38, v93
    v_pk_mul_f32 v[86:87], v[86:87], v[94:95]
    v_pk_mul_f32 v[88:89], v[88:89], v[96:97]
    v_pk_mul_f32 v[90:91], v[90:91], v[98:99]
    v_pk_mul_f32 v[92:93], v[92:93], v[100:101]
    v_cvt_pk_bf16_f32 v124, v86, v87
    v_cvt_pk_bf16_f32 v125, v88, v89
    v_cvt_pk_bf16_f32 v126, v90, v91
    v_cvt_pk_bf16_f32 v127, v92, v93
    buffer_store_dwordx4 v[124:127], v2, s[8:11], s29 offen offset:3072 sc1
    v_lshlrev_b32 v9, 3, v0
    ds_write_b64 v9, v[12:13] offset:45056
    v_lshl_add_u32 v9, v3, 2, s28
    v_subrev_u32 v11, 32, v9
    s_mov_b64 exec, 0xff
    ds_write_b32 v11, v12
    s_mov_b64 exec, 0x7f
    ds_write_b32 v11, v12 offset:4160
    s_mov_b64 exec, -1
    v_add_u32 v10, s28, v2
    s_waitcnt vmcnt(0)
    s_mov_b64 exec, 1
    ds_inc_u32 v1, v1 offset:4
    s_mov_b64 exec, -1
    s_mov_b32 m0, s28
    buffer_load_ushort v28, v12, s[36:39], s7 offen
    buffer_load_dwordx4 v2, s[12:15], s6 offen offset:0 nt lds
    buffer_load_dwordx4 v2, s[12:15], s6 offen offset:1024 nt lds
    buffer_load_dwordx4 v2, s[12:15], s6 offen offset:2048 nt lds
    buffer_load_dwordx4 v2, s[12:15], s6 offen offset:3072 nt lds
    s_add_u32 s20, s44, 0x600000
    s_addc_u32 s21, s45, 0
    s_mov_b32 s22, 0x280000
    s_mov_b32 s23, 0x20000
    v_and_b32 v5, 15, v3
    v_lshrrev_b32 v6, 4, v3
    v_bfe_u32 v7, v3, 2, 1
    v_lshl_add_u32 v7, v6, 1, v7
    v_mul_u32_u24 v7, 20480, v7
    v_bfe_u32 v8, v3, 3, 1
    v_lshl_add_u32 v7, v8, 6, v7
    v_xor_b32 v8, v6, v3
    v_and_b32 v8, 3, v8
    v_lshl_add_u32 v7, v8, 4, v7
    s_lshl_b32 s31, s94, 7
    s_mul_i32 s32, s3, 163840
    s_add_u32 s31, s31, s32
    s_mov_b32 s43, s31
    v_lshrrev_b32 v8, 3, v3
    v_mul_u32_u24 v14, 20480, v8
    v_and_b32 v9, 7, v3
    v_lshl_add_u32 v14, v9, 4, v14
    v_xor_b32 v9, v9, v8
    v_lshlrev_b32 v9, 4, v9
    v_lshl_add_u32 v15, v8, 7, v9
    s_lshl_b32 s33, s3, 10
    s_add_u32 s33, s33, 129408
    v_add_u32 v15, s33, v15
    v_add_u32 v8, 1, v5
    v_lshrrev_b32 v8, 1, v8
    v_lshlrev_b32 v8, 2, v8
    v_lshl_add_u32 v8, v6, 4, v8
    v_and_b32 v9, 1, v5
    v_xor_b32 v9, 1, v9
    v_mul_u32_u24 v9, 4160, v9
    v_add3_u32 v16, v8, v9, s28
    v_subrev_u32 v16, 32, v16
    v_add_u32 v17, 1024, v16
    v_add_u32 v18, 2048, v16
    v_add_u32 v19, 3072, v16
    v_lshlrev_b32 v8, 1, v5
    v_sub_u32 v8, v8, v6
    v_add_u32 v8, 1, v8
    v_and_b32 v9, 1, v8
    v_lshlrev_b32 v9, 7, v9
    v_bfe_u32 v29, v8, 1, 1
    v_lshl_add_u32 v9, v29, 6, v9
    v_ashrrev_i32 v8, 2, v8
    v_lshl_add_u32 v29, v8, 8, v9
    v_subrev_u32 v30, 0, v8
    v_xor_b32 v30, s3, v30
    v_and_b32 v30, 3, v30
    v_lshl_add_u32 v30, v30, 4, v29
    v_add_u32 v20, 46080, v30
    v_subrev_u32 v30, 1, v8
    v_xor_b32 v30, s3, v30
    v_and_b32 v30, 3, v30
    v_lshl_add_u32 v30, v30, 4, v29
    v_add_u32 v21, 45824, v30
    v_subrev_u32 v30, 2, v8
    v_xor_b32 v30, s3, v30
    v_and_b32 v30, 3, v30
    v_lshl_add_u32 v30, v30, 4, v29
    v_add_u32 v22, 45568, v30
    v_subrev_u32 v30, 3, v8
    v_xor_b32 v30, s3, v30
    v_and_b32 v30, 3, v30
    v_lshl_add_u32 v30, v30, 4, v29
    v_add_u32 v23, 45312, v30
    v_lshrrev_b32 v8, 1, v6
    v_lshrrev_b32 v29, 1, v5
    v_lshl_add_u32 v9, v29, 1, v8
    v_lshlrev_b32 v9, 7, v9
    v_xor_b32 v29, s3, v29
    v_and_b32 v29, 3, v29
    v_lshl_add_u32 v9, v29, 4, v9
    v_and_b32 v29, 1, v5
    v_lshl_add_u32 v9, v29, 6, v9
    v_and_b32 v30, 1, v6
    v_xor_b32 v31, 1, v30
    v_lshl_add_u32 v9, v31, 3, v9
    v_add_u32 v29, 47104, v9
    s_lshl_b32 s42, s3, 1
    v_add_u32 v8, s42, v8
    v_and_b32 v9, 7, v5
    v_xor_b32 v8, v8, v9
    v_lshlrev_b32 v8, 4, v8
    v_lshl_add_u32 v8, v5, 7, v8
    v_lshl_add_u32 v8, v30, 3, v8
    v_add_u32 v31, 129408, v8
    v_add_u32 v30, 79872, v2
    s_lshl_b32 s33, s3, 10
    s_add_u32 s33, s33, 47104
    s_waitcnt vmcnt(0)
    ds_read_b128 v[64:67], v10 offset:0
    ds_read_b32 v68, v10 offset:16
    ds_read_b128 v[72:75], v10 offset:1024
    ds_read_b32 v76, v10 offset:1040
    ds_read_b128 v[80:83], v10 offset:2048
    ds_read_b32 v84, v10 offset:2064
    ds_read_b128 v[88:91], v10 offset:3072
    ds_read_b32 v92, v10 offset:3088
    v_lshlrev_b32 v28, 16, v28
    s_waitcnt lgkmcnt(6)
    v_lshlrev_b32 v69, 16, v64
    v_alignbyte_b32 v64, v65, v64, 2
    v_alignbyte_b32 v65, v66, v65, 2
    v_alignbyte_b32 v66, v67, v66, 2
    v_alignbyte_b32 v67, v68, v67, 2
    s_waitcnt lgkmcnt(4)
    v_alignbyte_b32 v72, v73, v72, 2
    v_alignbyte_b32 v73, v74, v73, 2
    v_alignbyte_b32 v74, v75, v74, 2
    v_alignbyte_b32 v75, v76, v75, 2
    s_waitcnt lgkmcnt(2)
    v_alignbyte_b32 v80, v81, v80, 2
    v_alignbyte_b32 v81, v82, v81, 2
    v_alignbyte_b32 v82, v83, v82, 2
    v_alignbyte_b32 v83, v84, v83, 2
    s_waitcnt lgkmcnt(0)
    v_alignbyte_b32 v88, v89, v88, 2
    v_alignbyte_b32 v89, v90, v89, 2
    v_alignbyte_b32 v90, v91, v90, 2
    v_alignbyte_b32 v91, v92, v91, 2
    ds_write_b128 v10, v[64:67] offset:4160
    ds_write_b128 v10, v[72:75] offset:5184
    ds_write_b128 v10, v[80:83] offset:6208
    ds_write_b128 v10, v[88:91] offset:7232
    s_mov_b64 exec, 1
    ds_write_b32 v10, v69 offset:4156
    s_mov_b64 exec, -1
    s_waitcnt lgkmcnt(0)
    ds_read2_b32 a[0:1], v16 offset0:0 offset1:1
    ds_read2_b32 a[2:3], v16 offset0:2 offset1:3
    ds_read2_b32 a[4:5], v16 offset0:128 offset1:129
    ds_read2_b32 a[6:7], v16 offset0:130 offset1:131
    ds_read2_b32 a[8:9], v17 offset0:0 offset1:1
    ds_read2_b32 a[10:11], v17 offset0:2 offset1:3
    ds_read2_b32 a[12:13], v17 offset0:128 offset1:129
    ds_read2_b32 a[14:15], v17 offset0:130 offset1:131
    ds_read2_b32 a[16:17], v18 offset0:0 offset1:1
    ds_read2_b32 a[18:19], v18 offset0:2 offset1:3
    ds_read2_b32 a[20:21], v18 offset0:128 offset1:129
    ds_read2_b32 a[22:23], v18 offset0:130 offset1:131
    ds_read2_b32 a[24:25], v19 offset0:0 offset1:1
    ds_read2_b32 a[26:27], v19 offset0:2 offset1:3
    ds_read2_b32 a[28:29], v19 offset0:128 offset1:129
    ds_read2_b32 a[30:31], v19 offset0:130 offset1:131
    s_mov_b32 s35, 0
K_GO:
    ds_read_b32 v6, v1 offset:12
    s_add_u32 s35, s35, 1
    s_cmp_gt_u32 s35, 256000
    s_cbranch_scc1 K_GO_X
    s_waitcnt lgkmcnt(0)
    v_cmp_gt_u32 vcc, 1, v6
    s_nop 1
    s_cbranch_vccnz K_GO
K_GO_X:
    s_waitcnt lgkmcnt(0)
    s_setprio 2
    s_mov_b32 m0, s33
    s_add_u32 s33, s33, 4096
    buffer_load_dwordx4 v7, s[8:11], s31 offen sc1 lds
    s_add_u32 s31, s31, 655360
    s_mov_b32 m0, s33
    s_add_u32 s33, s33, 4096
    buffer_load_dwordx4 v7, s[8:11], s31 offen sc1 lds
    s_add_u32 s31, s31, 655360
    s_mov_b32 m0, s33
    s_add_u32 s33, s33, 4096
    buffer_load_dwordx4 v7, s[8:11], s31 offen sc1 lds
    s_add_u32 s31, s31, 655360
    s_mov_b32 m0, s33
    s_nop 0
    buffer_load_dwordx4 v7, s[8:11], s31 offen sc1 lds
    s_waitcnt vmcnt(0)
    s_mov_b64 exec, 1
    ds_inc_u32 v1, v1 offset:16
    s_mov_b64 exec, -1
    s_mov_b32 s35, 0
K_LV:
    ds_read_b32 v6, v1 offset:16
    s_add_u32 s35, s35, 1
    s_cmp_gt_u32 s35, 256000
    s_cbranch_scc1 K_LV_X
    s_waitcnt lgkmcnt(0)
    v_cmp_gt_u32 vcc, 4, v6
    s_nop 1
    s_cbranch_vccnz K_LV
K_LV_X:
    s_waitcnt lgkmcnt(0)
    ds_read_b128 a[32:35], v20 offset:1024
    ds_read_b128 a[36:39], v20 offset:3072
    ds_read_b128 a[40:43], v20 offset:5120
    ds_read_b128 a[44:47], v20 offset:7168
    ds_read_b128 a[48:51], v20 offset:9216
    ds_read_b128 a[52:55], v20 offset:11264
    ds_read_b128 a[56:59], v20 offset:13312
    ds_read_b128 a[60:63], v20 offset:15360
    s_waitcnt lgkmcnt(0)
    v_mfma_f32_16x16x32_bf16 v[32:35], a[0:3], a[32:35], 0
    ds_read_b128 a[96:99], v21 offset:1024
    v_mfma_f32_16x16x32_bf16 v[36:39], a[0:3], a[36:39], 0
    ds_read2_b32 a[64:65], v16 offset0:16 offset1:17
    v_mfma_f32_16x16x32_bf16 v[36:39], a[4:7], a[32:35], v[36:39]
    ds_read2_b32 a[66:67], v16 offset0:18 offset1:19
    v_mfma_f32_16x16x32_bf16 v[40:43], a[4:7], a[36:39], 0
    ds_read_b128 a[100:103], v21 offset:3072
    v_mfma_f32_16x16x32_bf16 v[40:43], a[0:3], a[40:43], v[40:43]
    ds_read2_b32 a[68:69], v16 offset0:144 offset1:145
    v_mfma_f32_16x16x32_bf16 v[44:47], a[4:7], a[40:43], 0
    ds_read2_b32 a[70:71], v16 offset0:146 offset1:147
    v_mfma_f32_16x16x32_bf16 v[40:43], a[8:11], a[32:35], v[40:43]
    ds_read_b128 a[104:107], v21 offset:5120
    v_mfma_f32_16x16x32_bf16 v[44:47], a[8:11], a[36:39], v[44:47]
    ds_read2_b32 a[72:73], v17 offset0:16 offset1:17
    v_mfma_f32_16x16x32_bf16 v[48:51], a[8:11], a[40:43], 0
    ds_read2_b32 a[74:75], v17 offset0:18 offset1:19
    v_mfma_f32_16x16x32_bf16 v[44:47], a[0:3], a[44:47], v[44:47]
    ds_read_b128 a[108:111], v21 offset:7168
    v_mfma_f32_16x16x32_bf16 v[48:51], a[4:7], a[44:47], v[48:51]
    ds_read2_b32 a[76:77], v17 offset0:144 offset1:145
    v_mfma_f32_16x16x32_bf16 v[52:55], a[8:11], a[44:47], 0
    ds_read2_b32 a[78:79], v17 offset0:146 offset1:147
    v_mfma_f32_16x16x32_bf16 v[44:47], a[12:15], a[32:35], v[44:47]
    ds_read_b128 a[112:115], v21 offset:9216
    v_mfma_f32_16x16x32_bf16 v[48:51], a[12:15], a[36:39], v[48:51]
    ds_read2_b32 a[80:81], v18 offset0:16 offset1:17
    v_mfma_f32_16x16x32_bf16 v[52:55], a[12:15], a[40:43], v[52:55]
    ds_read2_b32 a[82:83], v18 offset0:18 offset1:19
    v_mfma_f32_16x16x32_bf16 v[56:59], a[12:15], a[44:47], 0
    ds_read_b128 a[116:119], v21 offset:11264
    v_mfma_f32_16x16x32_bf16 v[48:51], a[0:3], a[48:51], v[48:51]
    ds_read2_b32 a[84:85], v18 offset0:144 offset1:145
    v_mfma_f32_16x16x32_bf16 v[52:55], a[4:7], a[48:51], v[52:55]
    ds_read2_b32 a[86:87], v18 offset0:146 offset1:147
    v_mfma_f32_16x16x32_bf16 v[56:59], a[8:11], a[48:51], v[56:59]
    ds_read_b128 a[120:123], v21 offset:13312
    v_mfma_f32_16x16x32_bf16 v[60:63], a[12:15], a[48:51], 0
    ds_read2_b32 a[88:89], v19 offset0:16 offset1:17
    v_mfma_f32_16x16x32_bf16 v[48:51], a[16:19], a[32:35], v[48:51]
    ds_read2_b32 a[90:91], v19 offset0:18 offset1:19
    v_mfma_f32_16x16x32_bf16 v[52:55], a[16:19], a[36:39], v[52:55]
    ds_read_b128 a[124:127], v21 offset:15360
    v_mfma_f32_16x16x32_bf16 v[56:59], a[16:19], a[40:43], v[56:59]
    ds_read2_b32 a[92:93], v19 offset0:144 offset1:145
    v_mfma_f32_16x16x32_bf16 v[60:63], a[16:19], a[44:47], v[60:63]
    ds_read2_b32 a[94:95], v19 offset0:146 offset1:147
    v_mfma_f32_16x16x32_bf16 v[52:55], a[0:3], a[52:55], v[52:55]
    ds_read_b64 v[6:7], v29 offset:0
    v_mfma_f32_16x16x32_bf16 v[56:59], a[4:7], a[52:55], v[56:59]
    ds_read_b64 v[8:9], v29 offset:2048
    v_mfma_f32_16x16x32_bf16 v[60:63], a[8:11], a[52:55], v[60:63]
    ds_read_b64 v[10:11], v29 offset:4096
    v_mfma_f32_16x16x32_bf16 v[52:55], a[20:23], a[32:35], v[52:55]
    v_mfma_f32_16x16x32_bf16 v[56:59], a[20:23], a[36:39], v[56:59]
    v_mfma_f32_16x16x32_bf16 v[60:63], a[20:23], a[40:43], v[60:63]
    v_mfma_f32_16x16x32_bf16 v[56:59], a[0:3], a[56:59], v[56:59]
    v_mfma_f32_16x16x32_bf16 v[60:63], a[4:7], a[56:59], v[60:63]
    v_mfma_f32_16x16x32_bf16 v[56:59], a[24:27], a[32:35], v[56:59]
    v_mfma_f32_16x16x32_bf16 v[60:63], a[24:27], a[36:39], v[60:63]
    v_mfma_f32_16x16x32_bf16 v[60:63], a[0:3], a[60:63], v[60:63]
    v_mfma_f32_16x16x32_bf16 v[60:63], a[28:31], a[32:35], v[60:63]
    s_waitcnt lgkmcnt(0)
    v_mfma_f32_16x16x32_bf16 v[32:35], a[64:67], a[96:99], v[32:35]
    ds_read_b128 a[32:35], v22 offset:1024
    v_mfma_f32_16x16x32_bf16 v[36:39], a[64:67], a[100:103], v[36:39]
    ds_read2_b32 a[0:1], v16 offset0:32 offset1:33
    v_mfma_f32_16x16x32_bf16 v[36:39], a[68:71], a[96:99], v[36:39]
    v_and_b32 v96, 0xffff0000, v7
    ds_read2_b32 a[2:3], v16 offset0:34 offset1:35
    v_mfma_f32_16x16x32_bf16 v[40:43], a[68:71], a[100:103], v[40:43]
    v_lshlrev_b32 v97, 16, v7
    ds_read_b128 a[36:39], v22 offset:3072
    v_mfma_f32_16x16x32_bf16 v[40:43], a[64:67], a[104:107], v[40:43]
    v_and_b32 v98, 0xffff0000, v6
    ds_read2_b32 a[4:5], v16 offset0:160 offset1:161
    v_mfma_f32_16x16x32_bf16 v[44:47], a[68:71], a[104:107], v[44:47]
    v_lshlrev_b32 v99, 16, v6
    ds_read2_b32 a[6:7], v16 offset0:162 offset1:163
    v_mfma_f32_16x16x32_bf16 v[40:43], a[72:75], a[96:99], v[40:43]
    v_mul_f32 v96, v28, v96
    ds_read_b128 a[40:43], v22 offset:5120
    v_mfma_f32_16x16x32_bf16 v[44:47], a[72:75], a[100:103], v[44:47]
    v_mul_f32 v97, v28, v97
    ds_read2_b32 a[8:9], v17 offset0:32 offset1:33
    v_mfma_f32_16x16x32_bf16 v[48:51], a[72:75], a[104:107], v[48:51]
    v_mul_f32 v98, v28, v98
    ds_read2_b32 a[10:11], v17 offset0:34 offset1:35
    v_mfma_f32_16x16x32_bf16 v[44:47], a[64:67], a[108:111], v[44:47]
    v_mul_f32 v99, v28, v99
    ds_read_b128 a[44:47], v22 offset:7168
    v_mfma_f32_16x16x32_bf16 v[48:51], a[68:71], a[108:111], v[48:51]
    v_and_b32 v100, 0xffff0000, v9
    ds_read2_b32 a[12:13], v17 offset0:160 offset1:161
    v_mfma_f32_16x16x32_bf16 v[52:55], a[72:75], a[108:111], v[52:55]
    v_lshlrev_b32 v101, 16, v9
    ds_read2_b32 a[14:15], v17 offset0:162 offset1:163
    v_mfma_f32_16x16x32_bf16 v[44:47], a[76:79], a[96:99], v[44:47]
    v_and_b32 v102, 0xffff0000, v8
    ds_read_b128 a[48:51], v22 offset:9216
    v_mfma_f32_16x16x32_bf16 v[48:51], a[76:79], a[100:103], v[48:51]
    v_lshlrev_b32 v103, 16, v8
    ds_read2_b32 a[16:17], v18 offset0:32 offset1:33
    v_mfma_f32_16x16x32_bf16 v[52:55], a[76:79], a[104:107], v[52:55]
    v_mul_f32 v100, v28, v100
    ds_read2_b32 a[18:19], v18 offset0:34 offset1:35
    v_mfma_f32_16x16x32_bf16 v[56:59], a[76:79], a[108:111], v[56:59]
    v_mul_f32 v101, v28, v101
    ds_read_b128 a[52:55], v22 offset:11264
    v_mfma_f32_16x16x32_bf16 v[48:51], a[64:67], a[112:115], v[48:51]
    v_mul_f32 v102, v28, v102
    ds_read2_b32 a[20:21], v18 offset0:160 offset1:161
    v_mfma_f32_16x16x32_bf16 v[52:55], a[68:71], a[112:115], v[52:55]
    v_mul_f32 v103, v28, v103
    ds_read2_b32 a[22:23], v18 offset0:162 offset1:163
    v_mfma_f32_16x16x32_bf16 v[56:59], a[72:75], a[112:115], v[56:59]
    v_and_b32 v104, 0xffff0000, v11
    ds_read_b128 a[56:59], v22 offset:13312
    v_mfma_f32_16x16x32_bf16 v[60:63], a[76:79], a[112:115], v[60:63]
    v_lshlrev_b32 v105, 16, v11
    ds_read2_b32 a[24:25], v19 offset0:32 offset1:33
    v_mfma_f32_16x16x32_bf16 v[48:51], a[80:83], a[96:99], v[48:51]
    v_and_b32 v106, 0xffff0000, v10
    ds_read2_b32 a[26:27], v19 offset0:34 offset1:35
    v_mfma_f32_16x16x32_bf16 v[52:55], a[80:83], a[100:103], v[52:55]
    v_lshlrev_b32 v107, 16, v10
    ds_read_b128 a[60:63], v22 offset:15360
    v_mfma_f32_16x16x32_bf16 v[56:59], a[80:83], a[104:107], v[56:59]
    v_mul_f32 v104, v28, v104
    ds_read2_b32 a[28:29], v19 offset0:160 offset1:161
    v_mfma_f32_16x16x32_bf16 v[60:63], a[80:83], a[108:111], v[60:63]
    v_mul_f32 v105, v28, v105
    ds_read2_b32 a[30:31], v19 offset0:162 offset1:163
    v_mfma_f32_16x16x32_bf16 v[52:55], a[64:67], a[116:119], v[52:55]
    v_mul_f32 v106, v28, v106
    ds_read_b64 v[12:13], v29 offset:6144
    v_mfma_f32_16x16x32_bf16 v[56:59], a[68:71], a[116:119], v[56:59]
    v_mul_f32 v107, v28, v107
    ds_read_b64 v[24:25], v29 offset:8192
    v_mfma_f32_16x16x32_bf16 v[60:63], a[72:75], a[116:119], v[60:63]
    ds_read_b64 v[26:27], v29 offset:10240
    v_mfma_f32_16x16x32_bf16 v[52:55], a[84:87], a[96:99], v[52:55]
    v_mfma_f32_16x16x32_bf16 v[56:59], a[84:87], a[100:103], v[56:59]
    v_mfma_f32_16x16x32_bf16 v[60:63], a[84:87], a[104:107], v[60:63]
    v_mfma_f32_16x16x32_bf16 v[56:59], a[64:67], a[120:123], v[56:59]
    v_mfma_f32_16x16x32_bf16 v[60:63], a[68:71], a[120:123], v[60:63]
    v_mfma_f32_16x16x32_bf16 v[56:59], a[88:91], a[96:99], v[56:59]
    v_mfma_f32_16x16x32_bf16 v[60:63], a[88:91], a[100:103], v[60:63]
    v_mfma_f32_16x16x32_bf16 v[60:63], a[64:67], a[124:127], v[60:63]
    v_mfma_f32_16x16x32_bf16 v[60:63], a[92:95], a[96:99], v[60:63]
    s_waitcnt lgkmcnt(0)
    v_mfma_f32_16x16x32_bf16 v[32:35], a[0:3], a[32:35], v[32:35]
    ds_read_b128 a[96:99], v23 offset:1024
    v_mfma_f32_16x16x32_bf16 v[36:39], a[0:3], a[36:39], v[36:39]
    ds_read2_b32 a[64:65], v16 offset0:48 offset1:49
    v_mfma_f32_16x16x32_bf16 v[36:39], a[4:7], a[32:35], v[36:39]
    v_and_b32 v108, 0xffff0000, v13
    ds_read2_b32 a[66:67], v16 offset0:50 offset1:51
    v_mfma_f32_16x16x32_bf16 v[40:43], a[4:7], a[36:39], v[40:43]
    v_lshlrev_b32 v109, 16, v13
    ds_read_b128 a[100:103], v23 offset:3072
    v_mfma_f32_16x16x32_bf16 v[40:43], a[0:3], a[40:43], v[40:43]
    v_and_b32 v110, 0xffff0000, v12
    ds_read2_b32 a[68:69], v16 offset0:176 offset1:177
    v_mfma_f32_16x16x32_bf16 v[44:47], a[4:7], a[40:43], v[44:47]
    v_lshlrev_b32 v111, 16, v12
    ds_read2_b32 a[70:71], v16 offset0:178 offset1:179
    v_mfma_f32_16x16x32_bf16 v[40:43], a[8:11], a[32:35], v[40:43]
    v_mul_f32 v108, v28, v108
    ds_read_b128 a[104:107], v23 offset:5120
    v_mfma_f32_16x16x32_bf16 v[44:47], a[8:11], a[36:39], v[44:47]
    v_mul_f32 v109, v28, v109
    ds_read2_b32 a[72:73], v17 offset0:48 offset1:49
    v_mfma_f32_16x16x32_bf16 v[48:51], a[8:11], a[40:43], v[48:51]
    v_mul_f32 v110, v28, v110
    ds_read2_b32 a[74:75], v17 offset0:50 offset1:51
    v_mfma_f32_16x16x32_bf16 v[44:47], a[0:3], a[44:47], v[44:47]
    v_mul_f32 v111, v28, v111
    ds_read_b128 a[108:111], v23 offset:7168
    v_mfma_f32_16x16x32_bf16 v[48:51], a[4:7], a[44:47], v[48:51]
    v_and_b32 v112, 0xffff0000, v25
    ds_read2_b32 a[76:77], v17 offset0:176 offset1:177
    v_mfma_f32_16x16x32_bf16 v[52:55], a[8:11], a[44:47], v[52:55]
    v_lshlrev_b32 v113, 16, v25
    ds_read2_b32 a[78:79], v17 offset0:178 offset1:179
    v_mfma_f32_16x16x32_bf16 v[44:47], a[12:15], a[32:35], v[44:47]
    v_and_b32 v114, 0xffff0000, v24
    ds_read_b128 a[112:115], v23 offset:9216
    v_mfma_f32_16x16x32_bf16 v[48:51], a[12:15], a[36:39], v[48:51]
    v_lshlrev_b32 v115, 16, v24
    ds_read2_b32 a[80:81], v18 offset0:48 offset1:49
    v_mfma_f32_16x16x32_bf16 v[52:55], a[12:15], a[40:43], v[52:55]
    v_mul_f32 v112, v28, v112
    ds_read2_b32 a[82:83], v18 offset0:50 offset1:51
    v_mfma_f32_16x16x32_bf16 v[56:59], a[12:15], a[44:47], v[56:59]
    v_mul_f32 v113, v28, v113
    ds_read_b128 a[116:119], v23 offset:11264
    v_mfma_f32_16x16x32_bf16 v[48:51], a[0:3], a[48:51], v[48:51]
    v_mul_f32 v114, v28, v114
    ds_read2_b32 a[84:85], v18 offset0:176 offset1:177
    v_mfma_f32_16x16x32_bf16 v[52:55], a[4:7], a[48:51], v[52:55]
    v_mul_f32 v115, v28, v115
    ds_read2_b32 a[86:87], v18 offset0:178 offset1:179
    v_mfma_f32_16x16x32_bf16 v[56:59], a[8:11], a[48:51], v[56:59]
    v_and_b32 v116, 0xffff0000, v27
    ds_read_b128 a[120:123], v23 offset:13312
    v_mfma_f32_16x16x32_bf16 v[60:63], a[12:15], a[48:51], v[60:63]
    v_lshlrev_b32 v117, 16, v27
    ds_read2_b32 a[88:89], v19 offset0:48 offset1:49
    v_mfma_f32_16x16x32_bf16 v[48:51], a[16:19], a[32:35], v[48:51]
    v_and_b32 v118, 0xffff0000, v26
    ds_read2_b32 a[90:91], v19 offset0:50 offset1:51
    v_mfma_f32_16x16x32_bf16 v[52:55], a[16:19], a[36:39], v[52:55]
    v_lshlrev_b32 v119, 16, v26
    ds_read_b128 a[124:127], v23 offset:15360
    v_mfma_f32_16x16x32_bf16 v[56:59], a[16:19], a[40:43], v[56:59]
    v_mul_f32 v116, v28, v116
    ds_read2_b32 a[92:93], v19 offset0:176 offset1:177
    v_mfma_f32_16x16x32_bf16 v[60:63], a[16:19], a[44:47], v[60:63]
    v_mul_f32 v117, v28, v117
    ds_read2_b32 a[94:95], v19 offset0:178 offset1:179
    v_mfma_f32_16x16x32_bf16 v[52:55], a[0:3], a[52:55], v[52:55]
    v_mul_f32 v118, v28, v118
    ds_read_b64 v[6:7], v29 offset:12288
    v_mfma_f32_16x16x32_bf16 v[56:59], a[4:7], a[52:55], v[56:59]
    v_mul_f32 v119, v28, v119
    ds_read_b64 v[8:9], v29 offset:14336
    v_mfma_f32_16x16x32_bf16 v[60:63], a[8:11], a[52:55], v[60:63]
    v_mfma_f32_16x16x32_bf16 v[52:55], a[20:23], a[32:35], v[52:55]
    v_mfma_f32_16x16x32_bf16 v[56:59], a[20:23], a[36:39], v[56:59]
    v_mfma_f32_16x16x32_bf16 v[60:63], a[20:23], a[40:43], v[60:63]
    v_mfma_f32_16x16x32_bf16 v[56:59], a[0:3], a[56:59], v[56:59]
    v_mfma_f32_16x16x32_bf16 v[60:63], a[4:7], a[56:59], v[60:63]
    v_mfma_f32_16x16x32_bf16 v[56:59], a[24:27], a[32:35], v[56:59]
    v_mfma_f32_16x16x32_bf16 v[60:63], a[24:27], a[36:39], v[60:63]
    v_mfma_f32_16x16x32_bf16 v[60:63], a[0:3], a[60:63], v[60:63]
    v_mfma_f32_16x16x32_bf16 v[60:63], a[28:31], a[32:35], v[60:63]
    s_waitcnt lgkmcnt(0)
    v_mfma_f32_16x16x32_bf16 v[32:35], a[64:67], a[96:99], v[32:35]
    ds_read_b128 a[32:35], v20 offset:0
    v_mfma_f32_16x16x32_bf16 v[36:39], a[64:67], a[100:103], v[36:39]
    ds_read2_b32 a[0:1], v16 offset0:64 offset1:65
    v_mfma_f32_16x16x32_bf16 v[36:39], a[68:71], a[96:99], v[36:39]
    v_and_b32 v120, 0xffff0000, v7
    ds_read2_b32 a[2:3], v16 offset0:66 offset1:67
    v_mfma_f32_16x16x32_bf16 v[40:43], a[68:71], a[100:103], v[40:43]
    v_lshlrev_b32 v121, 16, v7
    ds_read_b128 a[36:39], v20 offset:2048
    v_mfma_f32_16x16x32_bf16 v[40:43], a[64:67], a[104:107], v[40:43]
    v_and_b32 v122, 0xffff0000, v6
    ds_read2_b32 a[4:5], v16 offset0:192 offset1:193
    v_mfma_f32_16x16x32_bf16 v[44:47], a[68:71], a[104:107], v[44:47]
    v_lshlrev_b32 v123, 16, v6
    ds_read2_b32 a[6:7], v16 offset0:194 offset1:195
    v_mfma_f32_16x16x32_bf16 v[40:43], a[72:75], a[96:99], v[40:43]
    v_mul_f32 v120, v28, v120
    ds_read_b128 a[40:43], v20 offset:4096
    v_mfma_f32_16x16x32_bf16 v[44:47], a[72:75], a[100:103], v[44:47]
    v_mul_f32 v121, v28, v121
    ds_read2_b32 a[8:9], v17 offset0:64 offset1:65
    v_mfma_f32_16x16x32_bf16 v[48:51], a[72:75], a[104:107], v[48:51]
    v_mul_f32 v122, v28, v122
    ds_read2_b32 a[10:11], v17 offset0:66 offset1:67
    v_mfma_f32_16x16x32_bf16 v[44:47], a[64:67], a[108:111], v[44:47]
    v_mul_f32 v123, v28, v123
    ds_read_b128 a[44:47], v20 offset:6144
    v_mfma_f32_16x16x32_bf16 v[48:51], a[68:71], a[108:111], v[48:51]
    v_and_b32 v124, 0xffff0000, v9
    ds_read2_b32 a[12:13], v17 offset0:192 offset1:193
    v_mfma_f32_16x16x32_bf16 v[52:55], a[72:75], a[108:111], v[52:55]
    v_lshlrev_b32 v125, 16, v9
    ds_read2_b32 a[14:15], v17 offset0:194 offset1:195
    v_mfma_f32_16x16x32_bf16 v[44:47], a[76:79], a[96:99], v[44:47]
    v_and_b32 v126, 0xffff0000, v8
    ds_read_b128 a[48:51], v20 offset:8192
    v_mfma_f32_16x16x32_bf16 v[48:51], a[76:79], a[100:103], v[48:51]
    v_lshlrev_b32 v127, 16, v8
    ds_read2_b32 a[16:17], v18 offset0:64 offset1:65
    v_mfma_f32_16x16x32_bf16 v[52:55], a[76:79], a[104:107], v[52:55]
    v_mul_f32 v124, v28, v124
    ds_read2_b32 a[18:19], v18 offset0:66 offset1:67
    v_mfma_f32_16x16x32_bf16 v[56:59], a[76:79], a[108:111], v[56:59]
    v_mul_f32 v125, v28, v125
    ds_read_b128 a[52:55], v20 offset:10240
    v_mfma_f32_16x16x32_bf16 v[48:51], a[64:67], a[112:115], v[48:51]
    v_mul_f32 v126, v28, v126
    ds_read2_b32 a[20:21], v18 offset0:192 offset1:193
    v_mfma_f32_16x16x32_bf16 v[52:55], a[68:71], a[112:115], v[52:55]
    v_mul_f32 v127, v28, v127
    ds_read2_b32 a[22:23], v18 offset0:194 offset1:195
    v_mfma_f32_16x16x32_bf16 v[56:59], a[72:75], a[112:115], v[56:59]
    ds_read_b128 a[56:59], v20 offset:12288
    v_mfma_f32_16x16x32_bf16 v[60:63], a[76:79], a[112:115], v[60:63]
    ds_read2_b32 a[24:25], v19 offset0:64 offset1:65
    v_mfma_f32_16x16x32_bf16 v[48:51], a[80:83], a[96:99], v[48:51]
    ds_read2_b32 a[26:27], v19 offset0:66 offset1:67
    v_mfma_f32_16x16x32_bf16 v[52:55], a[80:83], a[100:103], v[52:55]
    ds_read_b128 a[60:63], v20 offset:14336
    v_mfma_f32_16x16x32_bf16 v[56:59], a[80:83], a[104:107], v[56:59]
    ds_read2_b32 a[28:29], v19 offset0:192 offset1:193
    v_mfma_f32_16x16x32_bf16 v[60:63], a[80:83], a[108:111], v[60:63]
    ds_read2_b32 a[30:31], v19 offset0:194 offset1:195
    v_mfma_f32_16x16x32_bf16 v[52:55], a[64:67], a[116:119], v[52:55]
    v_mfma_f32_16x16x32_bf16 v[56:59], a[68:71], a[116:119], v[56:59]
    v_mfma_f32_16x16x32_bf16 v[60:63], a[72:75], a[116:119], v[60:63]
    v_mfma_f32_16x16x32_bf16 v[52:55], a[84:87], a[96:99], v[52:55]
    v_mfma_f32_16x16x32_bf16 v[56:59], a[84:87], a[100:103], v[56:59]
    v_mfma_f32_16x16x32_bf16 v[60:63], a[84:87], a[104:107], v[60:63]
    v_mfma_f32_16x16x32_bf16 v[56:59], a[64:67], a[120:123], v[56:59]
    v_mfma_f32_16x16x32_bf16 v[60:63], a[68:71], a[120:123], v[60:63]
    v_mfma_f32_16x16x32_bf16 v[56:59], a[88:91], a[96:99], v[56:59]
    v_mfma_f32_16x16x32_bf16 v[60:63], a[88:91], a[100:103], v[60:63]
    v_mfma_f32_16x16x32_bf16 v[60:63], a[64:67], a[124:127], v[60:63]
    v_mfma_f32_16x16x32_bf16 v[60:63], a[92:95], a[96:99], v[60:63]
    s_waitcnt lgkmcnt(0)
    v_mfma_f32_16x16x32_bf16 v[32:35], a[0:3], a[32:35], v[32:35]
    ds_read_b128 a[96:99], v21 offset:0
    v_mfma_f32_16x16x32_bf16 v[36:39], a[0:3], a[36:39], v[36:39]
    ds_read2_b32 a[64:65], v16 offset0:80 offset1:81
    v_mfma_f32_16x16x32_bf16 v[36:39], a[4:7], a[32:35], v[36:39]
    ds_read2_b32 a[66:67], v16 offset0:82 offset1:83
    v_mfma_f32_16x16x32_bf16 v[40:43], a[4:7], a[36:39], v[40:43]
    ds_read_b128 a[100:103], v21 offset:2048
    v_mfma_f32_16x16x32_bf16 v[40:43], a[0:3], a[40:43], v[40:43]
    ds_read2_b32 a[68:69], v16 offset0:208 offset1:209
    v_mfma_f32_16x16x32_bf16 v[44:47], a[4:7], a[40:43], v[44:47]
    ds_read2_b32 a[70:71], v16 offset0:210 offset1:211
    v_mfma_f32_16x16x32_bf16 v[40:43], a[8:11], a[32:35], v[40:43]
    ds_read_b128 a[104:107], v21 offset:4096
    v_mfma_f32_16x16x32_bf16 v[44:47], a[8:11], a[36:39], v[44:47]
    ds_read2_b32 a[72:73], v17 offset0:80 offset1:81
    v_mfma_f32_16x16x32_bf16 v[48:51], a[8:11], a[40:43], v[48:51]
    ds_read2_b32 a[74:75], v17 offset0:82 offset1:83
    v_mfma_f32_16x16x32_bf16 v[44:47], a[0:3], a[44:47], v[44:47]
    ds_read_b128 a[108:111], v21 offset:6144
    v_mfma_f32_16x16x32_bf16 v[48:51], a[4:7], a[44:47], v[48:51]
    ds_read2_b32 a[76:77], v17 offset0:208 offset1:209
    v_mfma_f32_16x16x32_bf16 v[52:55], a[8:11], a[44:47], v[52:55]
    ds_read2_b32 a[78:79], v17 offset0:210 offset1:211
    v_mfma_f32_16x16x32_bf16 v[44:47], a[12:15], a[32:35], v[44:47]
    ds_read_b128 a[112:115], v21 offset:8192
    v_mfma_f32_16x16x32_bf16 v[48:51], a[12:15], a[36:39], v[48:51]
    ds_read2_b32 a[80:81], v18 offset0:80 offset1:81
    v_mfma_f32_16x16x32_bf16 v[52:55], a[12:15], a[40:43], v[52:55]
    ds_read2_b32 a[82:83], v18 offset0:82 offset1:83
    v_mfma_f32_16x16x32_bf16 v[56:59], a[12:15], a[44:47], v[56:59]
    ds_read_b128 a[116:119], v21 offset:10240
    v_mfma_f32_16x16x32_bf16 v[48:51], a[0:3], a[48:51], v[48:51]
    ds_read2_b32 a[84:85], v18 offset0:208 offset1:209
    v_mfma_f32_16x16x32_bf16 v[52:55], a[4:7], a[48:51], v[52:55]
    ds_read2_b32 a[86:87], v18 offset0:210 offset1:211
    v_mfma_f32_16x16x32_bf16 v[56:59], a[8:11], a[48:51], v[56:59]
    ds_read_b128 a[120:123], v21 offset:12288
    v_mfma_f32_16x16x32_bf16 v[60:63], a[12:15], a[48:51], v[60:63]
    ds_read2_b32 a[88:89], v19 offset0:80 offset1:81
    v_mfma_f32_16x16x32_bf16 v[48:51], a[16:19], a[32:35], v[48:51]
    ds_read2_b32 a[90:91], v19 offset0:82 offset1:83
    v_mfma_f32_16x16x32_bf16 v[52:55], a[16:19], a[36:39], v[52:55]
    ds_read_b128 a[124:127], v21 offset:14336
    v_mfma_f32_16x16x32_bf16 v[56:59], a[16:19], a[40:43], v[56:59]
    ds_read2_b32 a[92:93], v19 offset0:208 offset1:209
    v_mfma_f32_16x16x32_bf16 v[60:63], a[16:19], a[44:47], v[60:63]
    ds_read2_b32 a[94:95], v19 offset0:210 offset1:211
    v_mfma_f32_16x16x32_bf16 v[52:55], a[0:3], a[52:55], v[52:55]
    v_mfma_f32_16x16x32_bf16 v[56:59], a[4:7], a[52:55], v[56:59]
    v_mfma_f32_16x16x32_bf16 v[60:63], a[8:11], a[52:55], v[60:63]
    v_mfma_f32_16x16x32_bf16 v[52:55], a[20:23], a[32:35], v[52:55]
    v_mfma_f32_16x16x32_bf16 v[56:59], a[20:23], a[36:39], v[56:59]
    v_mfma_f32_16x16x32_bf16 v[60:63], a[20:23], a[40:43], v[60:63]
    v_mfma_f32_16x16x32_bf16 v[56:59], a[0:3], a[56:59], v[56:59]
    v_mfma_f32_16x16x32_bf16 v[60:63], a[4:7], a[56:59], v[60:63]
    v_mfma_f32_16x16x32_bf16 v[56:59], a[24:27], a[32:35], v[56:59]
    v_mfma_f32_16x16x32_bf16 v[60:63], a[24:27], a[36:39], v[60:63]
    v_mfma_f32_16x16x32_bf16 v[60:63], a[0:3], a[60:63], v[60:63]
    v_mfma_f32_16x16x32_bf16 v[60:63], a[28:31], a[32:35], v[60:63]
    s_waitcnt lgkmcnt(0)
    v_mfma_f32_16x16x32_bf16 v[32:35], a[64:67], a[96:99], v[32:35]
    ds_read_b128 a[32:35], v22 offset:0
    v_mfma_f32_16x16x32_bf16 v[36:39], a[64:67], a[100:103], v[36:39]
    ds_read2_b32 a[0:1], v16 offset0:96 offset1:97
    v_mfma_f32_16x16x32_bf16 v[36:39], a[68:71], a[96:99], v[36:39]
    ds_read2_b32 a[2:3], v16 offset0:98 offset1:99
    v_mfma_f32_16x16x32_bf16 v[40:43], a[68:71], a[100:103], v[40:43]
    ds_read_b128 a[36:39], v22 offset:2048
    v_mfma_f32_16x16x32_bf16 v[40:43], a[64:67], a[104:107], v[40:43]
    ds_read2_b32 a[4:5], v16 offset0:224 offset1:225
    v_mfma_f32_16x16x32_bf16 v[44:47], a[68:71], a[104:107], v[44:47]
    ds_read2_b32 a[6:7], v16 offset0:226 offset1:227
    v_mfma_f32_16x16x32_bf16 v[40:43], a[72:75], a[96:99], v[40:43]
    ds_read_b128 a[40:43], v22 offset:4096
    v_mfma_f32_16x16x32_bf16 v[44:47], a[72:75], a[100:103], v[44:47]
    ds_read2_b32 a[8:9], v17 offset0:96 offset1:97
    v_mfma_f32_16x16x32_bf16 v[48:51], a[72:75], a[104:107], v[48:51]
    ds_read2_b32 a[10:11], v17 offset0:98 offset1:99
    v_mfma_f32_16x16x32_bf16 v[44:47], a[64:67], a[108:111], v[44:47]
    ds_read_b128 a[44:47], v22 offset:6144
    v_mfma_f32_16x16x32_bf16 v[48:51], a[68:71], a[108:111], v[48:51]
    ds_read2_b32 a[12:13], v17 offset0:224 offset1:225
    v_mfma_f32_16x16x32_bf16 v[52:55], a[72:75], a[108:111], v[52:55]
    ds_read2_b32 a[14:15], v17 offset0:226 offset1:227
    v_mfma_f32_16x16x32_bf16 v[44:47], a[76:79], a[96:99], v[44:47]
    ds_read_b128 a[48:51], v22 offset:8192
    v_mfma_f32_16x16x32_bf16 v[48:51], a[76:79], a[100:103], v[48:51]
    ds_read2_b32 a[16:17], v18 offset0:96 offset1:97
    v_mfma_f32_16x16x32_bf16 v[52:55], a[76:79], a[104:107], v[52:55]
    ds_read2_b32 a[18:19], v18 offset0:98 offset1:99
    v_mfma_f32_16x16x32_bf16 v[56:59], a[76:79], a[108:111], v[56:59]
    ds_read_b128 a[52:55], v22 offset:10240
    v_mfma_f32_16x16x32_bf16 v[48:51], a[64:67], a[112:115], v[48:51]
    ds_read2_b32 a[20:21], v18 offset0:224 offset1:225
    v_mfma_f32_16x16x32_bf16 v[52:55], a[68:71], a[112:115], v[52:55]
    ds_read2_b32 a[22:23], v18 offset0:226 offset1:227
    v_mfma_f32_16x16x32_bf16 v[56:59], a[72:75], a[112:115], v[56:59]
    ds_read_b128 a[56:59], v22 offset:12288
    v_mfma_f32_16x16x32_bf16 v[60:63], a[76:79], a[112:115], v[60:63]
    ds_read2_b32 a[24:25], v19 offset0:96 offset1:97
    v_mfma_f32_16x16x32_bf16 v[48:51], a[80:83], a[96:99], v[48:51]
    ds_read2_b32 a[26:27], v19 offset0:98 offset1:99
    v_mfma_f32_16x16x32_bf16 v[52:55], a[80:83], a[100:103], v[52:55]
    ds_read_b128 a[60:63], v22 offset:14336
    v_mfma_f32_16x16x32_bf16 v[56:59], a[80:83], a[104:107], v[56:59]
    ds_read2_b32 a[28:29], v19 offset0:224 offset1:225
    v_mfma_f32_16x16x32_bf16 v[60:63], a[80:83], a[108:111], v[60:63]
    ds_read2_b32 a[30:31], v19 offset0:226 offset1:227
    v_mfma_f32_16x16x32_bf16 v[52:55], a[64:67], a[116:119], v[52:55]
    ds_read_b32 v4, v1 offset:28
    v_mfma_f32_16x16x32_bf16 v[56:59], a[68:71], a[116:119], v[56:59]
    v_mfma_f32_16x16x32_bf16 v[60:63], a[72:75], a[116:119], v[60:63]
    v_mfma_f32_16x16x32_bf16 v[52:55], a[84:87], a[96:99], v[52:55]
    v_mfma_f32_16x16x32_bf16 v[56:59], a[84:87], a[100:103], v[56:59]
    v_mfma_f32_16x16x32_bf16 v[60:63], a[84:87], a[104:107], v[60:63]
    v_mfma_f32_16x16x32_bf16 v[56:59], a[64:67], a[120:123], v[56:59]
    v_mfma_f32_16x16x32_bf16 v[60:63], a[68:71], a[120:123], v[60:63]
    v_mfma_f32_16x16x32_bf16 v[56:59], a[88:91], a[96:99], v[56:59]
    v_mfma_f32_16x16x32_bf16 v[60:63], a[88:91], a[100:103], v[60:63]
    v_mfma_f32_16x16x32_bf16 v[60:63], a[64:67], a[124:127], v[60:63]
    v_mfma_f32_16x16x32_bf16 v[60:63], a[92:95], a[96:99], v[60:63]
    s_waitcnt lgkmcnt(0)
    v_cmp_gt_u32 vcc, 4, v4
    s_nop 1
    s_cbranch_vccnz K_LX_S
K_LX_B:
    v_mfma_f32_16x16x32_bf16 v[32:35], a[0:3], a[32:35], v[32:35]
    ds_read_b64 v[10:11], v29 offset:16384
    ds_read_b128 a[96:99], v23 offset:0
    v_mfma_f32_16x16x32_bf16 v[36:39], a[0:3], a[36:39], v[36:39]
    ds_read_b128 v[64:67], v30 offset:0
    ds_read2_b32 a[64:65], v16 offset0:112 offset1:113
    v_mfma_f32_16x16x32_bf16 v[36:39], a[4:7], a[32:35], v[36:39]
    ds_read_b128 v[6:9], v30 offset:8192
    ds_read2_b32 a[66:67], v16 offset0:114 offset1:115
    v_mfma_f32_16x16x32_bf16 v[40:43], a[4:7], a[36:39], v[40:43]
    ds_read_b64 v[12:13], v29 offset:18432
    ds_read_b128 a[100:103], v23 offset:2048
    v_mfma_f32_16x16x32_bf16 v[40:43], a[0:3], a[40:43], v[40:43]
    ds_read_b128 v[68:71], v30 offset:1024
    ds_read2_b32 a[68:69], v16 offset0:240 offset1:241
    v_mfma_f32_16x16x32_bf16 v[44:47], a[4:7], a[40:43], v[44:47]
    ds_read_b128 v[24:27], v30 offset:9216
    ds_read2_b32 a[70:71], v16 offset0:242 offset1:243
    v_mfma_f32_16x16x32_bf16 v[40:43], a[8:11], a[32:35], v[40:43]
    s_waitcnt lgkmcnt(7)
    v_and_b32 v2, 0xffff0000, v11
    v_lshlrev_b32 v3, 16, v11
    ds_read_b128 a[104:107], v23 offset:4096
    v_mfma_f32_16x16x32_bf16 v[44:47], a[8:11], a[36:39], v[44:47]
    v_and_b32 v4, 0xffff0000, v10
    v_lshlrev_b32 v5, 16, v10
    ds_read2_b32 a[72:73], v17 offset0:112 offset1:113
    v_mfma_f32_16x16x32_bf16 v[48:51], a[8:11], a[40:43], v[48:51]
    v_fma_f32 v64, v2, v64, v6
    v_fma_f32 v65, v3, v65, v7
    ds_read2_b32 a[74:75], v17 offset0:114 offset1:115
    v_mfma_f32_16x16x32_bf16 v[44:47], a[0:3], a[44:47], v[44:47]
    v_fma_f32 v66, v4, v66, v8
    v_fma_f32 v67, v5, v67, v9
    ds_read_b64 v[10:11], v29 offset:20480
    ds_read_b128 a[108:111], v23 offset:6144
    v_mfma_f32_16x16x32_bf16 v[48:51], a[4:7], a[44:47], v[48:51]
    v_fma_f32 v96, v64, v96, v2
    v_fma_f32 v97, v65, v97, v3
    ds_read_b128 v[72:75], v30 offset:2048
    ds_read2_b32 a[76:77], v17 offset0:240 offset1:241
    v_mfma_f32_16x16x32_bf16 v[52:55], a[8:11], a[44:47], v[52:55]
    v_fma_f32 v98, v66, v98, v4
    v_fma_f32 v99, v67, v99, v5
    ds_read_b128 v[6:9], v30 offset:10240
    ds_read2_b32 a[78:79], v17 offset0:242 offset1:243
    v_mfma_f32_16x16x32_bf16 v[44:47], a[12:15], a[32:35], v[44:47]
    s_waitcnt lgkmcnt(10)
    v_and_b32 v2, 0xffff0000, v13
    v_lshlrev_b32 v3, 16, v13
    ds_read_b128 a[112:115], v23 offset:8192
    v_mfma_f32_16x16x32_bf16 v[48:51], a[12:15], a[36:39], v[48:51]
    v_and_b32 v4, 0xffff0000, v12
    v_lshlrev_b32 v5, 16, v12
    ds_read2_b32 a[80:81], v18 offset0:112 offset1:113
    v_mfma_f32_16x16x32_bf16 v[52:55], a[12:15], a[40:43], v[52:55]
    v_fma_f32 v68, v2, v68, v24
    v_fma_f32 v69, v3, v69, v25
    ds_read2_b32 a[82:83], v18 offset0:114 offset1:115
    v_mfma_f32_16x16x32_bf16 v[56:59], a[12:15], a[44:47], v[56:59]
    v_fma_f32 v70, v4, v70, v26
    v_fma_f32 v71, v5, v71, v27
    ds_read_b64 v[12:13], v29 offset:22528
    ds_read_b128 a[116:119], v23 offset:10240
    v_mfma_f32_16x16x32_bf16 v[48:51], a[0:3], a[48:51], v[48:51]
    v_fma_f32 v100, v68, v100, v2
    v_fma_f32 v101, v69, v101, v3
    ds_read_b128 v[76:79], v30 offset:3072
    ds_read2_b32 a[84:85], v18 offset0:240 offset1:241
    v_mfma_f32_16x16x32_bf16 v[52:55], a[4:7], a[48:51], v[52:55]
    v_fma_f32 v102, v70, v102, v4
    v_fma_f32 v103, v71, v103, v5
    ds_read_b128 v[24:27], v30 offset:11264
    ds_read2_b32 a[86:87], v18 offset0:242 offset1:243
    v_mfma_f32_16x16x32_bf16 v[56:59], a[8:11], a[48:51], v[56:59]
    s_waitcnt lgkmcnt(10)
    v_and_b32 v2, 0xffff0000, v11
    v_lshlrev_b32 v3, 16, v11
    ds_read_b128 a[120:123], v23 offset:12288
    v_mfma_f32_16x16x32_bf16 v[60:63], a[12:15], a[48:51], v[60:63]
    v_and_b32 v4, 0xffff0000, v10
    v_lshlrev_b32 v5, 16, v10
    ds_read2_b32 a[88:89], v19 offset0:112 offset1:113
    v_mfma_f32_16x16x32_bf16 v[48:51], a[16:19], a[32:35], v[48:51]
    v_fma_f32 v72, v2, v72, v6
    v_fma_f32 v73, v3, v73, v7
    ds_read2_b32 a[90:91], v19 offset0:114 offset1:115
    v_mfma_f32_16x16x32_bf16 v[52:55], a[16:19], a[36:39], v[52:55]
    v_fma_f32 v74, v4, v74, v8
    v_fma_f32 v75, v5, v75, v9
    ds_read_b64 v[10:11], v29 offset:24576
    ds_read_b128 a[124:127], v23 offset:14336
    v_mfma_f32_16x16x32_bf16 v[56:59], a[16:19], a[40:43], v[56:59]
    v_fma_f32 v104, v72, v104, v2
    v_fma_f32 v105, v73, v105, v3
    ds_read_b128 v[80:83], v30 offset:4096
    ds_read2_b32 a[92:93], v19 offset0:240 offset1:241
    v_mfma_f32_16x16x32_bf16 v[60:63], a[16:19], a[44:47], v[60:63]
    v_fma_f32 v106, v74, v106, v4
    v_fma_f32 v107, v75, v107, v5
    ds_read_b128 v[6:9], v30 offset:12288
    ds_read2_b32 a[94:95], v19 offset0:242 offset1:243
    v_mfma_f32_16x16x32_bf16 v[52:55], a[0:3], a[52:55], v[52:55]
    s_waitcnt lgkmcnt(10)
    v_and_b32 v2, 0xffff0000, v13
    v_lshlrev_b32 v3, 16, v13
    v_mfma_f32_16x16x32_bf16 v[56:59], a[4:7], a[52:55], v[56:59]
    v_and_b32 v4, 0xffff0000, v12
    v_lshlrev_b32 v5, 16, v12
    v_mfma_f32_16x16x32_bf16 v[60:63], a[8:11], a[52:55], v[60:63]
    v_fma_f32 v76, v2, v76, v24
    v_fma_f32 v77, v3, v77, v25
    v_mfma_f32_16x16x32_bf16 v[52:55], a[20:23], a[32:35], v[52:55]
    v_fma_f32 v78, v4, v78, v26
    v_fma_f32 v79, v5, v79, v27
    ds_read_b64 v[12:13], v29 offset:26624
    v_mfma_f32_16x16x32_bf16 v[56:59], a[20:23], a[36:39], v[56:59]
    v_fma_f32 v108, v76, v108, v2
    v_fma_f32 v109, v77, v109, v3
    ds_read_b128 v[84:87], v30 offset:5120
    v_mfma_f32_16x16x32_bf16 v[60:63], a[20:23], a[40:43], v[60:63]
    v_fma_f32 v110, v78, v110, v4
    v_fma_f32 v111, v79, v111, v5
    ds_read_b128 v[24:27], v30 offset:13312
    v_mfma_f32_16x16x32_bf16 v[56:59], a[0:3], a[56:59], v[56:59]
    s_waitcnt lgkmcnt(4)
    v_and_b32 v2, 0xffff0000, v11
    v_lshlrev_b32 v3, 16, v11
    v_mfma_f32_16x16x32_bf16 v[60:63], a[4:7], a[56:59], v[60:63]
    v_and_b32 v4, 0xffff0000, v10
    v_lshlrev_b32 v5, 16, v10
    v_mfma_f32_16x16x32_bf16 v[56:59], a[24:27], a[32:35], v[56:59]
    v_fma_f32 v80, v2, v80, v6
    v_fma_f32 v81, v3, v81, v7
    v_mfma_f32_16x16x32_bf16 v[60:63], a[24:27], a[36:39], v[60:63]
    v_fma_f32 v82, v4, v82, v8
    v_fma_f32 v83, v5, v83, v9
    ds_read_b64 v[10:11], v29 offset:28672
    v_mfma_f32_16x16x32_bf16 v[60:63], a[0:3], a[60:63], v[60:63]
    v_fma_f32 v112, v80, v112, v2
    v_fma_f32 v113, v81, v113, v3
    ds_read_b128 v[88:91], v30 offset:6144
    v_mfma_f32_16x16x32_bf16 v[60:63], a[28:31], a[32:35], v[60:63]
    v_fma_f32 v114, v82, v114, v4
    v_fma_f32 v115, v83, v115, v5
    ds_read_b128 v[6:9], v30 offset:14336
    s_waitcnt lgkmcnt(0)
    v_mfma_f32_16x16x32_bf16 v[36:39], a[64:67], a[100:103], v[36:39]
    v_and_b32 v2, 0xffff0000, v13
    v_lshlrev_b32 v3, 16, v13
    v_mfma_f32_16x16x32_bf16 v[32:35], a[64:67], a[96:99], v[32:35]
    v_and_b32 v4, 0xffff0000, v12
    v_lshlrev_b32 v5, 16, v12
    v_mfma_f32_16x16x32_bf16 v[36:39], a[68:71], a[96:99], v[36:39]
    v_fma_f32 v84, v2, v84, v24
    v_fma_f32 v85, v3, v85, v25
    v_mfma_f32_16x16x32_bf16 v[44:47], a[64:67], a[108:111], v[44:47]
    v_fma_f32 v86, v4, v86, v26
    v_fma_f32 v87, v5, v87, v27
    ds_read_b64 v[12:13], v29 offset:30720
    v_mfma_f32_16x16x32_bf16 v[40:43], a[64:67], a[104:107], v[40:43]
    v_fma_f32 v116, v84, v116, v2
    v_fma_f32 v117, v85, v117, v3
    ds_read_b128 v[92:95], v30 offset:7168
    v_mfma_f32_16x16x32_bf16 v[44:47], a[68:71], a[104:107], v[44:47]
    v_fma_f32 v118, v86, v118, v4
    ds_read_b128 v[24:27], v30 offset:15360
    v_fma_f32 v96, v64, v32, v96
    v_fma_f32 v97, v65, v33, v97
    v_mfma_f32_16x16x32_bf16 v[40:43], a[68:71], a[100:103], v[40:43]
    v_fma_f32 v119, v87, v119, v5
    v_fma_f32 v98, v66, v34, v98
    v_fma_f32 v99, v67, v35, v99
    v_mfma_f32_16x16x32_bf16 v[44:47], a[72:75], a[100:103], v[44:47]
    v_and_b32 v2, 0xffff0000, v11
    v_cvt_pk_bf16_f32 v64, v96, v97
    v_cvt_pk_bf16_f32 v65, v98, v99
    v_mfma_f32_16x16x32_bf16 v[40:43], a[72:75], a[96:99], v[40:43]
    v_lshlrev_b32 v3, 16, v11
    ds_write_b64 v31, v[64:65] offset:0
    v_fma_f32 v100, v68, v36, v100
    v_mfma_f32_16x16x32_bf16 v[44:47], a[76:79], a[96:99], v[44:47]
    v_and_b32 v4, 0xffff0000, v10
    v_fma_f32 v101, v69, v37, v101
    v_fma_f32 v102, v70, v38, v102
    v_mfma_f32_16x16x32_bf16 v[52:55], a[64:67], a[116:119], v[52:55]
    v_lshlrev_b32 v5, 16, v10
    v_fma_f32 v103, v71, v39, v103
    v_cvt_pk_bf16_f32 v68, v100, v101
    v_mfma_f32_16x16x32_bf16 v[48:51], a[64:67], a[112:115], v[48:51]
    v_fma_f32 v88, v2, v88, v6
    v_cvt_pk_bf16_f32 v69, v102, v103
    ds_write_b64 v31, v[68:69] offset:2048
    v_mfma_f32_16x16x32_bf16 v[52:55], a[68:71], a[112:115], v[52:55]
    v_fma_f32 v89, v3, v89, v7
    v_fma_f32 v104, v72, v40, v104
    v_fma_f32 v105, v73, v41, v105
    v_mfma_f32_16x16x32_bf16 v[48:51], a[68:71], a[108:111], v[48:51]
    v_fma_f32 v90, v4, v90, v8
    v_fma_f32 v106, v74, v42, v106
    v_fma_f32 v107, v75, v43, v107
    v_mfma_f32_16x16x32_bf16 v[52:55], a[72:75], a[108:111], v[52:55]
    v_fma_f32 v91, v5, v91, v9
    v_cvt_pk_bf16_f32 v72, v104, v105
    v_cvt_pk_bf16_f32 v73, v106, v107
    v_mfma_f32_16x16x32_bf16 v[48:51], a[72:75], a[104:107], v[48:51]
    v_fma_f32 v120, v88, v120, v2
    ds_write_b64 v31, v[72:73] offset:4096
    v_fma_f32 v108, v76, v44, v108
    v_mfma_f32_16x16x32_bf16 v[52:55], a[76:79], a[104:107], v[52:55]
    v_fma_f32 v121, v89, v121, v3
    v_fma_f32 v109, v77, v45, v109
    v_fma_f32 v110, v78, v46, v110
    v_mfma_f32_16x16x32_bf16 v[48:51], a[76:79], a[100:103], v[48:51]
    v_fma_f32 v122, v90, v122, v4
    v_fma_f32 v111, v79, v47, v111
    v_cvt_pk_bf16_f32 v76, v108, v109
    v_mfma_f32_16x16x32_bf16 v[52:55], a[80:83], a[100:103], v[52:55]
    v_fma_f32 v123, v91, v123, v5
    v_cvt_pk_bf16_f32 v77, v110, v111
    ds_write_b64 v31, v[76:77] offset:6144
    v_mfma_f32_16x16x32_bf16 v[48:51], a[80:83], a[96:99], v[48:51]
    s_waitcnt lgkmcnt(4)
    v_and_b32 v2, 0xffff0000, v13
    v_lshlrev_b32 v3, 16, v13
    v_mfma_f32_16x16x32_bf16 v[52:55], a[84:87], a[96:99], v[52:55]
    v_and_b32 v4, 0xffff0000, v12
    v_lshlrev_b32 v5, 16, v12
    v_mfma_f32_16x16x32_bf16 v[60:63], a[64:67], a[124:127], v[60:63]
    v_fma_f32 v92, v2, v92, v24
    v_fma_f32 v93, v3, v93, v25
    v_mfma_f32_16x16x32_bf16 v[56:59], a[64:67], a[120:123], v[56:59]
    v_fma_f32 v94, v4, v94, v26
    v_fma_f32 v112, v80, v48, v112
    v_fma_f32 v113, v81, v49, v113
    v_mfma_f32_16x16x32_bf16 v[60:63], a[68:71], a[120:123], v[60:63]
    v_fma_f32 v95, v5, v95, v27
    v_fma_f32 v114, v82, v50, v114
    v_fma_f32 v115, v83, v51, v115
    v_mfma_f32_16x16x32_bf16 v[56:59], a[68:71], a[116:119], v[56:59]
    v_fma_f32 v124, v92, v124, v2
    v_cvt_pk_bf16_f32 v80, v112, v113
    v_cvt_pk_bf16_f32 v81, v114, v115
    v_mfma_f32_16x16x32_bf16 v[60:63], a[72:75], a[116:119], v[60:63]
    v_fma_f32 v125, v93, v125, v3
    ds_write_b64 v31, v[80:81] offset:8192
    v_fma_f32 v116, v84, v52, v116
    v_mfma_f32_16x16x32_bf16 v[56:59], a[72:75], a[112:115], v[56:59]
    v_fma_f32 v126, v94, v126, v4
    v_fma_f32 v117, v85, v53, v117
    v_fma_f32 v118, v86, v54, v118
    v_mfma_f32_16x16x32_bf16 v[60:63], a[76:79], a[112:115], v[60:63]
    v_fma_f32 v127, v95, v127, v5
    v_fma_f32 v119, v87, v55, v119
    v_cvt_pk_bf16_f32 v84, v116, v117
    v_mfma_f32_16x16x32_bf16 v[56:59], a[76:79], a[108:111], v[56:59]
    v_cvt_pk_bf16_f32 v85, v118, v119
    ds_write_b64 v31, v[84:85] offset:10240
    v_mfma_f32_16x16x32_bf16 v[60:63], a[80:83], a[108:111], v[60:63]
    s_waitcnt lgkmcnt(0)
    s_mov_b64 exec, 1
    ds_inc_u32 v1, v1 offset:40
    s_mov_b64 exec, -1
    v_mfma_f32_16x16x32_bf16 v[56:59], a[80:83], a[104:107], v[56:59]
    v_mfma_f32_16x16x32_bf16 v[60:63], a[84:87], a[104:107], v[60:63]
    ds_read_b32 v6, v1 offset:40
    v_mfma_f32_16x16x32_bf16 v[56:59], a[84:87], a[100:103], v[56:59]
    v_mfma_f32_16x16x32_bf16 v[60:63], a[88:91], a[100:103], v[60:63]
    s_waitcnt lgkmcnt(0)
    v_cmp_gt_u32 vcc, 4, v6
    s_nop 1
    s_cbranch_vccnz K_LM_S
K_LM_B:
    ds_read_b128 v[64:67], v15 offset:0
    ds_read_b128 v[68:71], v15 offset:4096
    ds_read_b128 v[72:75], v15 offset:8192
    v_mfma_f32_16x16x32_bf16 v[56:59], a[88:91], a[96:99], v[56:59]
    v_mfma_f32_16x16x32_bf16 v[60:63], a[92:95], a[96:99], v[60:63]
    s_waitcnt lgkmcnt(2)
    buffer_store_dwordx4 v[64:67], v14, s[20:23], s43 offen sc1
    s_add_u32 s43, s43, 655360
    s_waitcnt lgkmcnt(1)
    buffer_store_dwordx4 v[68:71], v14, s[20:23], s43 offen sc1
    s_add_u32 s43, s43, 655360
    s_waitcnt lgkmcnt(0)
    buffer_store_dwordx4 v[72:75], v14, s[20:23], s43 offen sc1
    s_add_u32 s43, s43, 655360
    v_fma_f32 v120, v88, v56, v120
    v_fma_f32 v121, v89, v57, v121
    v_fma_f32 v122, v90, v58, v122
    v_fma_f32 v123, v91, v59, v123
    v_cvt_pk_bf16_f32 v88, v120, v121
    v_cvt_pk_bf16_f32 v89, v122, v123
    ds_write_b64 v31, v[88:89] offset:12288
    v_fma_f32 v124, v92, v60, v124
    v_fma_f32 v125, v93, v61, v125
    v_fma_f32 v126, v94, v62, v126
    v_fma_f32 v127, v95, v63, v127
    v_cvt_pk_bf16_f32 v92, v124, v125
    v_cvt_pk_bf16_f32 v93, v126, v127
    ds_write_b64 v31, v[92:93] offset:14336
    s_waitcnt lgkmcnt(0)
    s_mov_b64 exec, 1
    ds_inc_u32 v1, v1 offset:40
    s_mov_b64 exec, -1
    s_mov_b32 s35, 0
K_LN:
    ds_read_b32 v4, v1 offset:40
    s_add_u32 s35, s35, 1
    s_cmp_gt_u32 s35, 256000
    s_cbranch_scc1 K_LN_X
    s_waitcnt lgkmcnt(0)
    v_cmp_gt_u32 vcc, 8, v4
    s_nop 1
    s_cbranch_vccnz K_LN
K_LN_X:
    s_waitcnt lgkmcnt(0)
    ds_read_b128 v[76:79], v15 offset:12288
    s_waitcnt lgkmcnt(0)
    buffer_store_dwordx4 v[76:79], v14, s[20:23], s43 offen sc1
    s_barrier
    s_branch K2_COMP
K_LX_S:
    s_mov_b32 s35, 0
K_LX_W:
    ds_read_b32 v4, v1 offset:28
    s_add_u32 s35, s35, 1
    s_cmp_gt_u32 s35, 256000
    s_cbranch_scc1 K_LX_W_X
    s_waitcnt lgkmcnt(0)
    v_cmp_gt_u32 vcc, 4, v4
    s_nop 1
    s_cbranch_vccnz K_LX_W
K_LX_W_X:
    s_waitcnt lgkmcnt(0)
    s_branch K_LX_B
K_LM_S:
    s_mov_b32 s35, 0
K_LM_W:
    ds_read_b32 v6, v1 offset:40
    s_add_u32 s35, s35, 1
    s_cmp_gt_u32 s35, 256000
    s_cbranch_scc1 K_LM_W_X
    s_waitcnt lgkmcnt(0)
    v_cmp_gt_u32 vcc, 4, v6
    s_nop 1
    s_cbranch_vccnz K_LM_W
K_LM_W_X:
    s_waitcnt lgkmcnt(0)
    s_branch K_LM_B
K_W4P:
    v_lshlrev_b32 v2, 4, v3
    s_mov_b32 s35, 0
K_HB:
    buffer_load_dwordx2 v[26:27], v12, s[48:51], s43 offen sc1
    s_add_u32 s35, s35, 1
    s_cmp_gt_u32 s35, 4000
    s_waitcnt vmcnt(0)
    s_cbranch_scc1 K_HB_X
K_HB_T:
    v_cmp_eq_u64 vcc, v[24:25], v[26:27]
    s_nop 1
    s_cbranch_vccz K_HB_X
    s_sleep 2
    s_branch K_HB
K_HB_X:
K_W4T:
    ds_write_b32 v20, v26 offset:8
    s_cmp_ge_u32 s94, 160
    s_cbranch_scc1 K_W4A
    s_bfe_u32 s41, s94, 0x40002
    s_lshl_b32 s41, s41, 4
    s_lshr_b32 s40, s94, 6
    s_add_u32 s41, s41, s40
    s_lshl_b32 s41, s41, 2
    s_and_b32 s40, s94, 3
    s_add_u32 s41, s41, s40
    s_lshl_b32 s41, s41, 2
    s_mov_b32 s35, 0
K_C1:
    ds_read_b32 v22, v20 offset:4
    s_add_u32 s35, s35, 1
    s_cmp_gt_u32 s35, 256000
    s_cbranch_scc1 K_C1_X
    s_waitcnt lgkmcnt(0)
    v_cmp_gt_u32 vcc, 4, v22
    s_nop 1
    s_cbranch_vccnz K_C1
K_C1_X:
    s_waitcnt lgkmcnt(0)
    s_mov_b64 exec, 1
    buffer_store_dword v26, v12, s[48:51], s41 offen sc1
    s_mov_b64 exec, -1
K_W4A:
    s_and_b32 s42, s2, 15
    s_lshl_b32 s42, s42, 8
    s_add_u32 s42, s42, 4096
    s_cmp_ge_u32 s94, 160
    s_cbranch_scc1 K_W4B
    s_mov_b32 s35, 0
K_D1:
    buffer_load_dwordx4 v[32:35], v12, s[48:51], s42 offen sc1
    s_add_u32 s35, s35, 1
    s_cmp_gt_u32 s35, 4000
    s_waitcnt vmcnt(0)
    s_cbranch_scc1 K_D1_X
K_D1_T:
    v_cmp_ne_u32 vcc, v26, v32
    s_nop 1
    s_cbranch_vccnz K_D1
K_D1_X:
    s_mov_b64 exec, 1
    ds_inc_u32 v20, v20 offset:12
    s_mov_b64 exec, -1
    s_mov_b32 s35, 0
    s_branch K_D2_T
K_D2:
    buffer_load_dwordx4 v[32:35], v12, s[48:51], s42 offen sc1
    s_add_u32 s35, s35, 1
    s_cmp_gt_u32 s35, 4000
    s_waitcnt vmcnt(0)
    s_cbranch_scc1 K_D2_X
K_D2_T:
    v_cmp_ne_u32 vcc, v26, v33
    s_nop 1
    s_cbranch_vccz K_D2_X
    s_sleep 1
    s_branch K_D2
K_D2_X:
    s_mov_b64 exec, 1
    ds_inc_u32 v20, v20 offset:24
    s_mov_b64 exec, -1
    s_branch K_H
K_W4B:
    s_cmp_lt_u32 s94, 244
    s_cbranch_scc1 K_W4C
    s_bfe_u32 s41, s94, 0x40002
    s_lshl_b32 s41, s41, 4
    s_lshr_b32 s40, s94, 6
    s_add_u32 s41, s41, s40
    s_lshl_b32 s41, s41, 2
    s_and_b32 s40, s94, 3
    s_add_u32 s41, s41, s40
    s_lshl_b32 s41, s41, 2
    s_mov_b64 exec, 1
    buffer_store_dword v26, v12, s[48:51], s41 offen offset:128 sc1
    s_mov_b64 exec, -1
K_W4C:
    s_lshr_b32 s34, s94, 1
    s_cmp_lg_u32 s34, 106
    s_cbranch_scc1 K_W4D
    s_bfe_u32 s41, s94, 0x40002
    s_lshl_b32 s41, s41, 4
    s_lshr_b32 s40, s94, 6
    s_add_u32 s41, s41, s40
    s_lshl_b32 s41, s41, 2
    s_and_b32 s40, s94, 3
    s_add_u32 s41, s41, s40
    s_lshl_b32 s41, s41, 2
    s_mov_b64 exec, 1
    s_add_u32 s40, s41, 12288
    s_cmp_ge_u32 s94, 212
    s_cselect_b32 s40, s40, 0x4000
    buffer_store_dword v26, v12, s[48:51], s40 offen sc1
    s_mov_b64 exec, -1
K_W4D:
    s_mov_b32 s35, 0
K_DH:
    buffer_load_dwordx4 v[32:35], v12, s[48:51], s42 offen sc1
    s_add_u32 s35, s35, 1
    s_cmp_gt_u32 s35, 4000
    s_waitcnt vmcnt(0)
    s_cbranch_scc1 K_DH_X
K_DH_T:
    v_cmp_ne_u32 vcc, v26, v33
    s_nop 1
    s_cbranch_vccz K_DH_X
    s_sleep 2
    s_branch K_DH
K_DH_X:
    s_mov_b64 exec, 1
    ds_inc_u32 v20, v20 offset:48
    s_mov_b64 exec, -1
    s_branch K_H
K_MASTP:
    v_lshlrev_b32 v2, 4, v3
    v_mov_b32 v26, s4
    s_branch K_W4T
K_X:
    v_lshlrev_b32 v2, 4, v3
    v_bfe_u32 v8, v0, 4, 2
    v_and_b32 v9, 15, v0
    v_lshlrev_b32 v10, 2, v8
    v_xor_b32 v9, v9, v10
    v_mul_u32_u24 v16, 80, v8
    v_add_lshl_u32 v16, v16, v9, 4
    v_xor_b32 v17, 32, v16
    s_lshl_b32 s58, s58, 4
    s_and_b32 s59, s59, 15
    s_or_b32 s58, s58, s59
    s_mul_i32 s33, s58, 20480
    s_mov_b32 s26, 0x280000
    s_mov_b32 s27, 0x20000
    s_add_u32 s48, s44, 0x530000
    s_addc_u32 s49, s45, 0
    s_mov_b32 s50, 0x4000
    s_mov_b32 s51, 0x20000
    s_mov_b32 s8, s44
    s_mov_b32 s9, s45
    s_mov_b32 s10, 0x500000
    s_mov_b32 s11, 0x20000
    s_add_u32 s16, s44, 0x500000
    s_addc_u32 s17, s45, 0
    s_mov_b32 s18, 0x4000
    s_mov_b32 s19, 0x20000
    s_add_u32 s12, s44, 0x600000
    s_addc_u32 s13, s45, 0
    s_mov_b32 s14, 0x280000
    s_mov_b32 s15, 0x20000
    v_mov_b32 v4, -1
    v_mov_b32 v5, -1
    v_mov_b32 v6, -1
    v_mov_b32 v7, -1
    s_cmp_ge_u32 s94, 128
    s_cbranch_scc1 K_XN
    s_sub_u32 s6, s3, 3
    s_cmp_eq_u32 s3, 5
    s_cselect_b32 s6, 0, s6
    s_lshl_b32 s29, s6, 12
    s_add_u32 s30, s29, 63488
    v_bfe_u32 v9, v3, 2, 2
    v_xor_b32 v9, 3, v9
    v_bfe_u32 v10, v3, 1, 1
    v_lshlrev_b32 v10, 3, v10
    v_lshl_add_u32 v10, v8, 4, v10
    v_mul_u32_u24 v9, 0x140, v9
    v_xor_b32 v10, v10, v9
    v_and_b32 v11, 1, v3
    v_mul_u32_u24 v11, 0x820, v11
    v_xor_b32 v10, v10, v11
    v_add_u32 v104, s30, v10
    v_xor_b32 v105, 64, v104
    v_xor_b32 v106, 128, v104
    v_xor_b32 v107, 192, v104
    s_add_u32 s29, s29, s33
    s_add_u32 s29, s29, 2621440
    s_lshl_b32 s6, s6, 8
    s_add_u32 s40, s33, s6
    s_add_u32 s41, s40, 5120
    s_add_u32 s42, s40, 10240
    s_add_u32 s43, s40, 15360
    s_sub_u32 s7, s3, 6
    s_lshl_b32 s32, s7, 9
    s_lshr_b32 s33, s58, 4
    s_lshl_b32 s33, s33, 10
    s_add_u32 s32, s32, s33
    s_and_b32 s33, s58, 15
    s_lshl_b32 s33, s33, 4
    s_add_u32 s32, s32, s33
    s_lshl_b32 s7, s7, 11
    s_add_u32 s7, s7, 63488
    v_add_u32 v24, s7, v2
    s_cmp_lg_u32 s3, 5
    s_cbranch_scc1 K_X6
    s_add_u32 m0, s30, 0
    s_nop 0
    buffer_load_dwordx4 v16, s[24:27], s40 offen offset:0 nt lds
    s_add_u32 m0, s30, 1024
    s_nop 0
    buffer_load_dwordx4 v16, s[24:27], s41 offen offset:0 nt lds
    s_add_u32 m0, s30, 2048
    s_nop 0
    buffer_load_dwordx4 v17, s[24:27], s42 offen offset:0 nt lds
    s_add_u32 m0, s30, 3072
    s_nop 0
    buffer_load_dwordx4 v17, s[24:27], s43 offen offset:0 nt lds
    s_add_u32 m0, s30, 3840
    s_nop 0
    buffer_load_dwordx4 v16, s[24:27], s40 offen offset:256 nt lds
    s_add_u32 m0, s30, 4864
    s_nop 0
    buffer_load_dwordx4 v16, s[24:27], s41 offen offset:256 nt lds
    s_add_u32 m0, s30, 5888
    s_nop 0
    buffer_load_dwordx4 v17, s[24:27], s42 offen offset:256 nt lds
    s_add_u32 m0, s30, 6912
    s_nop 0
    buffer_load_dwordx4 v17, s[24:27], s43 offen offset:256 nt lds
    s_add_u32 m0, s30, 7680
    s_nop 0
    buffer_load_dwordx4 v16, s[24:27], s40 offen offset:512 nt lds
    s_add_u32 m0, s30, 8704
    s_nop 0
    buffer_load_dwordx4 v16, s[24:27], s41 offen offset:512 nt lds
    s_add_u32 m0, s30, 9728
    s_nop 0
    buffer_load_dwordx4 v17, s[24:27], s42 offen offset:512 nt lds
    s_add_u32 m0, s30, 10752
    s_nop 0
    buffer_load_dwordx4 v17, s[24:27], s43 offen offset:512 nt lds
    s_waitcnt vmcnt(8)
    ds_read_b64_tr_b16 v[32:33], v104 offset:1024
    ds_read_b64_tr_b16 v[34:35], v104 offset:0
    ds_read_b64_tr_b16 v[36:37], v105 offset:1024
    ds_read_b64_tr_b16 v[38:39], v105 offset:0
    ds_read_b64_tr_b16 v[40:41], v106 offset:1024
    ds_read_b64_tr_b16 v[42:43], v106 offset:0
    ds_read_b64_tr_b16 v[44:45], v107 offset:1024
    ds_read_b64_tr_b16 v[46:47], v107 offset:0
    s_waitcnt lgkmcnt(6)
    buffer_store_dwordx4 v[32:35], v2, s[8:11], s29 offen offset:0 sc1
    s_waitcnt lgkmcnt(4)
    buffer_store_dwordx4 v[36:39], v2, s[8:11], s29 offen offset:1024 sc1
    s_waitcnt lgkmcnt(2)
    buffer_store_dwordx4 v[40:43], v2, s[8:11], s29 offen offset:2048 sc1
    s_waitcnt lgkmcnt(0)
    buffer_store_dwordx4 v[44:47], v2, s[8:11], s29 offen offset:3072 sc1
    s_add_u32 s29, s29, 4096
    s_waitcnt vmcnt(8)
    ds_read_b64_tr_b16 v[48:49], v104 offset:5120
    ds_read_b64_tr_b16 v[50:51], v104 offset:4096
    ds_read_b64_tr_b16 v[52:53], v105 offset:5120
    ds_read_b64_tr_b16 v[54:55], v105 offset:4096
    ds_read_b64_tr_b16 v[56:57], v106 offset:5120
    ds_read_b64_tr_b16 v[58:59], v106 offset:4096
    ds_read_b64_tr_b16 v[60:61], v107 offset:5120
    ds_read_b64_tr_b16 v[62:63], v107 offset:4096
    s_waitcnt lgkmcnt(6)
    buffer_store_dwordx4 v[48:51], v2, s[8:11], s29 offen offset:0 sc1
    s_waitcnt lgkmcnt(4)
    buffer_store_dwordx4 v[52:55], v2, s[8:11], s29 offen offset:1024 sc1
    s_waitcnt lgkmcnt(2)
    buffer_store_dwordx4 v[56:59], v2, s[8:11], s29 offen offset:2048 sc1
    s_waitcnt lgkmcnt(0)
    buffer_store_dwordx4 v[60:63], v2, s[8:11], s29 offen offset:3072 sc1
    s_add_u32 s29, s29, 4096
    s_waitcnt vmcnt(8)
    s_mov_b64 exec, 1
    ds_inc_u32 v20, v20 offset:44
    s_mov_b64 exec, -1
    ds_read_b64_tr_b16 v[64:65], v104 offset:9216
    ds_read_b64_tr_b16 v[66:67], v104 offset:8192
    ds_read_b64_tr_b16 v[68:69], v105 offset:9216
    ds_read_b64_tr_b16 v[70:71], v105 offset:8192
    ds_read_b64_tr_b16 v[72:73], v106 offset:9216
    ds_read_b64_tr_b16 v[74:75], v106 offset:8192
    ds_read_b64_tr_b16 v[76:77], v107 offset:9216
    ds_read_b64_tr_b16 v[78:79], v107 offset:8192
    s_waitcnt lgkmcnt(6)
    buffer_store_dwordx4 v[64:67], v2, s[8:11], s29 offen offset:0 sc1
    s_waitcnt lgkmcnt(4)
    buffer_store_dwordx4 v[68:71], v2, s[8:11], s29 offen offset:1024 sc1
    s_waitcnt lgkmcnt(2)
    buffer_store_dwordx4 v[72:75], v2, s[8:11], s29 offen offset:2048 sc1
    s_waitcnt lgkmcnt(0)
    buffer_store_dwordx4 v[76:79], v2, s[8:11], s29 offen offset:3072 sc1
    s_branch K_XE
K_X6:
    s_add_u32 m0, s30, 0
    s_nop 0
    buffer_load_dwordx4 v16, s[24:27], s40 offen offset:0 nt lds
    s_add_u32 m0, s30, 1024
    s_nop 0
    buffer_load_dwordx4 v16, s[24:27], s41 offen offset:0 nt lds
    s_add_u32 m0, s30, 2048
    s_nop 0
    buffer_load_dwordx4 v17, s[24:27], s42 offen offset:0 nt lds
    s_add_u32 m0, s30, 3072
    s_nop 0
    buffer_load_dwordx4 v17, s[24:27], s43 offen offset:0 nt lds
    s_mov_b32 s33, 0x3f803f80
    s_waitcnt vmcnt(0)
    s_mov_b64 exec, 1
    ds_inc_u32 v20, v20 offset:44
    s_mov_b64 exec, -1
    ds_read_b64_tr_b16 v[80:81], v104 offset:1024
    ds_read_b64_tr_b16 v[82:83], v104 offset:0
    ds_read_b64_tr_b16 v[84:85], v105 offset:1024
    ds_read_b64_tr_b16 v[86:87], v105 offset:0
    ds_read_b64_tr_b16 v[88:89], v106 offset:1024
    ds_read_b64_tr_b16 v[90:91], v106 offset:0
    ds_read_b64_tr_b16 v[92:93], v107 offset:1024
    ds_read_b64_tr_b16 v[94:95], v107 offset:0
    s_waitcnt lgkmcnt(6)
    buffer_store_dwordx4 v[80:83], v2, s[8:11], s29 offen offset:0 sc1
    s_waitcnt lgkmcnt(4)
    buffer_store_dwordx4 v[84:87], v2, s[8:11], s29 offen offset:1024 sc1
    s_waitcnt lgkmcnt(2)
    buffer_store_dwordx4 v[88:91], v2, s[8:11], s29 offen offset:2048 sc1
    s_waitcnt lgkmcnt(0)
    buffer_store_dwordx4 v[92:95], v2, s[8:11], s29 offen offset:3072 sc1
    s_mov_b32 s35, 0
K_XR:
    ds_read_b32 v22, v20 offset:44
    s_add_u32 s35, s35, 1
    s_cmp_gt_u32 s35, 256000
    s_cbranch_scc1 K_XR_X
    s_waitcnt lgkmcnt(0)
    v_cmp_gt_u32 vcc, 3, v22
    s_nop 1
    s_cbranch_vccnz K_XR
K_XR_X:
    s_waitcnt lgkmcnt(0)
    ds_read_b128 v[32:35], v24 offset:0
    ds_read_b128 v[36:39], v24 offset:4096
    ds_read_b128 v[40:43], v24 offset:8192
    ds_read_b128 v[44:47], v24 offset:12288
    ds_read_b128 v[48:51], v24 offset:16384
    ds_read_b128 v[52:55], v24 offset:1024
    ds_read_b128 v[56:59], v24 offset:5120
    ds_read_b128 v[60:63], v24 offset:9216
    ds_read_b128 v[64:67], v24 offset:13312
    ds_read_b128 v[68:71], v24 offset:17408
    s_waitcnt lgkmcnt(9)
    v_dot2_f32_bf16 v72, v32, s33, 0
    v_dot2_f32_bf16 v73, v32, v32, 0
    s_waitcnt lgkmcnt(4)
    v_dot2_f32_bf16 v74, v52, s33, 0
    v_dot2_f32_bf16 v75, v52, v52, 0
    v_dot2_f32_bf16 v72, v33, s33, v72
    v_dot2_f32_bf16 v73, v33, v33, v73
    v_dot2_f32_bf16 v74, v53, s33, v74
    v_dot2_f32_bf16 v75, v53, v53, v75
    v_dot2_f32_bf16 v72, v34, s33, v72
    v_dot2_f32_bf16 v73, v34, v34, v73
    v_dot2_f32_bf16 v74, v54, s33, v74
    v_dot2_f32_bf16 v75, v54, v54, v75
    v_dot2_f32_bf16 v72, v35, s33, v72
    v_dot2_f32_bf16 v73, v35, v35, v73
    v_dot2_f32_bf16 v74, v55, s33, v74
    v_dot2_f32_bf16 v75, v55, v55, v75
    s_waitcnt lgkmcnt(8)
    v_dot2_f32_bf16 v72, v36, s33, v72
    v_dot2_f32_bf16 v73, v36, v36, v73
    s_waitcnt lgkmcnt(3)
    v_dot2_f32_bf16 v74, v56, s33, v74
    v_dot2_f32_bf16 v75, v56, v56, v75
    v_dot2_f32_bf16 v72, v37, s33, v72
    v_dot2_f32_bf16 v73, v37, v37, v73
    v_dot2_f32_bf16 v74, v57, s33, v74
    v_dot2_f32_bf16 v75, v57, v57, v75
    v_dot2_f32_bf16 v72, v38, s33, v72
    v_dot2_f32_bf16 v73, v38, v38, v73
    v_dot2_f32_bf16 v74, v58, s33, v74
    v_dot2_f32_bf16 v75, v58, v58, v75
    v_dot2_f32_bf16 v72, v39, s33, v72
    v_dot2_f32_bf16 v73, v39, v39, v73
    v_dot2_f32_bf16 v74, v59, s33, v74
    v_dot2_f32_bf16 v75, v59, v59, v75
    s_waitcnt lgkmcnt(7)
    v_dot2_f32_bf16 v72, v40, s33, v72
    v_dot2_f32_bf16 v73, v40, v40, v73
    s_waitcnt lgkmcnt(2)
    v_dot2_f32_bf16 v74, v60, s33, v74
    v_dot2_f32_bf16 v75, v60, v60, v75
    v_dot2_f32_bf16 v72, v41, s33, v72
    v_dot2_f32_bf16 v73, v41, v41, v73
    v_dot2_f32_bf16 v74, v61, s33, v74
    v_dot2_f32_bf16 v75, v61, v61, v75
    v_dot2_f32_bf16 v72, v42, s33, v72
    v_dot2_f32_bf16 v73, v42, v42, v73
    v_dot2_f32_bf16 v74, v62, s33, v74
    v_dot2_f32_bf16 v75, v62, v62, v75
    v_dot2_f32_bf16 v72, v43, s33, v72
    v_dot2_f32_bf16 v73, v43, v43, v73
    v_dot2_f32_bf16 v74, v63, s33, v74
    v_dot2_f32_bf16 v75, v63, v63, v75
    s_waitcnt lgkmcnt(6)
    v_dot2_f32_bf16 v72, v44, s33, v72
    v_dot2_f32_bf16 v73, v44, v44, v73
    s_waitcnt lgkmcnt(1)
    v_dot2_f32_bf16 v74, v64, s33, v74
    v_dot2_f32_bf16 v75, v64, v64, v75
    v_dot2_f32_bf16 v72, v45, s33, v72
    v_dot2_f32_bf16 v73, v45, v45, v73
    v_dot2_f32_bf16 v74, v65, s33, v74
    v_dot2_f32_bf16 v75, v65, v65, v75
    v_dot2_f32_bf16 v72, v46, s33, v72
    v_dot2_f32_bf16 v73, v46, v46, v73
    v_dot2_f32_bf16 v74, v66, s33, v74
    v_dot2_f32_bf16 v75, v66, v66, v75
    v_dot2_f32_bf16 v72, v47, s33, v72
    v_dot2_f32_bf16 v73, v47, v47, v73
    v_dot2_f32_bf16 v74, v67, s33, v74
    v_dot2_f32_bf16 v75, v67, v67, v75
    s_waitcnt lgkmcnt(5)
    v_dot2_f32_bf16 v72, v48, s33, v72
    v_dot2_f32_bf16 v73, v48, v48, v73
    s_waitcnt lgkmcnt(0)
    v_dot2_f32_bf16 v74, v68, s33, v74
    v_dot2_f32_bf16 v75, v68, v68, v75
    v_dot2_f32_bf16 v72, v49, s33, v72
    v_dot2_f32_bf16 v73, v49, v49, v73
    v_dot2_f32_bf16 v74, v69, s33, v74
    v_dot2_f32_bf16 v75, v69, v69, v75
    v_dot2_f32_bf16 v72, v50, s33, v72
    v_dot2_f32_bf16 v73, v50, v50, v73
    v_dot2_f32_bf16 v74, v70, s33, v74
    v_dot2_f32_bf16 v75, v70, v70, v75
    v_dot2_f32_bf16 v72, v51, s33, v72
    v_dot2_f32_bf16 v73, v51, v51, v73
    v_dot2_f32_bf16 v74, v71, s33, v74
    v_dot2_f32_bf16 v75, v71, v71, v75
    v_add_f32_dpp v72, v72, v72 row_ror:8 row_mask:0xf bank_mask:0xf
    v_add_f32_dpp v73, v73, v73 row_ror:8 row_mask:0xf bank_mask:0xf
    v_add_f32_dpp v74, v74, v74 row_ror:8 row_mask:0xf bank_mask:0xf
    v_add_f32_dpp v75, v75, v75 row_ror:8 row_mask:0xf bank_mask:0xf
    v_add_f32_dpp v72, v72, v72 row_ror:4 row_mask:0xf bank_mask:0xf
    v_add_f32_dpp v73, v73, v73 row_ror:4 row_mask:0xf bank_mask:0xf
    v_add_f32_dpp v74, v74, v74 row_ror:4 row_mask:0xf bank_mask:0xf
    v_add_f32_dpp v75, v75, v75 row_ror:4 row_mask:0xf bank_mask:0xf
    v_add_f32_dpp v72, v72, v72 row_ror:2 row_mask:0xf bank_mask:0xf
    v_add_f32_dpp v73, v73, v73 row_ror:2 row_mask:0xf bank_mask:0xf
    v_add_f32_dpp v74, v74, v74 row_ror:2 row_mask:0xf bank_mask:0xf
    v_add_f32_dpp v75, v75, v75 row_ror:2 row_mask:0xf bank_mask:0xf
    v_add_f32_dpp v72, v72, v72 row_ror:1 row_mask:0xf bank_mask:0xf
    v_add_f32_dpp v73, v73, v73 row_ror:1 row_mask:0xf bank_mask:0xf
    v_add_f32_dpp v74, v74, v74 row_ror:1 row_mask:0xf bank_mask:0xf
    v_add_f32_dpp v75, v75, v75 row_ror:1 row_mask:0xf bank_mask:0xf
    v_and_b32 v9, 1, v3
    v_cmp_eq_u32 vcc, 1, v9
    s_nop 1
    v_cndmask_b32 v72, v72, v74, vcc
    v_cndmask_b32 v73, v73, v75, vcc
    v_mul_f32 v76, 0x3acccccd, v72
    v_mul_f32 v73, 0x3acccccd, v73
    v_fma_f32 v73, -v76, v76, v73
    v_max_f32 v73, 0, v73
    v_cvt_pk_bf16_f32 v74, v76, v76
    v_and_b32 v74, 0xffff0000, v74
    v_cvt_pk_bf16_f32 v73, v73, v73
    v_and_b32 v73, 0xffff0000, v73
    v_add_f32 v73, 0x3727c5ac, v73
    v_cvt_pk_bf16_f32 v73, v73, v73
    v_and_b32 v73, 0xffff0000, v73
    v_sqrt_f32 v73, v73
    s_nop 0
    v_cvt_pk_bf16_f32 v73, v73, v73
    v_and_b32 v73, 0xffff0000, v73
    v_rcp_f32 v75, v73
    s_nop 0
    v_mul_f32 v74, v74, v75
    v_sub_f32 v74, 0, v74
    v_lshlrev_b32 v77, 2, v8
    v_lshl_add_u32 v77, v9, 8, v77
    s_mov_b32 exec_lo, 0x30003
    s_mov_b32 exec_hi, 0x30003
    buffer_store_dword v75, v77, s[16:19], s32 offen sc1
    s_add_u32 s32, s32, 8192
    buffer_store_dword v74, v77, s[16:19], s32 offen sc1
    s_mov_b64 exec, -1
K_XE:
    s_waitcnt vmcnt(0)
    s_mov_b64 exec, 1
    ds_inc_rtn_u32 v22, v20, v20 offset:20
    s_mov_b64 exec, -1
    s_waitcnt lgkmcnt(0)
    v_readfirstlane_b32 s42, v22
    s_nop 1
    s_cmp_lg_u32 s42, 2
    s_cbranch_scc1 K_XF
    s_mov_b32 s35, 0
K_XF_OK:
    ds_read_b32 v22, v20 offset:8
    s_add_u32 s35, s35, 1
    s_cmp_gt_u32 s35, 256000
    s_cbranch_scc1 K_XF_OK_X
    s_waitcnt lgkmcnt(0)
    v_cmp_gt_u32 vcc, 1, v22
    s_nop 1
    s_cbranch_vccnz K_XF_OK
K_XF_OK_X:
    s_waitcnt lgkmcnt(0)
    s_bfe_u32 s41, s94, 0x40002
    s_lshl_b32 s41, s41, 4
    s_lshr_b32 s40, s94, 6
    s_add_u32 s41, s41, s40
    s_lshl_b32 s41, s41, 2
    s_and_b32 s40, s94, 3
    s_add_u32 s41, s41, s40
    s_lshl_b32 s41, s41, 2
    s_mov_b64 exec, 1
    buffer_store_dword v22, v12, s[48:51], s41 offen offset:64 sc1
    s_mov_b64 exec, -1
K_XF:
    s_branch K_XG
K_XN:
    s_cmp_ge_u32 s94, 160
    s_cbranch_scc1 K_H
    s_mov_b32 s35, 0
K_XO:
    ds_read_b32 v22, v20 offset:8
    s_add_u32 s35, s35, 1
    s_cmp_gt_u32 s35, 256000
    s_cbranch_scc1 K_XO_X
    s_waitcnt lgkmcnt(0)
    v_cmp_gt_u32 vcc, 1, v22
    s_nop 1
    s_cbranch_vccz K_XO_X
    s_sleep 1
    s_branch K_XO
K_XO_X:
    s_waitcnt lgkmcnt(0)
K_XG:
    v_lshrrev_b32 v13, 3, v3
    v_mul_u32_u24 v14, 20480, v13
    v_and_b32 v13, 7, v3
    v_lshl_add_u32 v14, v13, 4, v14
    s_sub_u32 s38, s3, 5
    s_mul_i32 s38, s38, 163840
    s_lshl_b32 s39, s94, 7
    s_add_u32 s38, s38, s39
    buffer_store_dwordx4 v[4:7], v14, s[12:15], s38 offen sc1
    s_add_u32 s38, s38, 491520
    buffer_store_dwordx4 v[4:7], v14, s[12:15], s38 offen sc1
    s_add_u32 s38, s38, 491520
    buffer_store_dwordx4 v[4:7], v14, s[12:15], s38 offen sc1
    s_add_u32 s38, s38, 491520
    buffer_store_dwordx4 v[4:7], v14, s[12:15], s38 offen sc1
    s_add_u32 s38, s38, 491520
    buffer_store_dwordx4 v[4:7], v14, s[12:15], s38 offen sc1
    s_add_u32 s38, s38, 491520
    buffer_store_dwordx4 v[4:7], v14, s[12:15], s38 offen sc1
    s_waitcnt vmcnt(0)
K_XI:
    s_mov_b64 exec, 1
    ds_inc_rtn_u32 v22, v20, v20 offset:32
    s_mov_b64 exec, -1
    s_waitcnt lgkmcnt(0)
    v_readfirstlane_b32 s42, v22
    s_nop 1
    s_cmp_lg_u32 s42, 2
    s_cbranch_scc1 K_XH
    s_mov_b32 s35, 0
K_XH_OK:
    ds_read_b32 v22, v20 offset:8
    s_add_u32 s35, s35, 1
    s_cmp_gt_u32 s35, 256000
    s_cbranch_scc1 K_XH_OK_X
    s_waitcnt lgkmcnt(0)
    v_cmp_gt_u32 vcc, 1, v22
    s_nop 1
    s_cbranch_vccnz K_XH_OK
K_XH_OK_X:
    s_waitcnt lgkmcnt(0)
    s_bfe_u32 s41, s94, 0x40002
    s_lshl_b32 s41, s41, 4
    s_lshr_b32 s40, s94, 6
    s_add_u32 s41, s41, s40
    s_lshl_b32 s41, s41, 2
    s_and_b32 s40, s94, 3
    s_add_u32 s41, s41, s40
    s_lshl_b32 s41, s41, 2
    s_mov_b64 exec, 1
    buffer_store_dword v22, v12, s[48:51], s41 offen offset:128 sc1
    s_mov_b64 exec, -1
K_XH:
K_XJ:
    s_mov_b32 s35, 0
K_G2:
    ds_read_b32 v22, v20 offset:24
    s_add_u32 s35, s35, 1
    s_cmp_gt_u32 s35, 256000
    s_cbranch_scc1 K_G2_X
    s_waitcnt lgkmcnt(0)
    v_cmp_gt_u32 vcc, 1, v22
    s_nop 1
    s_cbranch_vccz K_G2_X
    s_sleep 1
    s_branch K_G2
K_G2_X:
    s_waitcnt lgkmcnt(0)
K_H:
    s_sub_u32 s7, s3, 4
    s_add_u32 s16, s44, 0x500000
    s_addc_u32 s17, s45, 0
    s_mov_b32 s18, 0x4000
    s_mov_b32 s19, 0x20000
    s_add_u32 s20, s44, 0x1100000
    s_addc_u32 s21, s45, 0
    s_mov_b32 s22, 0x6c0000
    s_mov_b32 s23, 0x20000
    s_mov_b32 s8, s44
    s_mov_b32 s9, s45
    s_mov_b32 s10, 0x500000
    s_mov_b32 s11, 0x20000
    v_mov_b32 v28, -1
    v_mov_b32 v29, -1
    v_mov_b32 v30, -1
    v_mov_b32 v31, -1
    s_cmp_ge_u32 s94, 160
    s_cbranch_scc1 K_HF
    v_lshrrev_b32 v6, 4, v3
    v_bfe_u32 v7, v3, 2, 1
    v_lshl_add_u32 v7, v6, 1, v7
    v_mul_u32_u24 v7, 20480, v7
    v_bfe_u32 v8, v3, 3, 1
    v_lshl_add_u32 v7, v8, 6, v7
    v_xor_b32 v8, v6, v3
    v_and_b32 v8, 3, v8
    v_lshl_add_u32 v7, v8, 4, v7
    s_lshl_b32 s31, s94, 7
    s_mul_i32 s32, s7, 163840
    s_add_u32 s31, s31, s32
    s_add_u32 s31, s31, 2621440
    s_lshl_b32 s33, s7, 10
    s_add_u32 s33, s33, 63488
    s_mov_b32 m0, s33
    s_add_u32 s33, s33, 4096
    buffer_load_dwordx4 v7, s[8:11], s31 offen sc1 lds
    s_add_u32 s31, s31, 655360
    s_mov_b32 m0, s33
    s_add_u32 s33, s33, 4096
    buffer_load_dwordx4 v7, s[8:11], s31 offen sc1 lds
    s_add_u32 s31, s31, 655360
    s_mov_b32 m0, s33
    s_add_u32 s33, s33, 4096
    buffer_load_dwordx4 v7, s[8:11], s31 offen sc1 lds
    s_add_u32 s31, s31, 655360
    s_mov_b32 m0, s33
    s_nop 0
    buffer_load_dwordx4 v7, s[8:11], s31 offen sc1 lds
    s_lshl_b32 s34, s7, 12
    s_add_u32 m0, s34, 79872
    s_nop 0
    buffer_load_dwordx4 v2, s[16:19], s34 offen offset:0 sc1 lds
    buffer_load_dwordx4 v2, s[16:19], s34 offen offset:1024 sc1 lds
    buffer_load_dwordx4 v2, s[16:19], s34 offen offset:2048 sc1 lds
    buffer_load_dwordx4 v2, s[16:19], s34 offen offset:3072 sc1 lds
    s_branch K_HN
K_HF:
    s_mov_b32 s35, 0
K_HG:
    ds_read_b32 v22, v20 offset:48
    s_add_u32 s35, s35, 1
    s_cmp_gt_u32 s35, 256000
    s_cbranch_scc1 K_HG_X
    s_waitcnt lgkmcnt(0)
    v_cmp_gt_u32 vcc, 1, v22
    s_nop 1
    s_cbranch_vccz K_HG_X
    s_sleep 1
    s_branch K_HG
K_HG_X:
    s_waitcnt lgkmcnt(0)
    s_cmp_lt_u32 s94, 244
    s_cselect_b32 s34, 4, 0
    s_mov_b32 s35, 0
K_HO:
    ds_read_b32 v22, v20 offset:32
    s_add_u32 s35, s35, 1
    s_cmp_gt_u32 s35, 256000
    s_cbranch_scc1 K_HO_X
    s_waitcnt lgkmcnt(0)
    v_cmp_gt_u32 vcc, s34, v22
    s_nop 1
    s_cbranch_vccz K_HO_X
    s_sleep 1
    s_branch K_HO
K_HO_X:
    s_waitcnt lgkmcnt(0)
    s_add_u32 s16, s44, 0x504000
    s_addc_u32 s17, s45, 0
    s_mov_b32 s18, 0x2000
    s_mov_b32 s19, 0x20000
    s_sub_u32 s42, s94, 160
    s_lshl_b32 s42, s42, 2
    s_add_u32 s42, s42, s7
    s_lshl_b32 s43, s42, 10
    s_mul_i32 s42, s42, 18432
    buffer_store_dwordx4 v[28:31], v2, s[20:23], s42 offen offset:0 sc1
    buffer_store_dwordx4 v[28:31], v2, s[20:23], s42 offen offset:1024 sc1
    buffer_store_dwordx4 v[28:31], v2, s[20:23], s42 offen offset:2048 sc1
    buffer_store_dwordx4 v[28:31], v2, s[20:23], s42 offen offset:3072 sc1
    s_add_u32 s42, s42, 4096
    buffer_store_dwordx4 v[28:31], v2, s[20:23], s42 offen offset:0 sc1
    buffer_store_dwordx4 v[28:31], v2, s[20:23], s42 offen offset:1024 sc1
    buffer_store_dwordx4 v[28:31], v2, s[20:23], s42 offen offset:2048 sc1
    buffer_store_dwordx4 v[28:31], v2, s[20:23], s42 offen offset:3072 sc1
    s_add_u32 s42, s42, 4096
    buffer_store_dwordx4 v[28:31], v2, s[20:23], s42 offen offset:0 sc1
    buffer_store_dwordx4 v[28:31], v2, s[20:23], s42 offen offset:1024 sc1
    buffer_store_dwordx4 v[28:31], v2, s[20:23], s42 offen offset:2048 sc1
    buffer_store_dwordx4 v[28:31], v2, s[20:23], s42 offen offset:3072 sc1
    s_add_u32 s42, s42, 4096
    buffer_store_dwordx4 v[28:31], v2, s[20:23], s42 offen offset:0 sc1
    buffer_store_dwordx4 v[28:31], v2, s[20:23], s42 offen offset:1024 sc1
    buffer_store_dwordx4 v[28:31], v2, s[20:23], s42 offen offset:2048 sc1
    buffer_store_dwordx4 v[28:31], v2, s[20:23], s42 offen offset:3072 sc1
    s_add_u32 s42, s42, 4096
    buffer_store_dwordx4 v[28:31], v2, s[20:23], s42 offen offset:0 sc1
    buffer_store_dwordx4 v[28:31], v2, s[20:23], s42 offen offset:1024 sc1
    buffer_store_dwordx4 v[28:31], v2, s[16:19], s43 offen sc1
K_HN:
    s_add_u32 s16, s44, 0x504000
    s_addc_u32 s17, s45, 0
    s_mov_b32 s18, 0x2000
    s_mov_b32 s19, 0x20000
    s_and_b32 s4, s2, 1
    s_lshl_b32 s4, s4, 3
    s_bfe_u32 s5, s2, 0x30003
    s_add_u32 s4, s4, s5
    s_bfe_u32 s5, s2, 0x20001
    s_lshl_b32 s5, s5, 2
    s_lshr_b32 s6, s2, 6
    s_add_u32 s5, s5, s6
    s_lshl_b32 s28, s4, 3
    s_lshl_b32 s6, s7, 1
    s_add_u32 s28, s28, s6
    s_mul_i32 s28, s28, 20480
    s_add_u32 s29, s28, 19456
    s_lshl_b32 s32, s7, 11
    s_mul_i32 s6, s7, 3
    s_min_u32 s33, s7, 2
    s_add_u32 s6, s6, s33
    s_lshr_b32 s33, s7, 1
    s_add_u32 s33, s33, 2
    s_and_b32 s34, s7, 1
    s_mul_i32 s33, s33, s34
    s_cmp_eq_u32 s5, 15
    s_cselect_b32 s6, s33, s6
    s_lshl_b32 s6, s6, 10
    s_mul_i32 s30, s5, 286720
    s_add_u32 s30, s30, s6
    s_add_u32 s33, s6, 8192
    s_add_u32 s8, s44, 0x600000
    s_addc_u32 s9, s45, 0
    s_mov_b32 s10, 0x280000
    s_mov_b32 s11, 0x20000
    s_add_u32 s12, s44, 0x900000
    s_addc_u32 s13, s45, 0
    s_mov_b32 s14, 0x460000
    s_mov_b32 s15, 0x20000
    s_and_b32 s56, s2, 7
    s_lshl_b32 s56, s56, 2
    s_bfe_u32 s57, s2, 0x20003
    s_add_u32 s56, s56, s57
    s_lshr_b32 s57, s2, 5
    s_mul_i32 s37, s7, 14
    s_cmp_eq_u32 s7, 3
    s_subb_u32 s37, s37, 0
    s_lshr_b32 s34, s7, 1
    s_sub_u32 s59, s37, s34
    s_add_u32 s59, s59, 8
    s_mul_i32 s34, s57, 54
    s_add_u32 s36, s34, s59
    s_mul_i32 s36, s36, 5120
    s_add_u32 s37, s34, s37
    s_mul_i32 s37, s37, 5120
    s_mul_i32 s38, s7, 12288
    s_add_u32 s38, s38, 112640
    s_mul_i32 s39, s7, 5120
    s_mul_i32 s58, s7, 3072
    s_add_u32 s58, s58, 22528
    s_mul_i32 s40, s56, 54
    s_add_u32 s40, s40, s59
    s_lshl_b32 s40, s40, 12
    s_add_u32 s24, s44, 0xe00000
    s_addc_u32 s25, s45, 0
    s_mov_b32 s26, 0x21c000
    s_mov_b32 s27, 0x20000
    s_mov_b32 s52, s46
    s_mov_b32 s53, s47
    s_mov_b32 s54, 0x280000
    s_mov_b32 s55, 0x20000
    s_lshl_b32 s34, s7, 2
    s_add_u32 s34, s34, 161792
    v_mov_b32 v1, s34
    ds_write_b32 v1, v12
    ds_write_b32 v1, v12 offset:16
    ds_write_b32 v1, v12 offset:32
    v_add_u32 v113, 0x10000, v2
    v_add_u32 v114, 0x20000, v2
    v_add_u32 v8, s32, v2
    v_add_u32 v9, 67584, v8
    s_cmp_lg_u32 s3, 4
    s_cbranch_scc1 K_HA0
    s_and_b32 s42, s2, 15
    s_lshl_b32 s42, s42, 8
    s_add_u32 s42, s42, 4096
    buffer_load_dwordx4 v[32:35], v12, s[48:51], s42 offen sc1
K_HA0:
    s_cmp_ge_u32 s94, 160
    s_cbranch_scc1 K_HA1
    s_waitcnt vmcnt(0)
    s_mov_b64 exec, 1
    ds_inc_u32 v20, v20 offset:28
    s_mov_b64 exec, -1
K_HA1:
    s_cmp_lg_u32 s3, 4
    s_cbranch_scc1 K_HA
    s_waitcnt vmcnt(0)
    s_mov_b32 s35, 0
    s_branch K_DA_T
K_DA:
    buffer_load_dwordx4 v[32:35], v12, s[48:51], s42 offen sc1
    s_add_u32 s35, s35, 1
    s_cmp_gt_u32 s35, 4000
    s_waitcnt vmcnt(0)
    s_cbranch_scc1 K_DA_X
K_DA_T:
    v_cmp_ne_u32 vcc, v26, v35
    s_nop 1
    s_cbranch_vccz K_DA_X
    s_sleep 2
    s_branch K_DA
K_DA_X:
    s_mov_b64 exec, 1
    ds_inc_u32 v20, v20 offset:56
    s_mov_b64 exec, -1
K_HA:
    s_mov_b32 s35, 0
K_GA:
    ds_read_b32 v22, v20 offset:56
    s_add_u32 s35, s35, 1
    s_cmp_gt_u32 s35, 256000
    s_cbranch_scc1 K_GA_X
    s_waitcnt lgkmcnt(0)
    v_cmp_gt_u32 vcc, 1, v22
    s_nop 1
    s_cbranch_vccz K_GA_X
    s_sleep 1
    s_branch K_GA
K_GA_X:
    s_waitcnt lgkmcnt(0)
    buffer_load_dwordx4 v[56:59], v2, s[24:27], s36 offen offset:0 sc1
    buffer_load_dwordx4 v[60:63], v2, s[24:27], s36 offen offset:1024 sc1
    buffer_load_dwordx4 v[64:67], v2, s[24:27], s36 offen offset:2048 sc1
    buffer_load_dwordx4 v[68:71], v2, s[24:27], s36 offen offset:3072 sc1
    s_add_u32 s36, s36, 4096
    buffer_load_dwordx4 v[72:75], v2, s[24:27], s36 offen offset:0 sc1
    buffer_load_dwordx4 v[76:79], v2, s[24:27], s36 offen offset:1024 sc1
    buffer_load_dwordx4 v[80:83], v2, s[24:27], s36 offen offset:2048 sc1
    buffer_load_dwordx4 v[84:87], v2, s[24:27], s36 offen offset:3072 sc1
    s_add_u32 s36, s36, 4096
    buffer_load_dwordx4 v[88:91], v2, s[24:27], s36 offen offset:0 sc1
    buffer_load_dwordx4 v[92:95], v2, s[24:27], s36 offen offset:1024 sc1
    buffer_load_dwordx4 v[96:99], v2, s[24:27], s36 offen offset:2048 sc1
    buffer_load_dwordx4 v[100:103], v2, s[24:27], s36 offen offset:3072 sc1
    s_add_u32 s36, s36, 4096
    buffer_load_dwordx4 v[104:107], v2, s[24:27], s36 offen offset:0 sc1
    buffer_load_dwordx4 v[108:111], v2, s[24:27], s36 offen offset:1024 sc1
    buffer_load_dwordx4 v[116:119], v2, s[24:27], s36 offen offset:2048 sc1
    buffer_load_dwordx4 v[120:123], v2, s[24:27], s36 offen offset:3072 sc1
    s_add_u32 s36, s36, 4096
    buffer_load_dwordx4 v[124:127], v2, s[24:27], s36 offen offset:0 sc1
    buffer_load_dwordx4 a[80:83], v2, s[24:27], s36 offen offset:1024 sc1
    buffer_load_dwordx4 a[84:87], v2, s[24:27], s36 offen offset:2048 sc1
    buffer_load_dwordx4 a[88:91], v2, s[24:27], s36 offen offset:3072 sc1
    s_add_u32 s36, s36, 4096
    buffer_load_dwordx4 a[92:95], v2, s[24:27], s36 offen offset:0 sc1
    buffer_load_dwordx4 a[96:99], v2, s[24:27], s36 offen offset:1024 sc1
    buffer_load_dwordx4 a[100:103], v2, s[24:27], s36 offen offset:2048 sc1
    buffer_load_dwordx4 a[104:107], v2, s[24:27], s36 offen offset:3072 sc1
    s_add_u32 s36, s36, 4096
    buffer_load_dwordx4 a[108:111], v2, s[24:27], s36 offen offset:0 sc1
    buffer_load_dwordx4 a[112:115], v2, s[24:27], s36 offen offset:1024 sc1
    buffer_load_dwordx4 a[116:119], v2, s[24:27], s36 offen offset:2048 sc1
    buffer_load_dwordx4 a[120:123], v2, s[24:27], s36 offen offset:3072 sc1
    s_add_u32 s36, s36, 4096
    buffer_load_dwordx4 a[124:127], v2, s[24:27], s36 offen offset:0 sc1
    s_cmp_lg_u32 s3, 4
    s_cbranch_scc1 K_H3
    s_and_b32 s42, s2, 15
    s_lshl_b32 s42, s42, 8
    s_add_u32 s42, s42, 4096
    s_mov_b32 s35, 0
K_D3:
    buffer_load_dwordx4 v[32:35], v12, s[48:51], s42 offen sc1
    s_add_u32 s35, s35, 1
    s_cmp_gt_u32 s35, 4000
    s_waitcnt vmcnt(0)
    s_cbranch_scc1 K_D3_X
K_D3_T:
    v_cmp_ne_u32 vcc, v26, v34
    s_nop 1
    s_cbranch_vccz K_D3_X
    s_sleep 2
    s_branch K_D3
K_D3_X:
    s_mov_b64 exec, 1
    ds_inc_u32 v20, v20 offset:36
    s_mov_b64 exec, -1
K_H3:
    s_mov_b32 s35, 0
K_G3:
    ds_read_b32 v22, v20 offset:36
    s_add_u32 s35, s35, 1
    s_cmp_gt_u32 s35, 256000
    s_cbranch_scc1 K_G3_X
    s_waitcnt lgkmcnt(0)
    v_cmp_gt_u32 vcc, 1, v22
    s_nop 1
    s_cbranch_vccz K_G3_X
    s_sleep 1
    s_branch K_G3
K_G3_X:
    s_waitcnt lgkmcnt(0)
    ds_read_b32 v26, v20 offset:8
    ds_read_b32 v27, v20 offset:8
    s_mov_b32 s43, s40
    s_bfe_u32 s41, s94, 0x40002
    s_lshl_b32 s41, s41, 4
    s_lshr_b32 s40, s94, 6
    s_add_u32 s41, s41, s40
    s_lshl_b32 s41, s41, 2
    s_and_b32 s40, s94, 3
    s_add_u32 s41, s41, s40
    s_lshl_b32 s41, s41, 2
    s_mov_b32 s40, s43
    s_cmp_eq_u32 s7, 0
    s_cselect_b32 s41, s41, 0x4000
    s_cmp_ge_u32 s94, 160
    s_cselect_b32 s41, s41, 0x4000
    v_and_b32 v21, 15, v3
    v_lshlrev_b32 v21, 8, v21
    v_lshrrev_b32 v22, 4, v3
    v_lshl_add_u32 v21, v22, 4, v21
    v_lshlrev_b32 v24, 7, v3
    s_bfe_u32 s42, s2, 0x30003
    s_lshl_b32 s42, s42, 2
    s_add_u32 s42, s42, s7
    s_mul_i32 s42, s42, 8064
    s_mul_i32 s43, s5, 286720
    s_add_u32 s42, s42, s43
    s_add_u32 s42, s42, 28672
    s_and_b32 s43, s56, 3
    s_mul_i32 s43, s43, 10240
    s_add_u32 s43, s43, s37
    s_cmp_ge_u32 s7, 2
    s_cbranch_scc1 K2_LOAD3
    s_add_u32 m0, s33, 0
    s_nop 0
    buffer_load_dwordx4 v2, s[12:15], s30 offen offset:0 sc1 lds
    buffer_load_dwordx4 v2, s[12:15], s30 offen offset:1024 sc1 lds
    buffer_load_dwordx4 v2, s[12:15], s30 offen offset:2048 sc1 lds
    buffer_load_dwordx4 v2, s[12:15], s30 offen offset:3072 sc1 lds
    s_add_u32 s30, s30, 14336
    s_add_u32 m0, s33, 22528
    s_nop 0
    buffer_load_dwordx4 v2, s[12:15], s30 offen offset:0 sc1 lds
    buffer_load_dwordx4 v2, s[12:15], s30 offen offset:1024 sc1 lds
    buffer_load_dwordx4 v2, s[12:15], s30 offen offset:2048 sc1 lds
    buffer_load_dwordx4 v2, s[12:15], s30 offen offset:3072 sc1 lds
    s_add_u32 s30, s30, 14336
    s_barrier
    s_add_u32 m0, s33, 45056
    s_nop 0
    buffer_load_dwordx4 v2, s[12:15], s30 offen offset:0 sc1 lds
    buffer_load_dwordx4 v2, s[12:15], s30 offen offset:1024 sc1 lds
    buffer_load_dwordx4 v2, s[12:15], s30 offen offset:2048 sc1 lds
    buffer_load_dwordx4 v2, s[12:15], s30 offen offset:3072 sc1 lds
    s_add_u32 s30, s30, 14336
    s_add_u32 m0, s32, 0
    s_nop 0
    buffer_load_dwordx4 v2, s[8:11], s28 offen sc1 lds
    buffer_load_dwordx4 v2, s[8:11], s29 offen offset:1024 sc1 lds
    s_add_u32 s28, s28, 1024
    s_add_u32 s29, s29, 1024
    s_add_u32 m0, s32, 22528
    s_nop 0
    buffer_load_dwordx4 v2, s[8:11], s28 offen sc1 lds
    buffer_load_dwordx4 v2, s[8:11], s29 offen offset:1024 sc1 lds
    s_add_u32 s28, s28, 1024
    s_add_u32 s29, s29, 1024
    s_add_u32 m0, s32, 45056
    s_nop 0
    buffer_load_dwordx4 v2, s[8:11], s28 offen sc1 lds
    buffer_load_dwordx4 v2, s[8:11], s29 offen offset:1024 sc1 lds
    s_add_u32 s28, s28, 1024
    s_add_u32 s29, s29, 1024
    s_waitcnt vmcnt(4)
    s_mov_b32 s31, 0
K2_A4_0:
    ds_read2st64_b32 v[10:11], v8 offset0:0 offset1:4
    s_waitcnt lgkmcnt(0)
    v_max_u32 v10, v10, v11
    v_cmp_eq_u32 vcc, -1, v10
    s_nop 1
    s_cbranch_vccnz K2_A4_0_R
K2_A4_0_B:
    s_barrier
    s_add_u32 m0, s32, 67584
    s_nop 0
    buffer_load_dwordx4 v2, s[8:11], s28 offen sc1 lds
    buffer_load_dwordx4 v2, s[8:11], s29 offen offset:1024 sc1 lds
    s_add_u32 s28, s28, 1024
    s_add_u32 s29, s29, 1024
    s_add_u32 m0, s33, 67584
    s_nop 0
    buffer_load_dwordx4 v2, s[12:15], s30 offen offset:0 sc1 lds
    buffer_load_dwordx4 v2, s[12:15], s30 offen offset:1024 sc1 lds
    buffer_load_dwordx4 v2, s[12:15], s30 offen offset:2048 sc1 lds
    buffer_load_dwordx4 v2, s[12:15], s30 offen offset:3072 sc1 lds
    s_add_u32 s30, s30, 14336
    s_waitcnt vmcnt(8)
    s_mov_b32 s31, 0
K2_A4_1:
    ds_read2st64_b32 v[10:11], v8 offset0:88 offset1:92
    s_waitcnt lgkmcnt(0)
    v_max_u32 v10, v10, v11
    v_cmp_eq_u32 vcc, -1, v10
    s_nop 1
    s_cbranch_vccnz K2_A4_1_R
K2_A4_1_B:
    s_barrier
    s_add_u32 m0, s32, 90112
    s_nop 0
    buffer_load_dwordx4 v2, s[8:11], s28 offen sc1 lds
    buffer_load_dwordx4 v2, s[8:11], s29 offen offset:1024 sc1 lds
    s_add_u32 s28, s28, 1024
    s_add_u32 s29, s29, 1024
    s_add_u32 m0, s33, 90112
    s_nop 0
    buffer_load_dwordx4 v2, s[12:15], s30 offen offset:0 sc1 lds
    buffer_load_dwordx4 v2, s[12:15], s30 offen offset:1024 sc1 lds
    buffer_load_dwordx4 v2, s[12:15], s30 offen offset:2048 sc1 lds
    buffer_load_dwordx4 v2, s[12:15], s30 offen offset:3072 sc1 lds
    s_add_u32 s30, s30, 14336
    s_mov_b64 exec, 1
    buffer_store_dword v26, v12, s[48:51], s41 offen offset:192 sc1
    s_mov_b64 exec, -1
    s_waitcnt vmcnt(13)
    s_mov_b32 s31, 0
K2_A4_2:
    ds_read2st64_b32 v[10:11], v8 offset0:176 offset1:180
    s_waitcnt lgkmcnt(0)
    v_max_u32 v10, v10, v11
    v_cmp_eq_u32 vcc, -1, v10
    s_nop 1
    s_cbranch_vccnz K2_A4_2_R
K2_A4_2_B:
    s_barrier
    s_add_u32 m0, s32, 0
    s_nop 0
    buffer_load_dwordx4 v2, s[8:11], s28 offen sc1 lds
    buffer_load_dwordx4 v2, s[8:11], s29 offen offset:1024 sc1 lds
    s_add_u32 s28, s28, 1024
    s_add_u32 s29, s29, 1024
    s_add_u32 m0, s33, 0
    s_nop 0
    buffer_load_dwordx4 v2, s[12:15], s30 offen offset:0 sc1 lds
    buffer_load_dwordx4 v2, s[12:15], s30 offen offset:1024 sc1 lds
    buffer_load_dwordx4 v2, s[12:15], s30 offen offset:2048 sc1 lds
    buffer_load_dwordx4 v2, s[12:15], s30 offen offset:3072 sc1 lds
    s_add_u32 s30, s30, 14336
    s_waitcnt vmcnt(13)
    s_mov_b32 s31, 0
K2_A4_3:
    ds_read2st64_b32 v[10:11], v9 offset0:0 offset1:4
    s_waitcnt lgkmcnt(0)
    v_max_u32 v10, v10, v11
    v_cmp_eq_u32 vcc, -1, v10
    s_nop 1
    s_cbranch_vccnz K2_A4_3_R
K2_A4_3_B:
    s_barrier
    s_add_u32 m0, s32, 22528
    s_nop 0
    buffer_load_dwordx4 v2, s[8:11], s28 offen sc1 lds
    buffer_load_dwordx4 v2, s[8:11], s29 offen offset:1024 sc1 lds
    s_add_u32 s28, s28, 1024
    s_add_u32 s29, s29, 1024
    s_add_u32 m0, s33, 22528
    s_nop 0
    buffer_load_dwordx4 v2, s[12:15], s30 offen offset:0 sc1 lds
    buffer_load_dwordx4 v2, s[12:15], s30 offen offset:1024 sc1 lds
    buffer_load_dwordx4 v2, s[12:15], s30 offen offset:2048 sc1 lds
    buffer_load_dwordx4 v2, s[12:15], s30 offen offset:3072 sc1 lds
    s_add_u32 s30, s30, 14336
    s_waitcnt vmcnt(13)
    s_mov_b32 s31, 0
K2_A4_4:
    ds_read2st64_b32 v[10:11], v9 offset0:88 offset1:92
    s_waitcnt lgkmcnt(0)
    v_max_u32 v10, v10, v11
    v_cmp_eq_u32 vcc, -1, v10
    s_nop 1
    s_cbranch_vccnz K2_A4_4_R
K2_A4_4_B:
    s_barrier
    s_add_u32 m0, s32, 45056
    s_nop 0
    buffer_load_dwordx4 v2, s[8:11], s28 offen sc1 lds
    buffer_load_dwordx4 v2, s[8:11], s29 offen offset:1024 sc1 lds
    s_add_u32 s28, s28, 1024
    s_add_u32 s29, s29, 1024
    s_add_u32 m0, s33, 45056
    s_nop 0
    buffer_load_dwordx4 v2, s[12:15], s30 offen offset:0 sc1 lds
    buffer_load_dwordx4 v2, s[12:15], s30 offen offset:1024 sc1 lds
    buffer_load_dwordx4 v2, s[12:15], s30 offen offset:2048 sc1 lds
    buffer_load_dwordx4 v2, s[12:15], s30 offen offset:3072 sc1 lds
    s_add_u32 s30, s30, 14336
    s_waitcnt vmcnt(12)
    s_mov_b32 s31, 0
K2_A4_5:
    ds_read2st64_b32 v[10:11], v8 offset0:0 offset1:4
    s_waitcnt lgkmcnt(0)
    v_max_u32 v10, v10, v11
    v_cmp_eq_u32 vcc, -1, v10
    s_nop 1
    s_cbranch_vccnz K2_A4_5_R
K2_A4_5_B:
    s_barrier
    s_add_u32 m0, s32, 67584
    s_nop 0
    buffer_load_dwordx4 v2, s[8:11], s28 offen sc1 lds
    buffer_load_dwordx4 v2, s[8:11], s29 offen offset:1024 sc1 lds
    s_add_u32 s28, s28, 1024
    s_add_u32 s29, s29, 1024
    s_add_u32 m0, s33, 67584
    s_nop 0
    buffer_load_dwordx4 v2, s[12:15], s30 offen offset:0 sc1 lds
    buffer_load_dwordx4 v2, s[12:15], s30 offen offset:1024 sc1 lds
    buffer_load_dwordx4 v2, s[12:15], s30 offen offset:2048 sc1 lds
    buffer_load_dwordx4 v2, s[12:15], s30 offen offset:3072 sc1 lds
    s_add_u32 s30, s30, 14336
    s_waitcnt vmcnt(12)
    s_mov_b32 s31, 0
K2_A4_6:
    ds_read2st64_b32 v[10:11], v8 offset0:88 offset1:92
    s_waitcnt lgkmcnt(0)
    v_max_u32 v10, v10, v11
    v_cmp_eq_u32 vcc, -1, v10
    s_nop 1
    s_cbranch_vccnz K2_A4_6_R
K2_A4_6_B:
    s_barrier
    s_add_u32 m0, s32, 90112
    s_nop 0
    buffer_load_dwordx4 v2, s[8:11], s28 offen sc1 lds
    buffer_load_dwordx4 v2, s[8:11], s29 offen offset:1024 sc1 lds
    s_add_u32 s28, s28, 1024
    s_add_u32 s29, s29, 1024
    s_add_u32 m0, s33, 90112
    s_nop 0
    buffer_load_dwordx4 v2, s[12:15], s30 offen offset:0 sc1 lds
    buffer_load_dwordx4 v2, s[12:15], s30 offen offset:1024 sc1 lds
    buffer_load_dwordx4 v2, s[12:15], s30 offen offset:2048 sc1 lds
    buffer_load_dwordx4 v2, s[12:15], s30 offen offset:3072 sc1 lds
    s_add_u32 s30, s30, 14336
    s_waitcnt vmcnt(12)
    s_mov_b32 s31, 0
K2_A4_7:
    ds_read2st64_b32 v[10:11], v8 offset0:176 offset1:180
    s_waitcnt lgkmcnt(0)
    v_max_u32 v10, v10, v11
    v_cmp_eq_u32 vcc, -1, v10
    s_nop 1
    s_cbranch_vccnz K2_A4_7_R
K2_A4_7_B:
    s_barrier
    s_add_u32 m0, s32, 0
    s_nop 0
    buffer_load_dwordx4 v2, s[8:11], s28 offen sc1 lds
    buffer_load_dwordx4 v2, s[8:11], s29 offen offset:1024 sc1 lds
    s_add_u32 s28, s28, 1024
    s_add_u32 s29, s29, 1024
    s_add_u32 m0, s33, 0
    s_nop 0
    buffer_load_dwordx4 v2, s[12:15], s30 offen offset:0 sc1 lds
    buffer_load_dwordx4 v2, s[12:15], s30 offen offset:1024 sc1 lds
    buffer_load_dwordx4 v2, s[12:15], s30 offen offset:2048 sc1 lds
    buffer_load_dwordx4 v2, s[12:15], s30 offen offset:3072 sc1 lds
    s_add_u32 s30, s30, 14336
    s_waitcnt vmcnt(12)
    s_mov_b32 s31, 0
K2_A4_8:
    ds_read2st64_b32 v[10:11], v9 offset0:0 offset1:4
    s_waitcnt lgkmcnt(0)
    v_max_u32 v10, v10, v11
    v_cmp_eq_u32 vcc, -1, v10
    s_nop 1
    s_cbranch_vccnz K2_A4_8_R
K2_A4_8_B:
    s_barrier
    s_add_u32 m0, s32, 22528
    s_nop 0
    buffer_load_dwordx4 v2, s[8:11], s28 offen sc1 lds
    buffer_load_dwordx4 v2, s[8:11], s29 offen offset:1024 sc1 lds
    s_add_u32 s28, s28, 1024
    s_add_u32 s29, s29, 1024
    s_add_u32 m0, s33, 22528
    s_nop 0
    buffer_load_dwordx4 v2, s[12:15], s30 offen offset:0 sc1 lds
    buffer_load_dwordx4 v2, s[12:15], s30 offen offset:1024 sc1 lds
    buffer_load_dwordx4 v2, s[12:15], s30 offen offset:2048 sc1 lds
    buffer_load_dwordx4 v2, s[12:15], s30 offen offset:3072 sc1 lds
    s_add_u32 s30, s30, 14336
    s_waitcnt vmcnt(12)
    s_mov_b32 s31, 0
K2_A4_9:
    ds_read2st64_b32 v[10:11], v9 offset0:88 offset1:92
    s_waitcnt lgkmcnt(0)
    v_max_u32 v10, v10, v11
    v_cmp_eq_u32 vcc, -1, v10
    s_nop 1
    s_cbranch_vccnz K2_A4_9_R
K2_A4_9_B:
    s_barrier
    s_add_u32 m0, s32, 45056
    s_nop 0
    buffer_load_dwordx4 v2, s[8:11], s28 offen sc1 lds
    buffer_load_dwordx4 v2, s[8:11], s29 offen offset:1024 sc1 lds
    s_add_u32 s28, s28, 1024
    s_add_u32 s29, s29, 1024
    s_add_u32 m0, s33, 45056
    s_nop 0
    buffer_load_dwordx4 v2, s[12:15], s30 offen offset:0 sc1 lds
    buffer_load_dwordx4 v2, s[12:15], s30 offen offset:1024 sc1 lds
    buffer_load_dwordx4 v2, s[12:15], s30 offen offset:2048 sc1 lds
    buffer_load_dwordx4 v2, s[12:15], s30 offen offset:3072 sc1 lds
    s_add_u32 s30, s30, 14336
    s_waitcnt vmcnt(12)
    s_mov_b32 s31, 0
K2_A4_10:
    ds_read2st64_b32 v[10:11], v8 offset0:0 offset1:4
    s_waitcnt lgkmcnt(0)
    v_max_u32 v10, v10, v11
    v_cmp_eq_u32 vcc, -1, v10
    s_nop 1
    s_cbranch_vccnz K2_A4_10_R
K2_A4_10_B:
    s_barrier
    s_add_u32 m0, s32, 67584
    s_nop 0
    buffer_load_dwordx4 v2, s[8:11], s28 offen sc1 lds
    buffer_load_dwordx4 v2, s[8:11], s29 offen offset:1024 sc1 lds
    s_add_u32 s28, s28, 1024
    s_add_u32 s29, s29, 1024
    s_add_u32 m0, s33, 67584
    s_nop 0
    buffer_load_dwordx4 v2, s[12:15], s30 offen offset:0 sc1 lds
    buffer_load_dwordx4 v2, s[12:15], s30 offen offset:1024 sc1 lds
    buffer_load_dwordx4 v2, s[12:15], s30 offen offset:2048 sc1 lds
    buffer_load_dwordx4 v2, s[12:15], s30 offen offset:3072 sc1 lds
    s_add_u32 s30, s30, 14336
    s_waitcnt vmcnt(12)
    s_mov_b32 s31, 0
K2_A4_11:
    ds_read2st64_b32 v[10:11], v8 offset0:88 offset1:92
    s_waitcnt lgkmcnt(0)
    v_max_u32 v10, v10, v11
    v_cmp_eq_u32 vcc, -1, v10
    s_nop 1
    s_cbranch_vccnz K2_A4_11_R
K2_A4_11_B:
    s_barrier
    s_add_u32 m0, s32, 90112
    s_nop 0
    buffer_load_dwordx4 v2, s[8:11], s28 offen sc1 lds
    buffer_load_dwordx4 v2, s[8:11], s29 offen offset:1024 sc1 lds
    s_add_u32 s28, s28, 1024
    s_add_u32 s29, s29, 1024
    s_add_u32 m0, s33, 90112
    s_nop 0
    buffer_load_dwordx4 v2, s[12:15], s30 offen offset:0 sc1 lds
    buffer_load_dwordx4 v2, s[12:15], s30 offen offset:1024 sc1 lds
    buffer_load_dwordx4 v2, s[12:15], s30 offen offset:2048 sc1 lds
    buffer_load_dwordx4 v2, s[12:15], s30 offen offset:3072 sc1 lds
    s_add_u32 s30, s30, 14336
    s_waitcnt vmcnt(12)
    s_mov_b32 s31, 0
K2_A4_12:
    ds_read2st64_b32 v[10:11], v8 offset0:176 offset1:180
    s_waitcnt lgkmcnt(0)
    v_max_u32 v10, v10, v11
    v_cmp_eq_u32 vcc, -1, v10
    s_nop 1
    s_cbranch_vccnz K2_A4_12_R
K2_A4_12_B:
    s_barrier
    s_add_u32 m0, s32, 0
    s_nop 0
    buffer_load_dwordx4 v2, s[8:11], s28 offen sc1 lds
    buffer_load_dwordx4 v2, s[8:11], s29 offen offset:1024 sc1 lds
    s_add_u32 s28, s28, 1024
    s_add_u32 s29, s29, 1024
    s_add_u32 m0, s33, 0
    s_nop 0
    buffer_load_dwordx4 v2, s[12:15], s30 offen offset:0 sc1 lds
    buffer_load_dwordx4 v2, s[12:15], s30 offen offset:1024 sc1 lds
    buffer_load_dwordx4 v2, s[12:15], s30 offen offset:2048 sc1 lds
    buffer_load_dwordx4 v2, s[12:15], s30 offen offset:3072 sc1 lds
    s_add_u32 s30, s30, 14336
    s_waitcnt vmcnt(12)
    s_mov_b32 s31, 0
K2_A4_13:
    ds_read2st64_b32 v[10:11], v9 offset0:0 offset1:4
    s_waitcnt lgkmcnt(0)
    v_max_u32 v10, v10, v11
    v_cmp_eq_u32 vcc, -1, v10
    s_nop 1
    s_cbranch_vccnz K2_A4_13_R
K2_A4_13_B:
    s_barrier
    s_add_u32 m0, s32, 22528
    s_nop 0
    buffer_load_dwordx4 v2, s[8:11], s28 offen sc1 lds
    buffer_load_dwordx4 v2, s[8:11], s29 offen offset:1024 sc1 lds
    s_add_u32 s28, s28, 1024
    s_add_u32 s29, s29, 1024
    s_add_u32 m0, s33, 22528
    s_nop 0
    buffer_load_dwordx4 v2, s[12:15], s30 offen offset:0 sc1 lds
    buffer_load_dwordx4 v2, s[12:15], s30 offen offset:1024 sc1 lds
    buffer_load_dwordx4 v2, s[12:15], s30 offen offset:2048 sc1 lds
    buffer_load_dwordx4 v2, s[12:15], s30 offen offset:3072 sc1 lds
    s_add_u32 s30, s30, 14336
    s_waitcnt vmcnt(12)
    s_mov_b32 s31, 0
K2_A4_14:
    ds_read2st64_b32 v[10:11], v9 offset0:88 offset1:92
    s_waitcnt lgkmcnt(0)
    v_max_u32 v10, v10, v11
    v_cmp_eq_u32 vcc, -1, v10
    s_nop 1
    s_cbranch_vccnz K2_A4_14_R
K2_A4_14_B:
    s_barrier
    s_add_u32 m0, s32, 45056
    s_nop 0
    buffer_load_dwordx4 v2, s[8:11], s28 offen sc1 lds
    buffer_load_dwordx4 v2, s[8:11], s29 offen offset:1024 sc1 lds
    s_add_u32 s28, s28, 1024
    s_add_u32 s29, s29, 1024
    s_add_u32 m0, s33, 45056
    s_nop 0
    buffer_load_dwordx4 v2, s[12:15], s30 offen offset:0 sc1 lds
    buffer_load_dwordx4 v2, s[12:15], s30 offen offset:1024 sc1 lds
    buffer_load_dwordx4 v2, s[12:15], s30 offen offset:2048 sc1 lds
    buffer_load_dwordx4 v2, s[12:15], s30 offen offset:3072 sc1 lds
    s_add_u32 s30, s30, 14336
    s_waitcnt vmcnt(12)
    s_mov_b32 s31, 0
K2_A4_15:
    ds_read2st64_b32 v[10:11], v8 offset0:0 offset1:4
    s_waitcnt lgkmcnt(0)
    v_max_u32 v10, v10, v11
    v_cmp_eq_u32 vcc, -1, v10
    s_nop 1
    s_cbranch_vccnz K2_A4_15_R
K2_A4_15_B:
    s_barrier
    s_add_u32 m0, s32, 67584
    s_nop 0
    buffer_load_dwordx4 v2, s[8:11], s28 offen sc1 lds
    buffer_load_dwordx4 v2, s[8:11], s29 offen offset:1024 sc1 lds
    s_add_u32 s28, s28, 1024
    s_add_u32 s29, s29, 1024
    s_add_u32 m0, s33, 67584
    s_nop 0
    buffer_load_dwordx4 v2, s[12:15], s30 offen offset:0 sc1 lds
    buffer_load_dwordx4 v2, s[12:15], s30 offen offset:1024 sc1 lds
    buffer_load_dwordx4 v2, s[12:15], s30 offen offset:2048 sc1 lds
    buffer_load_dwordx4 v2, s[12:15], s30 offen offset:3072 sc1 lds
    s_add_u32 s30, s30, 14336
    s_waitcnt vmcnt(12)
    s_mov_b32 s31, 0
K2_A4_16:
    ds_read2st64_b32 v[10:11], v8 offset0:88 offset1:92
    s_waitcnt lgkmcnt(0)
    v_max_u32 v10, v10, v11
    v_cmp_eq_u32 vcc, -1, v10
    s_nop 1
    s_cbranch_vccnz K2_A4_16_R
K2_A4_16_B:
    s_barrier
    s_add_u32 m0, s32, 90112
    s_nop 0
    buffer_load_dwordx4 v2, s[8:11], s28 offen sc1 lds
    buffer_load_dwordx4 v2, s[8:11], s29 offen offset:1024 sc1 lds
    s_add_u32 s28, s28, 1024
    s_add_u32 s29, s29, 1024
    s_add_u32 m0, s33, 90112
    s_nop 0
    buffer_load_dwordx4 v2, s[12:15], s30 offen offset:0 sc1 lds
    buffer_load_dwordx4 v2, s[12:15], s30 offen offset:1024 sc1 lds
    buffer_load_dwordx4 v2, s[12:15], s30 offen offset:2048 sc1 lds
    buffer_load_dwordx4 v2, s[12:15], s30 offen offset:3072 sc1 lds
    s_add_u32 s30, s30, 14336
    buffer_load_dwordx4 v[32:35], v21, s[48:51], 0 offen offset:192 sc1
    s_add_u32 m0, s38, 0
    s_nop 0
    buffer_load_dwordx4 v2, s[24:27], s37 offen offset:0 sc1 lds
    s_add_u32 m0, s38, 0
    s_nop 0
    buffer_load_dwordx4 v2, s[24:27], s37 offen offset:1024 sc1 lds
    s_add_u32 m0, s38, 0
    s_nop 0
    buffer_load_dwordx4 v2, s[24:27], s37 offen offset:2048 sc1 lds
    s_add_u32 m0, s38, 0
    s_nop 0
    buffer_load_dwordx4 v2, s[24:27], s37 offen offset:3072 sc1 lds
    s_add_u32 s37, s37, 4096
    s_waitcnt vmcnt(17)
    s_mov_b32 s31, 0
K2_A4_17:
    ds_read2st64_b32 v[10:11], v8 offset0:176 offset1:180
    s_waitcnt lgkmcnt(0)
    v_max_u32 v10, v10, v11
    v_cmp_eq_u32 vcc, -1, v10
    s_nop 1
    s_cbranch_vccnz K2_A4_17_R
K2_A4_17_B:
    s_barrier
    s_add_u32 m0, s38, 4096
    s_nop 0
    buffer_load_dwordx4 v2, s[24:27], s37 offen offset:0 sc1 lds
    s_add_u32 m0, s38, 4096
    s_nop 0
    buffer_load_dwordx4 v2, s[24:27], s37 offen offset:1024 sc1 lds
    s_add_u32 m0, s38, 4096
    s_nop 0
    buffer_load_dwordx4 v2, s[24:27], s37 offen offset:2048 sc1 lds
    s_add_u32 m0, s38, 4096
    s_nop 0
    buffer_load_dwordx4 v2, s[24:27], s37 offen offset:3072 sc1 lds
    s_add_u32 s37, s37, 4096
    s_add_u32 m0, s38, 8192
    s_nop 0
    buffer_load_dwordx4 v2, s[24:27], s37 offen offset:0 sc1 lds
    s_add_u32 m0, s38, 8192
    s_nop 0
    buffer_load_dwordx4 v2, s[24:27], s37 offen offset:1024 sc1 lds
    s_waitcnt vmcnt(10)
    s_mov_b32 s35, 0
    s_branch K2_C4_T
K2_C4:
    buffer_load_dwordx4 v[32:35], v21, s[48:51], 0 offen offset:192 sc1
    s_add_u32 s35, s35, 1
    s_cmp_gt_u32 s35, 4000
    s_waitcnt vmcnt(0)
    s_cbranch_scc1 K2_C4_X
K2_C4_T:
    s_mov_b32 exec_lo, 0x0
    s_mov_b32 exec_hi, 0xffffff00
    v_cmp_ne_u64 vcc, v[32:33], v[26:27]
    v_cmp_ne_u64 s[4:5], v[34:35], v[26:27]
    s_nop 1
    s_or_b64 vcc, vcc, s[4:5]
    s_mov_b64 exec, -1
    s_cbranch_vccnz K2_C4
K2_C4_X:
    s_waitcnt vmcnt(17)
    s_mov_b32 s31, 0
K2_A4_18:
    ds_read2st64_b32 v[10:11], v9 offset0:0 offset1:4
    s_waitcnt lgkmcnt(0)
    v_max_u32 v10, v10, v11
    v_cmp_eq_u32 vcc, -1, v10
    s_nop 1
    s_cbranch_vccnz K2_A4_18_R
K2_A4_18_B:
    s_barrier
    s_add_u32 m0, s38, 8192
    s_nop 0
    buffer_load_dwordx4 v2, s[24:27], s37 offen offset:2048 sc1 lds
    s_add_u32 m0, s38, 8192
    s_nop 0
    buffer_load_dwordx4 v2, s[24:27], s37 offen offset:3072 sc1 lds
    s_add_u32 s37, s37, 4096
    s_add_u32 m0, s39, 0
    s_nop 0
    buffer_load_dwordx4 v2, s[24:27], s37 offen offset:0 sc1 lds
    s_add_u32 m0, s39, 0
    s_nop 0
    buffer_load_dwordx4 v2, s[24:27], s37 offen offset:1024 sc1 lds
    s_add_u32 m0, s39, 0
    s_nop 0
    buffer_load_dwordx4 v2, s[24:27], s37 offen offset:2048 sc1 lds
    s_add_u32 m0, s39, 0
    s_nop 0
    buffer_load_dwordx4 v2, s[24:27], s37 offen offset:3072 sc1 lds
    s_add_u32 s37, s37, 4096
    s_waitcnt vmcnt(17)
    s_mov_b32 s31, 0
K2_A4_19:
    ds_read2st64_b32 v[10:11], v9 offset0:88 offset1:92
    s_waitcnt lgkmcnt(0)
    v_max_u32 v10, v10, v11
    v_cmp_eq_u32 vcc, -1, v10
    s_nop 1
    s_cbranch_vccnz K2_A4_19_R
K2_A4_19_B:
    s_barrier
    s_add_u32 m0, s39, 4096
    s_nop 0
    buffer_load_dwordx4 v2, s[24:27], s37 offen offset:0 sc1 lds
    s_sub_u32 m0, s58, 1024
    s_nop 0
    buffer_load_dwordx4 v2, s[24:27], s37 offen offset:1024 sc1 lds
    s_sub_u32 m0, s58, 1024
    s_nop 0
    buffer_load_dwordx4 v2, s[24:27], s37 offen offset:2048 sc1 lds
    s_sub_u32 m0, s58, 1024
    s_nop 0
    buffer_load_dwordx4 v2, s[24:27], s37 offen offset:3072 sc1 lds
    s_add_u32 s37, s37, 4096
    s_branch K2_L2
K2_A4_0_R:
    s_add_u32 s31, s31, 1
    s_cmp_gt_u32 s31, 4000
    s_cbranch_scc1 K2_A4_0_B
    s_sub_u32 s34, s28, 3072
    s_sub_u32 s35, s29, 3072
    s_add_u32 m0, s32, 0
    s_nop 0
    buffer_load_dwordx4 v2, s[8:11], s34 offen sc1 lds
    buffer_load_dwordx4 v2, s[8:11], s35 offen offset:1024 sc1 lds
    s_sub_u32 s34, s28, 2048
    s_sub_u32 s35, s29, 2048
    s_add_u32 m0, s32, 22528
    s_nop 0
    buffer_load_dwordx4 v2, s[8:11], s34 offen sc1 lds
    buffer_load_dwordx4 v2, s[8:11], s35 offen offset:1024 sc1 lds
    s_sub_u32 s34, s28, 1024
    s_sub_u32 s35, s29, 1024
    s_add_u32 m0, s32, 45056
    s_nop 0
    buffer_load_dwordx4 v2, s[8:11], s34 offen sc1 lds
    buffer_load_dwordx4 v2, s[8:11], s35 offen offset:1024 sc1 lds
    s_waitcnt vmcnt(4)
    s_branch K2_A4_0
K2_A4_1_R:
    s_add_u32 s31, s31, 1
    s_cmp_gt_u32 s31, 4000
    s_cbranch_scc1 K2_A4_1_B
    s_sub_u32 s34, s28, 3072
    s_sub_u32 s35, s29, 3072
    s_add_u32 m0, s32, 22528
    s_nop 0
    buffer_load_dwordx4 v2, s[8:11], s34 offen sc1 lds
    buffer_load_dwordx4 v2, s[8:11], s35 offen offset:1024 sc1 lds
    s_waitcnt vmcnt(0)
    s_branch K2_A4_1
K2_A4_2_R:
    s_add_u32 s31, s31, 1
    s_cmp_gt_u32 s31, 4000
    s_cbranch_scc1 K2_A4_2_B
    s_sub_u32 s34, s28, 3072
    s_sub_u32 s35, s29, 3072
    s_add_u32 m0, s32, 45056
    s_nop 0
    buffer_load_dwordx4 v2, s[8:11], s34 offen sc1 lds
    buffer_load_dwordx4 v2, s[8:11], s35 offen offset:1024 sc1 lds
    s_waitcnt vmcnt(0)
    s_branch K2_A4_2
K2_A4_3_R:
    s_add_u32 s31, s31, 1
    s_cmp_gt_u32 s31, 4000
    s_cbranch_scc1 K2_A4_3_B
    s_sub_u32 s34, s28, 3072
    s_sub_u32 s35, s29, 3072
    s_add_u32 m0, s32, 67584
    s_nop 0
    buffer_load_dwordx4 v2, s[8:11], s34 offen sc1 lds
    buffer_load_dwordx4 v2, s[8:11], s35 offen offset:1024 sc1 lds
    s_waitcnt vmcnt(0)
    s_branch K2_A4_3
K2_A4_4_R:
    s_add_u32 s31, s31, 1
    s_cmp_gt_u32 s31, 4000
    s_cbranch_scc1 K2_A4_4_B
    s_sub_u32 s34, s28, 3072
    s_sub_u32 s35, s29, 3072
    s_add_u32 m0, s32, 90112
    s_nop 0
    buffer_load_dwordx4 v2, s[8:11], s34 offen sc1 lds
    buffer_load_dwordx4 v2, s[8:11], s35 offen offset:1024 sc1 lds
    s_waitcnt vmcnt(0)
    s_branch K2_A4_4
K2_A4_5_R:
    s_add_u32 s31, s31, 1
    s_cmp_gt_u32 s31, 4000
    s_cbranch_scc1 K2_A4_5_B
    s_sub_u32 s34, s28, 3072
    s_sub_u32 s35, s29, 3072
    s_add_u32 m0, s32, 0
    s_nop 0
    buffer_load_dwordx4 v2, s[8:11], s34 offen sc1 lds
    buffer_load_dwordx4 v2, s[8:11], s35 offen offset:1024 sc1 lds
    s_waitcnt vmcnt(0)
    s_branch K2_A4_5
K2_A4_6_R:
    s_add_u32 s31, s31, 1
    s_cmp_gt_u32 s31, 4000
    s_cbranch_scc1 K2_A4_6_B
    s_sub_u32 s34, s28, 3072
    s_sub_u32 s35, s29, 3072
    s_add_u32 m0, s32, 22528
    s_nop 0
    buffer_load_dwordx4 v2, s[8:11], s34 offen sc1 lds
    buffer_load_dwordx4 v2, s[8:11], s35 offen offset:1024 sc1 lds
    s_waitcnt vmcnt(0)
    s_branch K2_A4_6
K2_A4_7_R:
    s_add_u32 s31, s31, 1
    s_cmp_gt_u32 s31, 4000
    s_cbranch_scc1 K2_A4_7_B
    s_sub_u32 s34, s28, 3072
    s_sub_u32 s35, s29, 3072
    s_add_u32 m0, s32, 45056
    s_nop 0
    buffer_load_dwordx4 v2, s[8:11], s34 offen sc1 lds
    buffer_load_dwordx4 v2, s[8:11], s35 offen offset:1024 sc1 lds
    s_waitcnt vmcnt(0)
    s_branch K2_A4_7
K2_A4_8_R:
    s_add_u32 s31, s31, 1
    s_cmp_gt_u32 s31, 4000
    s_cbranch_scc1 K2_A4_8_B
    s_sub_u32 s34, s28, 3072
    s_sub_u32 s35, s29, 3072
    s_add_u32 m0, s32, 67584
    s_nop 0
    buffer_load_dwordx4 v2, s[8:11], s34 offen sc1 lds
    buffer_load_dwordx4 v2, s[8:11], s35 offen offset:1024 sc1 lds
    s_waitcnt vmcnt(0)
    s_branch K2_A4_8
K2_A4_9_R:
    s_add_u32 s31, s31, 1
    s_cmp_gt_u32 s31, 4000
    s_cbranch_scc1 K2_A4_9_B
    s_sub_u32 s34, s28, 3072
    s_sub_u32 s35, s29, 3072
    s_add_u32 m0, s32, 90112
    s_nop 0
    buffer_load_dwordx4 v2, s[8:11], s34 offen sc1 lds
    buffer_load_dwordx4 v2, s[8:11], s35 offen offset:1024 sc1 lds
    s_waitcnt vmcnt(0)
    s_branch K2_A4_9
K2_A4_10_R:
    s_add_u32 s31, s31, 1
    s_cmp_gt_u32 s31, 4000
    s_cbranch_scc1 K2_A4_10_B
    s_sub_u32 s34, s28, 3072
    s_sub_u32 s35, s29, 3072
    s_add_u32 m0, s32, 0
    s_nop 0
    buffer_load_dwordx4 v2, s[8:11], s34 offen sc1 lds
    buffer_load_dwordx4 v2, s[8:11], s35 offen offset:1024 sc1 lds
    s_waitcnt vmcnt(0)
    s_branch K2_A4_10
K2_A4_11_R:
    s_add_u32 s31, s31, 1
    s_cmp_gt_u32 s31, 4000
    s_cbranch_scc1 K2_A4_11_B
    s_sub_u32 s34, s28, 3072
    s_sub_u32 s35, s29, 3072
    s_add_u32 m0, s32, 22528
    s_nop 0
    buffer_load_dwordx4 v2, s[8:11], s34 offen sc1 lds
    buffer_load_dwordx4 v2, s[8:11], s35 offen offset:1024 sc1 lds
    s_waitcnt vmcnt(0)
    s_branch K2_A4_11
K2_A4_12_R:
    s_add_u32 s31, s31, 1
    s_cmp_gt_u32 s31, 4000
    s_cbranch_scc1 K2_A4_12_B
    s_sub_u32 s34, s28, 3072
    s_sub_u32 s35, s29, 3072
    s_add_u32 m0, s32, 45056
    s_nop 0
    buffer_load_dwordx4 v2, s[8:11], s34 offen sc1 lds
    buffer_load_dwordx4 v2, s[8:11], s35 offen offset:1024 sc1 lds
    s_waitcnt vmcnt(0)
    s_branch K2_A4_12
K2_A4_13_R:
    s_add_u32 s31, s31, 1
    s_cmp_gt_u32 s31, 4000
    s_cbranch_scc1 K2_A4_13_B
    s_sub_u32 s34, s28, 3072
    s_sub_u32 s35, s29, 3072
    s_add_u32 m0, s32, 67584
    s_nop 0
    buffer_load_dwordx4 v2, s[8:11], s34 offen sc1 lds
    buffer_load_dwordx4 v2, s[8:11], s35 offen offset:1024 sc1 lds
    s_waitcnt vmcnt(0)
    s_branch K2_A4_13
K2_A4_14_R:
    s_add_u32 s31, s31, 1
    s_cmp_gt_u32 s31, 4000
    s_cbranch_scc1 K2_A4_14_B
    s_sub_u32 s34, s28, 3072
    s_sub_u32 s35, s29, 3072
    s_add_u32 m0, s32, 90112
    s_nop 0
    buffer_load_dwordx4 v2, s[8:11], s34 offen sc1 lds
    buffer_load_dwordx4 v2, s[8:11], s35 offen offset:1024 sc1 lds
    s_waitcnt vmcnt(0)
    s_branch K2_A4_14
K2_A4_15_R:
    s_add_u32 s31, s31, 1
    s_cmp_gt_u32 s31, 4000
    s_cbranch_scc1 K2_A4_15_B
    s_sub_u32 s34, s28, 3072
    s_sub_u32 s35, s29, 3072
    s_add_u32 m0, s32, 0
    s_nop 0
    buffer_load_dwordx4 v2, s[8:11], s34 offen sc1 lds
    buffer_load_dwordx4 v2, s[8:11], s35 offen offset:1024 sc1 lds
    s_waitcnt vmcnt(0)
    s_branch K2_A4_15
K2_A4_16_R:
    s_add_u32 s31, s31, 1
    s_cmp_gt_u32 s31, 4000
    s_cbranch_scc1 K2_A4_16_B
    s_sub_u32 s34, s28, 3072
    s_sub_u32 s35, s29, 3072
    s_add_u32 m0, s32, 22528
    s_nop 0
    buffer_load_dwordx4 v2, s[8:11], s34 offen sc1 lds
    buffer_load_dwordx4 v2, s[8:11], s35 offen offset:1024 sc1 lds
    s_waitcnt vmcnt(0)
    s_branch K2_A4_16
K2_A4_17_R:
    s_add_u32 s31, s31, 1
    s_cmp_gt_u32 s31, 4000
    s_cbranch_scc1 K2_A4_17_B
    s_sub_u32 s34, s28, 3072
    s_sub_u32 s35, s29, 3072
    s_add_u32 m0, s32, 45056
    s_nop 0
    buffer_load_dwordx4 v2, s[8:11], s34 offen sc1 lds
    buffer_load_dwordx4 v2, s[8:11], s35 offen offset:1024 sc1 lds
    s_waitcnt vmcnt(0)
    s_branch K2_A4_17
K2_A4_18_R:
    s_add_u32 s31, s31, 1
    s_cmp_gt_u32 s31, 4000
    s_cbranch_scc1 K2_A4_18_B
    s_sub_u32 s34, s28, 2048
    s_sub_u32 s35, s29, 2048
    s_add_u32 m0, s32, 67584
    s_nop 0
    buffer_load_dwordx4 v2, s[8:11], s34 offen sc1 lds
    buffer_load_dwordx4 v2, s[8:11], s35 offen offset:1024 sc1 lds
    s_waitcnt vmcnt(0)
    s_branch K2_A4_18
K2_A4_19_R:
    s_add_u32 s31, s31, 1
    s_cmp_gt_u32 s31, 4000
    s_cbranch_scc1 K2_A4_19_B
    s_sub_u32 s34, s28, 1024
    s_sub_u32 s35, s29, 1024
    s_add_u32 m0, s32, 90112
    s_nop 0
    buffer_load_dwordx4 v2, s[8:11], s34 offen sc1 lds
    buffer_load_dwordx4 v2, s[8:11], s35 offen offset:1024 sc1 lds
    s_waitcnt vmcnt(0)
    s_branch K2_A4_19
K2_LOAD3:
    s_add_u32 m0, s33, 0
    s_nop 0
    buffer_load_dwordx4 v2, s[12:15], s30 offen offset:0 sc1 lds
    buffer_load_dwordx4 v2, s[12:15], s30 offen offset:1024 sc1 lds
    buffer_load_dwordx4 v2, s[12:15], s30 offen offset:2048 sc1 lds
    s_add_u32 s30, s30, 14336
    s_add_u32 m0, s33, 22528
    s_nop 0
    buffer_load_dwordx4 v2, s[12:15], s30 offen offset:0 sc1 lds
    buffer_load_dwordx4 v2, s[12:15], s30 offen offset:1024 sc1 lds
    buffer_load_dwordx4 v2, s[12:15], s30 offen offset:2048 sc1 lds
    s_add_u32 s30, s30, 14336
    s_barrier
    s_add_u32 m0, s33, 45056
    s_nop 0
    buffer_load_dwordx4 v2, s[12:15], s30 offen offset:0 sc1 lds
    buffer_load_dwordx4 v2, s[12:15], s30 offen offset:1024 sc1 lds
    buffer_load_dwordx4 v2, s[12:15], s30 offen offset:2048 sc1 lds
    s_add_u32 s30, s30, 14336
    s_add_u32 m0, s32, 0
    s_nop 0
    buffer_load_dwordx4 v2, s[8:11], s28 offen sc1 lds
    buffer_load_dwordx4 v2, s[8:11], s29 offen offset:1024 sc1 lds
    s_add_u32 s28, s28, 1024
    s_add_u32 s29, s29, 1024
    s_add_u32 m0, s32, 22528
    s_nop 0
    buffer_load_dwordx4 v2, s[8:11], s28 offen sc1 lds
    buffer_load_dwordx4 v2, s[8:11], s29 offen offset:1024 sc1 lds
    s_add_u32 s28, s28, 1024
    s_add_u32 s29, s29, 1024
    s_add_u32 m0, s32, 45056
    s_nop 0
    buffer_load_dwordx4 v2, s[8:11], s28 offen sc1 lds
    buffer_load_dwordx4 v2, s[8:11], s29 offen offset:1024 sc1 lds
    s_add_u32 s28, s28, 1024
    s_add_u32 s29, s29, 1024
    s_waitcnt vmcnt(4)
    s_mov_b32 s31, 0
K2_A3_0:
    ds_read2st64_b32 v[10:11], v8 offset0:0 offset1:4
    s_waitcnt lgkmcnt(0)
    v_max_u32 v10, v10, v11
    v_cmp_eq_u32 vcc, -1, v10
    s_nop 1
    s_cbranch_vccnz K2_A3_0_R
K2_A3_0_B:
    s_barrier
    s_add_u32 m0, s32, 67584
    s_nop 0
    buffer_load_dwordx4 v2, s[8:11], s28 offen sc1 lds
    buffer_load_dwordx4 v2, s[8:11], s29 offen offset:1024 sc1 lds
    s_add_u32 s28, s28, 1024
    s_add_u32 s29, s29, 1024
    s_add_u32 m0, s33, 67584
    s_nop 0
    buffer_load_dwordx4 v2, s[12:15], s30 offen offset:0 sc1 lds
    buffer_load_dwordx4 v2, s[12:15], s30 offen offset:1024 sc1 lds
    buffer_load_dwordx4 v2, s[12:15], s30 offen offset:2048 sc1 lds
    s_add_u32 s30, s30, 14336
    s_waitcnt vmcnt(7)
    s_mov_b32 s31, 0
K2_A3_1:
    ds_read2st64_b32 v[10:11], v8 offset0:88 offset1:92
    s_waitcnt lgkmcnt(0)
    v_max_u32 v10, v10, v11
    v_cmp_eq_u32 vcc, -1, v10
    s_nop 1
    s_cbranch_vccnz K2_A3_1_R
K2_A3_1_B:
    s_barrier
    s_add_u32 m0, s32, 90112
    s_nop 0
    buffer_load_dwordx4 v2, s[8:11], s28 offen sc1 lds
    buffer_load_dwordx4 v2, s[8:11], s29 offen offset:1024 sc1 lds
    s_add_u32 s28, s28, 1024
    s_add_u32 s29, s29, 1024
    s_add_u32 m0, s33, 90112
    s_nop 0
    buffer_load_dwordx4 v2, s[12:15], s30 offen offset:0 sc1 lds
    buffer_load_dwordx4 v2, s[12:15], s30 offen offset:1024 sc1 lds
    buffer_load_dwordx4 v2, s[12:15], s30 offen offset:2048 sc1 lds
    s_add_u32 s30, s30, 14336
    s_waitcnt vmcnt(10)
    s_mov_b32 s31, 0
K2_A3_2:
    ds_read2st64_b32 v[10:11], v8 offset0:176 offset1:180
    s_waitcnt lgkmcnt(0)
    v_max_u32 v10, v10, v11
    v_cmp_eq_u32 vcc, -1, v10
    s_nop 1
    s_cbranch_vccnz K2_A3_2_R
K2_A3_2_B:
    s_barrier
    s_add_u32 m0, s32, 0
    s_nop 0
    buffer_load_dwordx4 v2, s[8:11], s28 offen sc1 lds
    buffer_load_dwordx4 v2, s[8:11], s29 offen offset:1024 sc1 lds
    s_add_u32 s28, s28, 1024
    s_add_u32 s29, s29, 1024
    s_add_u32 m0, s33, 0
    s_nop 0
    buffer_load_dwordx4 v2, s[12:15], s30 offen offset:0 sc1 lds
    buffer_load_dwordx4 v2, s[12:15], s30 offen offset:1024 sc1 lds
    buffer_load_dwordx4 v2, s[12:15], s30 offen offset:2048 sc1 lds
    s_add_u32 s30, s30, 14336
    s_waitcnt vmcnt(10)
    s_mov_b32 s31, 0
K2_A3_3:
    ds_read2st64_b32 v[10:11], v9 offset0:0 offset1:4
    s_waitcnt lgkmcnt(0)
    v_max_u32 v10, v10, v11
    v_cmp_eq_u32 vcc, -1, v10
    s_nop 1
    s_cbranch_vccnz K2_A3_3_R
K2_A3_3_B:
    s_barrier
    s_add_u32 m0, s32, 22528
    s_nop 0
    buffer_load_dwordx4 v2, s[8:11], s28 offen sc1 lds
    buffer_load_dwordx4 v2, s[8:11], s29 offen offset:1024 sc1 lds
    s_add_u32 s28, s28, 1024
    s_add_u32 s29, s29, 1024
    s_add_u32 m0, s33, 22528
    s_nop 0
    buffer_load_dwordx4 v2, s[12:15], s30 offen offset:0 sc1 lds
    buffer_load_dwordx4 v2, s[12:15], s30 offen offset:1024 sc1 lds
    buffer_load_dwordx4 v2, s[12:15], s30 offen offset:2048 sc1 lds
    s_add_u32 s30, s30, 14336
    s_waitcnt vmcnt(10)
    s_mov_b32 s31, 0
K2_A3_4:
    ds_read2st64_b32 v[10:11], v9 offset0:88 offset1:92
    s_waitcnt lgkmcnt(0)
    v_max_u32 v10, v10, v11
    v_cmp_eq_u32 vcc, -1, v10
    s_nop 1
    s_cbranch_vccnz K2_A3_4_R
K2_A3_4_B:
    s_barrier
    s_add_u32 m0, s32, 45056
    s_nop 0
    buffer_load_dwordx4 v2, s[8:11], s28 offen sc1 lds
    buffer_load_dwordx4 v2, s[8:11], s29 offen offset:1024 sc1 lds
    s_add_u32 s28, s28, 1024
    s_add_u32 s29, s29, 1024
    s_add_u32 m0, s33, 45056
    s_nop 0
    buffer_load_dwordx4 v2, s[12:15], s30 offen offset:0 sc1 lds
    buffer_load_dwordx4 v2, s[12:15], s30 offen offset:1024 sc1 lds
    buffer_load_dwordx4 v2, s[12:15], s30 offen offset:2048 sc1 lds
    s_add_u32 s30, s30, 14336
    s_waitcnt vmcnt(10)
    s_mov_b32 s31, 0
K2_A3_5:
    ds_read2st64_b32 v[10:11], v8 offset0:0 offset1:4
    s_waitcnt lgkmcnt(0)
    v_max_u32 v10, v10, v11
    v_cmp_eq_u32 vcc, -1, v10
    s_nop 1
    s_cbranch_vccnz K2_A3_5_R
K2_A3_5_B:
    s_barrier
    s_add_u32 m0, s32, 67584
    s_nop 0
    buffer_load_dwordx4 v2, s[8:11], s28 offen sc1 lds
    buffer_load_dwordx4 v2, s[8:11], s29 offen offset:1024 sc1 lds
    s_add_u32 s28, s28, 1024
    s_add_u32 s29, s29, 1024
    s_add_u32 m0, s33, 67584
    s_nop 0
    buffer_load_dwordx4 v2, s[12:15], s30 offen offset:0 sc1 lds
    buffer_load_dwordx4 v2, s[12:15], s30 offen offset:1024 sc1 lds
    buffer_load_dwordx4 v2, s[12:15], s30 offen offset:2048 sc1 lds
    s_add_u32 s30, s30, 14336
    s_waitcnt vmcnt(10)
    s_mov_b32 s31, 0
K2_A3_6:
    ds_read2st64_b32 v[10:11], v8 offset0:88 offset1:92
    s_waitcnt lgkmcnt(0)
    v_max_u32 v10, v10, v11
    v_cmp_eq_u32 vcc, -1, v10
    s_nop 1
    s_cbranch_vccnz K2_A3_6_R
K2_A3_6_B:
    s_barrier
    s_add_u32 m0, s32, 90112
    s_nop 0
    buffer_load_dwordx4 v2, s[8:11], s28 offen sc1 lds
    buffer_load_dwordx4 v2, s[8:11], s29 offen offset:1024 sc1 lds
    s_add_u32 s28, s28, 1024
    s_add_u32 s29, s29, 1024
    s_add_u32 m0, s33, 90112
    s_nop 0
    buffer_load_dwordx4 v2, s[12:15], s30 offen offset:0 sc1 lds
    buffer_load_dwordx4 v2, s[12:15], s30 offen offset:1024 sc1 lds
    buffer_load_dwordx4 v2, s[12:15], s30 offen offset:2048 sc1 lds
    s_add_u32 s30, s30, 14336
    s_waitcnt vmcnt(10)
    s_mov_b32 s31, 0
K2_A3_7:
    ds_read2st64_b32 v[10:11], v8 offset0:176 offset1:180
    s_waitcnt lgkmcnt(0)
    v_max_u32 v10, v10, v11
    v_cmp_eq_u32 vcc, -1, v10
    s_nop 1
    s_cbranch_vccnz K2_A3_7_R
K2_A3_7_B:
    s_barrier
    s_add_u32 m0, s32, 0
    s_nop 0
    buffer_load_dwordx4 v2, s[8:11], s28 offen sc1 lds
    buffer_load_dwordx4 v2, s[8:11], s29 offen offset:1024 sc1 lds
    s_add_u32 s28, s28, 1024
    s_add_u32 s29, s29, 1024
    s_add_u32 m0, s33, 0
    s_nop 0
    buffer_load_dwordx4 v2, s[12:15], s30 offen offset:0 sc1 lds
    buffer_load_dwordx4 v2, s[12:15], s30 offen offset:1024 sc1 lds
    buffer_load_dwordx4 v2, s[12:15], s30 offen offset:2048 sc1 lds
    s_add_u32 s30, s30, 14336
    s_waitcnt vmcnt(10)
    s_mov_b32 s31, 0
K2_A3_8:
    ds_read2st64_b32 v[10:11], v9 offset0:0 offset1:4
    s_waitcnt lgkmcnt(0)
    v_max_u32 v10, v10, v11
    v_cmp_eq_u32 vcc, -1, v10
    s_nop 1
    s_cbranch_vccnz K2_A3_8_R
K2_A3_8_B:
    s_barrier
    s_add_u32 m0, s32, 22528
    s_nop 0
    buffer_load_dwordx4 v2, s[8:11], s28 offen sc1 lds
    buffer_load_dwordx4 v2, s[8:11], s29 offen offset:1024 sc1 lds
    s_add_u32 s28, s28, 1024
    s_add_u32 s29, s29, 1024
    s_add_u32 m0, s33, 22528
    s_nop 0
    buffer_load_dwordx4 v2, s[12:15], s30 offen offset:0 sc1 lds
    buffer_load_dwordx4 v2, s[12:15], s30 offen offset:1024 sc1 lds
    buffer_load_dwordx4 v2, s[12:15], s30 offen offset:2048 sc1 lds
    s_add_u32 s30, s30, 14336
    s_waitcnt vmcnt(10)
    s_mov_b32 s31, 0
K2_A3_9:
    ds_read2st64_b32 v[10:11], v9 offset0:88 offset1:92
    s_waitcnt lgkmcnt(0)
    v_max_u32 v10, v10, v11
    v_cmp_eq_u32 vcc, -1, v10
    s_nop 1
    s_cbranch_vccnz K2_A3_9_R
K2_A3_9_B:
    s_barrier
    s_add_u32 m0, s32, 45056
    s_nop 0
    buffer_load_dwordx4 v2, s[8:11], s28 offen sc1 lds
    buffer_load_dwordx4 v2, s[8:11], s29 offen offset:1024 sc1 lds
    s_add_u32 s28, s28, 1024
    s_add_u32 s29, s29, 1024
    s_add_u32 m0, s33, 45056
    s_nop 0
    buffer_load_dwordx4 v2, s[12:15], s30 offen offset:0 sc1 lds
    buffer_load_dwordx4 v2, s[12:15], s30 offen offset:1024 sc1 lds
    buffer_load_dwordx4 v2, s[12:15], s30 offen offset:2048 sc1 lds
    s_add_u32 s30, s30, 14336
    s_waitcnt vmcnt(10)
    s_mov_b32 s31, 0
K2_A3_10:
    ds_read2st64_b32 v[10:11], v8 offset0:0 offset1:4
    s_waitcnt lgkmcnt(0)
    v_max_u32 v10, v10, v11
    v_cmp_eq_u32 vcc, -1, v10
    s_nop 1
    s_cbranch_vccnz K2_A3_10_R
K2_A3_10_B:
    s_barrier
    s_add_u32 m0, s32, 67584
    s_nop 0
    buffer_load_dwordx4 v2, s[8:11], s28 offen sc1 lds
    buffer_load_dwordx4 v2, s[8:11], s29 offen offset:1024 sc1 lds
    s_add_u32 s28, s28, 1024
    s_add_u32 s29, s29, 1024
    s_add_u32 m0, s33, 67584
    s_nop 0
    buffer_load_dwordx4 v2, s[12:15], s30 offen offset:0 sc1 lds
    buffer_load_dwordx4 v2, s[12:15], s30 offen offset:1024 sc1 lds
    buffer_load_dwordx4 v2, s[12:15], s30 offen offset:2048 sc1 lds
    s_add_u32 s30, s30, 14336
    s_waitcnt vmcnt(10)
    s_mov_b32 s31, 0
K2_A3_11:
    ds_read2st64_b32 v[10:11], v8 offset0:88 offset1:92
    s_waitcnt lgkmcnt(0)
    v_max_u32 v10, v10, v11
    v_cmp_eq_u32 vcc, -1, v10
    s_nop 1
    s_cbranch_vccnz K2_A3_11_R
K2_A3_11_B:
    s_barrier
    s_add_u32 m0, s32, 90112
    s_nop 0
    buffer_load_dwordx4 v2, s[8:11], s28 offen sc1 lds
    buffer_load_dwordx4 v2, s[8:11], s29 offen offset:1024 sc1 lds
    s_add_u32 s28, s28, 1024
    s_add_u32 s29, s29, 1024
    s_add_u32 m0, s33, 90112
    s_nop 0
    buffer_load_dwordx4 v2, s[12:15], s30 offen offset:0 sc1 lds
    buffer_load_dwordx4 v2, s[12:15], s30 offen offset:1024 sc1 lds
    buffer_load_dwordx4 v2, s[12:15], s30 offen offset:2048 sc1 lds
    s_add_u32 s30, s30, 14336
    s_waitcnt vmcnt(10)
    s_mov_b32 s31, 0
K2_A3_12:
    ds_read2st64_b32 v[10:11], v8 offset0:176 offset1:180
    s_waitcnt lgkmcnt(0)
    v_max_u32 v10, v10, v11
    v_cmp_eq_u32 vcc, -1, v10
    s_nop 1
    s_cbranch_vccnz K2_A3_12_R
K2_A3_12_B:
    s_barrier
    s_add_u32 m0, s32, 0
    s_nop 0
    buffer_load_dwordx4 v2, s[8:11], s28 offen sc1 lds
    buffer_load_dwordx4 v2, s[8:11], s29 offen offset:1024 sc1 lds
    s_add_u32 s28, s28, 1024
    s_add_u32 s29, s29, 1024
    s_add_u32 m0, s33, 0
    s_nop 0
    buffer_load_dwordx4 v2, s[12:15], s30 offen offset:0 sc1 lds
    buffer_load_dwordx4 v2, s[12:15], s30 offen offset:1024 sc1 lds
    buffer_load_dwordx4 v2, s[12:15], s30 offen offset:2048 sc1 lds
    s_add_u32 s30, s30, 14336
    s_waitcnt vmcnt(10)
    s_mov_b32 s31, 0
K2_A3_13:
    ds_read2st64_b32 v[10:11], v9 offset0:0 offset1:4
    s_waitcnt lgkmcnt(0)
    v_max_u32 v10, v10, v11
    v_cmp_eq_u32 vcc, -1, v10
    s_nop 1
    s_cbranch_vccnz K2_A3_13_R
K2_A3_13_B:
    s_barrier
    s_add_u32 m0, s32, 22528
    s_nop 0
    buffer_load_dwordx4 v2, s[8:11], s28 offen sc1 lds
    buffer_load_dwordx4 v2, s[8:11], s29 offen offset:1024 sc1 lds
    s_add_u32 s28, s28, 1024
    s_add_u32 s29, s29, 1024
    s_add_u32 m0, s33, 22528
    s_nop 0
    buffer_load_dwordx4 v2, s[12:15], s30 offen offset:0 sc1 lds
    buffer_load_dwordx4 v2, s[12:15], s30 offen offset:1024 sc1 lds
    buffer_load_dwordx4 v2, s[12:15], s30 offen offset:2048 sc1 lds
    s_add_u32 s30, s30, 14336
    s_waitcnt vmcnt(10)
    s_mov_b32 s31, 0
K2_A3_14:
    ds_read2st64_b32 v[10:11], v9 offset0:88 offset1:92
    s_waitcnt lgkmcnt(0)
    v_max_u32 v10, v10, v11
    v_cmp_eq_u32 vcc, -1, v10
    s_nop 1
    s_cbranch_vccnz K2_A3_14_R
K2_A3_14_B:
    s_barrier
    s_add_u32 m0, s32, 45056
    s_nop 0
    buffer_load_dwordx4 v2, s[8:11], s28 offen sc1 lds
    buffer_load_dwordx4 v2, s[8:11], s29 offen offset:1024 sc1 lds
    s_add_u32 s28, s28, 1024
    s_add_u32 s29, s29, 1024
    s_add_u32 m0, s33, 45056
    s_nop 0
    buffer_load_dwordx4 v2, s[12:15], s30 offen offset:0 sc1 lds
    buffer_load_dwordx4 v2, s[12:15], s30 offen offset:1024 sc1 lds
    buffer_load_dwordx4 v2, s[12:15], s30 offen offset:2048 sc1 lds
    s_add_u32 s30, s30, 14336
    s_waitcnt vmcnt(10)
    s_mov_b32 s31, 0
K2_A3_15:
    ds_read2st64_b32 v[10:11], v8 offset0:0 offset1:4
    s_waitcnt lgkmcnt(0)
    v_max_u32 v10, v10, v11
    v_cmp_eq_u32 vcc, -1, v10
    s_nop 1
    s_cbranch_vccnz K2_A3_15_R
K2_A3_15_B:
    s_barrier
    s_add_u32 m0, s32, 67584
    s_nop 0
    buffer_load_dwordx4 v2, s[8:11], s28 offen sc1 lds
    buffer_load_dwordx4 v2, s[8:11], s29 offen offset:1024 sc1 lds
    s_add_u32 s28, s28, 1024
    s_add_u32 s29, s29, 1024
    s_add_u32 m0, s33, 67584
    s_nop 0
    buffer_load_dwordx4 v2, s[12:15], s30 offen offset:0 sc1 lds
    buffer_load_dwordx4 v2, s[12:15], s30 offen offset:1024 sc1 lds
    buffer_load_dwordx4 v2, s[12:15], s30 offen offset:2048 sc1 lds
    s_add_u32 s30, s30, 14336
    s_waitcnt vmcnt(10)
    s_mov_b32 s31, 0
K2_A3_16:
    ds_read2st64_b32 v[10:11], v8 offset0:88 offset1:92
    s_waitcnt lgkmcnt(0)
    v_max_u32 v10, v10, v11
    v_cmp_eq_u32 vcc, -1, v10
    s_nop 1
    s_cbranch_vccnz K2_A3_16_R
K2_A3_16_B:
    s_barrier
    s_add_u32 m0, s32, 90112
    s_nop 0
    buffer_load_dwordx4 v2, s[8:11], s28 offen sc1 lds
    buffer_load_dwordx4 v2, s[8:11], s29 offen offset:1024 sc1 lds
    s_add_u32 s28, s28, 1024
    s_add_u32 s29, s29, 1024
    s_add_u32 m0, s33, 90112
    s_nop 0
    buffer_load_dwordx4 v2, s[12:15], s30 offen offset:0 sc1 lds
    buffer_load_dwordx4 v2, s[12:15], s30 offen offset:1024 sc1 lds
    buffer_load_dwordx4 v2, s[12:15], s30 offen offset:2048 sc1 lds
    s_add_u32 s30, s30, 14336
    s_add_u32 m0, s38, 0
    s_nop 0
    buffer_load_dwordx4 v2, s[24:27], s37 offen offset:0 sc1 lds
    s_add_u32 m0, s38, 0
    s_nop 0
    buffer_load_dwordx4 v2, s[24:27], s37 offen offset:1024 sc1 lds
    s_add_u32 m0, s38, 0
    s_nop 0
    buffer_load_dwordx4 v2, s[24:27], s37 offen offset:2048 sc1 lds
    s_add_u32 m0, s38, 0
    s_nop 0
    buffer_load_dwordx4 v2, s[24:27], s37 offen offset:3072 sc1 lds
    s_add_u32 s37, s37, 4096
    s_waitcnt vmcnt(14)
    s_mov_b32 s31, 0
K2_A3_17:
    ds_read2st64_b32 v[10:11], v8 offset0:176 offset1:180
    s_waitcnt lgkmcnt(0)
    v_max_u32 v10, v10, v11
    v_cmp_eq_u32 vcc, -1, v10
    s_nop 1
    s_cbranch_vccnz K2_A3_17_R
K2_A3_17_B:
    s_barrier
    s_add_u32 m0, s38, 4096
    s_nop 0
    buffer_load_dwordx4 v2, s[24:27], s37 offen offset:0 sc1 lds
    s_add_u32 m0, s38, 4096
    s_nop 0
    buffer_load_dwordx4 v2, s[24:27], s37 offen offset:1024 sc1 lds
    s_add_u32 m0, s38, 4096
    s_nop 0
    buffer_load_dwordx4 v2, s[24:27], s37 offen offset:2048 sc1 lds
    s_add_u32 m0, s38, 4096
    s_nop 0
    buffer_load_dwordx4 v2, s[24:27], s37 offen offset:3072 sc1 lds
    s_add_u32 s37, s37, 4096
    s_add_u32 m0, s38, 8192
    s_nop 0
    buffer_load_dwordx4 v2, s[24:27], s37 offen offset:0 sc1 lds
    s_add_u32 m0, s38, 8192
    s_nop 0
    buffer_load_dwordx4 v2, s[24:27], s37 offen offset:1024 sc1 lds
    s_waitcnt vmcnt(15)
    s_mov_b32 s31, 0
K2_A3_18:
    ds_read2st64_b32 v[10:11], v9 offset0:0 offset1:4
    s_waitcnt lgkmcnt(0)
    v_max_u32 v10, v10, v11
    v_cmp_eq_u32 vcc, -1, v10
    s_nop 1
    s_cbranch_vccnz K2_A3_18_R
K2_A3_18_B:
    s_barrier
    s_add_u32 m0, s38, 8192
    s_nop 0
    buffer_load_dwordx4 v2, s[24:27], s37 offen offset:2048 sc1 lds
    s_add_u32 m0, s38, 8192
    s_nop 0
    buffer_load_dwordx4 v2, s[24:27], s37 offen offset:3072 sc1 lds
    s_add_u32 s37, s37, 4096
    s_add_u32 m0, s39, 0
    s_nop 0
    buffer_load_dwordx4 v2, s[24:27], s37 offen offset:0 sc1 lds
    s_add_u32 m0, s39, 0
    s_nop 0
    buffer_load_dwordx4 v2, s[24:27], s37 offen offset:1024 sc1 lds
    s_add_u32 m0, s39, 0
    s_nop 0
    buffer_load_dwordx4 v2, s[24:27], s37 offen offset:2048 sc1 lds
    s_add_u32 m0, s39, 0
    s_nop 0
    buffer_load_dwordx4 v2, s[24:27], s37 offen offset:3072 sc1 lds
    s_add_u32 s37, s37, 4096
    s_waitcnt vmcnt(16)
    s_mov_b32 s31, 0
K2_A3_19:
    ds_read2st64_b32 v[10:11], v9 offset0:88 offset1:92
    s_waitcnt lgkmcnt(0)
    v_max_u32 v10, v10, v11
    v_cmp_eq_u32 vcc, -1, v10
    s_nop 1
    s_cbranch_vccnz K2_A3_19_R
K2_A3_19_B:
    s_barrier
    s_add_u32 m0, s39, 4096
    s_nop 0
    buffer_load_dwordx4 v2, s[24:27], s37 offen offset:0 sc1 lds
    s_sub_u32 m0, s58, 1024
    s_nop 0
    buffer_load_dwordx4 v2, s[24:27], s37 offen offset:1024 sc1 lds
    s_sub_u32 m0, s58, 1024
    s_nop 0
    buffer_load_dwordx4 v2, s[24:27], s37 offen offset:2048 sc1 lds
    s_sub_u32 m0, s58, 1024
    s_nop 0
    buffer_load_dwordx4 v2, s[24:27], s37 offen offset:3072 sc1 lds
    s_add_u32 s37, s37, 4096
    s_branch K2_L2
K2_A3_0_R:
    s_add_u32 s31, s31, 1
    s_cmp_gt_u32 s31, 4000
    s_cbranch_scc1 K2_A3_0_B
    s_sub_u32 s34, s28, 3072
    s_sub_u32 s35, s29, 3072
    s_add_u32 m0, s32, 0
    s_nop 0
    buffer_load_dwordx4 v2, s[8:11], s34 offen sc1 lds
    buffer_load_dwordx4 v2, s[8:11], s35 offen offset:1024 sc1 lds
    s_sub_u32 s34, s28, 2048
    s_sub_u32 s35, s29, 2048
    s_add_u32 m0, s32, 22528
    s_nop 0
    buffer_load_dwordx4 v2, s[8:11], s34 offen sc1 lds
    buffer_load_dwordx4 v2, s[8:11], s35 offen offset:1024 sc1 lds
    s_sub_u32 s34, s28, 1024
    s_sub_u32 s35, s29, 1024
    s_add_u32 m0, s32, 45056
    s_nop 0
    buffer_load_dwordx4 v2, s[8:11], s34 offen sc1 lds
    buffer_load_dwordx4 v2, s[8:11], s35 offen offset:1024 sc1 lds
    s_waitcnt vmcnt(4)
    s_branch K2_A3_0
K2_A3_1_R:
    s_add_u32 s31, s31, 1
    s_cmp_gt_u32 s31, 4000
    s_cbranch_scc1 K2_A3_1_B
    s_sub_u32 s34, s28, 3072
    s_sub_u32 s35, s29, 3072
    s_add_u32 m0, s32, 22528
    s_nop 0
    buffer_load_dwordx4 v2, s[8:11], s34 offen sc1 lds
    buffer_load_dwordx4 v2, s[8:11], s35 offen offset:1024 sc1 lds
    s_waitcnt vmcnt(0)
    s_branch K2_A3_1
K2_A3_2_R:
    s_add_u32 s31, s31, 1
    s_cmp_gt_u32 s31, 4000
    s_cbranch_scc1 K2_A3_2_B
    s_sub_u32 s34, s28, 3072
    s_sub_u32 s35, s29, 3072
    s_add_u32 m0, s32, 45056
    s_nop 0
    buffer_load_dwordx4 v2, s[8:11], s34 offen sc1 lds
    buffer_load_dwordx4 v2, s[8:11], s35 offen offset:1024 sc1 lds
    s_waitcnt vmcnt(0)
    s_branch K2_A3_2
K2_A3_3_R:
    s_add_u32 s31, s31, 1
    s_cmp_gt_u32 s31, 4000
    s_cbranch_scc1 K2_A3_3_B
    s_sub_u32 s34, s28, 3072
    s_sub_u32 s35, s29, 3072
    s_add_u32 m0, s32, 67584
    s_nop 0
    buffer_load_dwordx4 v2, s[8:11], s34 offen sc1 lds
    buffer_load_dwordx4 v2, s[8:11], s35 offen offset:1024 sc1 lds
    s_waitcnt vmcnt(0)
    s_branch K2_A3_3
K2_A3_4_R:
    s_add_u32 s31, s31, 1
    s_cmp_gt_u32 s31, 4000
    s_cbranch_scc1 K2_A3_4_B
    s_sub_u32 s34, s28, 3072
    s_sub_u32 s35, s29, 3072
    s_add_u32 m0, s32, 90112
    s_nop 0
    buffer_load_dwordx4 v2, s[8:11], s34 offen sc1 lds
    buffer_load_dwordx4 v2, s[8:11], s35 offen offset:1024 sc1 lds
    s_waitcnt vmcnt(0)
    s_branch K2_A3_4
K2_A3_5_R:
    s_add_u32 s31, s31, 1
    s_cmp_gt_u32 s31, 4000
    s_cbranch_scc1 K2_A3_5_B
    s_sub_u32 s34, s28, 3072
    s_sub_u32 s35, s29, 3072
    s_add_u32 m0, s32, 0
    s_nop 0
    buffer_load_dwordx4 v2, s[8:11], s34 offen sc1 lds
    buffer_load_dwordx4 v2, s[8:11], s35 offen offset:1024 sc1 lds
    s_waitcnt vmcnt(0)
    s_branch K2_A3_5
K2_A3_6_R:
    s_add_u32 s31, s31, 1
    s_cmp_gt_u32 s31, 4000
    s_cbranch_scc1 K2_A3_6_B
    s_sub_u32 s34, s28, 3072
    s_sub_u32 s35, s29, 3072
    s_add_u32 m0, s32, 22528
    s_nop 0
    buffer_load_dwordx4 v2, s[8:11], s34 offen sc1 lds
    buffer_load_dwordx4 v2, s[8:11], s35 offen offset:1024 sc1 lds
    s_waitcnt vmcnt(0)
    s_branch K2_A3_6
K2_A3_7_R:
    s_add_u32 s31, s31, 1
    s_cmp_gt_u32 s31, 4000
    s_cbranch_scc1 K2_A3_7_B
    s_sub_u32 s34, s28, 3072
    s_sub_u32 s35, s29, 3072
    s_add_u32 m0, s32, 45056
    s_nop 0
    buffer_load_dwordx4 v2, s[8:11], s34 offen sc1 lds
    buffer_load_dwordx4 v2, s[8:11], s35 offen offset:1024 sc1 lds
    s_waitcnt vmcnt(0)
    s_branch K2_A3_7
K2_A3_8_R:
    s_add_u32 s31, s31, 1
    s_cmp_gt_u32 s31, 4000
    s_cbranch_scc1 K2_A3_8_B
    s_sub_u32 s34, s28, 3072
    s_sub_u32 s35, s29, 3072
    s_add_u32 m0, s32, 67584
    s_nop 0
    buffer_load_dwordx4 v2, s[8:11], s34 offen sc1 lds
    buffer_load_dwordx4 v2, s[8:11], s35 offen offset:1024 sc1 lds
    s_waitcnt vmcnt(0)
    s_branch K2_A3_8
K2_A3_9_R:
    s_add_u32 s31, s31, 1
    s_cmp_gt_u32 s31, 4000
    s_cbranch_scc1 K2_A3_9_B
    s_sub_u32 s34, s28, 3072
    s_sub_u32 s35, s29, 3072
    s_add_u32 m0, s32, 90112
    s_nop 0
    buffer_load_dwordx4 v2, s[8:11], s34 offen sc1 lds
    buffer_load_dwordx4 v2, s[8:11], s35 offen offset:1024 sc1 lds
    s_waitcnt vmcnt(0)
    s_branch K2_A3_9
K2_A3_10_R:
    s_add_u32 s31, s31, 1
    s_cmp_gt_u32 s31, 4000
    s_cbranch_scc1 K2_A3_10_B
    s_sub_u32 s34, s28, 3072
    s_sub_u32 s35, s29, 3072
    s_add_u32 m0, s32, 0
    s_nop 0
    buffer_load_dwordx4 v2, s[8:11], s34 offen sc1 lds
    buffer_load_dwordx4 v2, s[8:11], s35 offen offset:1024 sc1 lds
    s_waitcnt vmcnt(0)
    s_branch K2_A3_10
K2_A3_11_R:
    s_add_u32 s31, s31, 1
    s_cmp_gt_u32 s31, 4000
    s_cbranch_scc1 K2_A3_11_B
    s_sub_u32 s34, s28, 3072
    s_sub_u32 s35, s29, 3072
    s_add_u32 m0, s32, 22528
    s_nop 0
    buffer_load_dwordx4 v2, s[8:11], s34 offen sc1 lds
    buffer_load_dwordx4 v2, s[8:11], s35 offen offset:1024 sc1 lds
    s_waitcnt vmcnt(0)
    s_branch K2_A3_11
K2_A3_12_R:
    s_add_u32 s31, s31, 1
    s_cmp_gt_u32 s31, 4000
    s_cbranch_scc1 K2_A3_12_B
    s_sub_u32 s34, s28, 3072
    s_sub_u32 s35, s29, 3072
    s_add_u32 m0, s32, 45056
    s_nop 0
    buffer_load_dwordx4 v2, s[8:11], s34 offen sc1 lds
    buffer_load_dwordx4 v2, s[8:11], s35 offen offset:1024 sc1 lds
    s_waitcnt vmcnt(0)
    s_branch K2_A3_12
K2_A3_13_R:
    s_add_u32 s31, s31, 1
    s_cmp_gt_u32 s31, 4000
    s_cbranch_scc1 K2_A3_13_B
    s_sub_u32 s34, s28, 3072
    s_sub_u32 s35, s29, 3072
    s_add_u32 m0, s32, 67584
    s_nop 0
    buffer_load_dwordx4 v2, s[8:11], s34 offen sc1 lds
    buffer_load_dwordx4 v2, s[8:11], s35 offen offset:1024 sc1 lds
    s_waitcnt vmcnt(0)
    s_branch K2_A3_13
K2_A3_14_R:
    s_add_u32 s31, s31, 1
    s_cmp_gt_u32 s31, 4000
    s_cbranch_scc1 K2_A3_14_B
    s_sub_u32 s34, s28, 3072
    s_sub_u32 s35, s29, 3072
    s_add_u32 m0, s32, 90112
    s_nop 0
    buffer_load_dwordx4 v2, s[8:11], s34 offen sc1 lds
    buffer_load_dwordx4 v2, s[8:11], s35 offen offset:1024 sc1 lds
    s_waitcnt vmcnt(0)
    s_branch K2_A3_14
K2_A3_15_R:
    s_add_u32 s31, s31, 1
    s_cmp_gt_u32 s31, 4000
    s_cbranch_scc1 K2_A3_15_B
    s_sub_u32 s34, s28, 3072
    s_sub_u32 s35, s29, 3072
    s_add_u32 m0, s32, 0
    s_nop 0
    buffer_load_dwordx4 v2, s[8:11], s34 offen sc1 lds
    buffer_load_dwordx4 v2, s[8:11], s35 offen offset:1024 sc1 lds
    s_waitcnt vmcnt(0)
    s_branch K2_A3_15
K2_A3_16_R:
    s_add_u32 s31, s31, 1
    s_cmp_gt_u32 s31, 4000
    s_cbranch_scc1 K2_A3_16_B
    s_sub_u32 s34, s28, 3072
    s_sub_u32 s35, s29, 3072
    s_add_u32 m0, s32, 22528
    s_nop 0
    buffer_load_dwordx4 v2, s[8:11], s34 offen sc1 lds
    buffer_load_dwordx4 v2, s[8:11], s35 offen offset:1024 sc1 lds
    s_waitcnt vmcnt(0)
    s_branch K2_A3_16
K2_A3_17_R:
    s_add_u32 s31, s31, 1
    s_cmp_gt_u32 s31, 4000
    s_cbranch_scc1 K2_A3_17_B
    s_sub_u32 s34, s28, 3072
    s_sub_u32 s35, s29, 3072
    s_add_u32 m0, s32, 45056
    s_nop 0
    buffer_load_dwordx4 v2, s[8:11], s34 offen sc1 lds
    buffer_load_dwordx4 v2, s[8:11], s35 offen offset:1024 sc1 lds
    s_waitcnt vmcnt(0)
    s_branch K2_A3_17
K2_A3_18_R:
    s_add_u32 s31, s31, 1
    s_cmp_gt_u32 s31, 4000
    s_cbranch_scc1 K2_A3_18_B
    s_sub_u32 s34, s28, 2048
    s_sub_u32 s35, s29, 2048
    s_add_u32 m0, s32, 67584
    s_nop 0
    buffer_load_dwordx4 v2, s[8:11], s34 offen sc1 lds
    buffer_load_dwordx4 v2, s[8:11], s35 offen offset:1024 sc1 lds
    s_waitcnt vmcnt(0)
    s_branch K2_A3_18
K2_A3_19_R:
    s_add_u32 s31, s31, 1
    s_cmp_gt_u32 s31, 4000
    s_cbranch_scc1 K2_A3_19_B
    s_sub_u32 s34, s28, 1024
    s_sub_u32 s35, s29, 1024
    s_add_u32 m0, s32, 90112
    s_nop 0
    buffer_load_dwordx4 v2, s[8:11], s34 offen sc1 lds
    buffer_load_dwordx4 v2, s[8:11], s35 offen offset:1024 sc1 lds
    s_waitcnt vmcnt(0)
    s_branch K2_A3_19
K2_L2:
    s_setprio 1
    v_mov_b32 v7, 1
    s_waitcnt vmcnt(0)
    ds_write_b32 v1, v7
    v_mov_b32 v1, 161792
    s_mov_b32 s34, 0
K2_LW:
    ds_read_b128 v[8:11], v1 offset:32
    s_add_u32 s34, s34, 1
    s_cmp_gt_u32 s34, 256000
    s_cbranch_scc1 K2_LW_X
    s_waitcnt lgkmcnt(0)
    v_and_b32 v8, v8, v9
    v_and_b32 v10, v10, v11
    v_and_b32 v8, v8, v10
    v_cmp_eq_u32 vcc, 0, v8
    s_nop 1
    s_cbranch_vccnz K2_LW
K2_LW_X:
    s_waitcnt lgkmcnt(0)
    buffer_load_dwordx4 v[8:11], v2, s[20:23], s40 offen offset:0 sc1
    buffer_load_dwordx4 v[16:19], v2, s[20:23], s40 offen offset:1024 sc1
    buffer_load_dwordx4 v[12:15], v2, s[20:23], s40 offen offset:2048 sc1
    buffer_load_dwordx4 v[20:23], v2, s[20:23], s40 offen offset:3072 sc1
    s_add_u32 s40, s40, 4096
    buffer_load_dwordx4 v[24:27], v2, s[20:23], s40 offen offset:0 sc1
    buffer_load_dwordx4 v[32:35], v2, s[20:23], s40 offen offset:1024 sc1
    buffer_load_dwordx4 v[28:31], v2, s[20:23], s40 offen offset:2048 sc1
    buffer_load_dwordx4 v[36:39], v2, s[20:23], s40 offen offset:3072 sc1
    s_add_u32 s40, s40, 4096
    buffer_load_dwordx4 v[40:43], v2, s[20:23], s40 offen offset:0 sc1
    buffer_load_dwordx4 v[48:51], v2, s[20:23], s40 offen offset:1024 sc1
    buffer_load_dwordx4 v[44:47], v2, s[20:23], s40 offen offset:2048 sc1
    buffer_load_dwordx4 v[52:55], v2, s[20:23], s40 offen offset:3072 sc1
    s_add_u32 s40, s40, 4096
    s_lshl_b32 s34, s56, 2
    s_add_u32 s34, s34, s7
    s_lshl_b32 s42, s34, 6
    v_and_b32 v5, 15, v3
    v_lshlrev_b32 v5, 2, v5
    s_mul_i32 s43, s34, 20480
    s_mul_i32 s35, s57, 160
    s_add_u32 s43, s43, s35
    s_waitcnt vmcnt(8)
    v_max3_u32 v4, v8, v12, v16
    v_max_u32 v4, v4, v20
    v_cmp_eq_u32 vcc, -1, v4
    s_nop 1
    s_cbranch_vccnz K2_HL_0_R
K2_HL_0_B:
    v_swap_b32 v10, v12
    v_swap_b32 v11, v13
    v_swap_b32 v18, v20
    v_swap_b32 v19, v21
    v_mfma_f32_16x16x32_bf16 a[0:3], v[56:59], v[8:11], 0
    v_mfma_f32_16x16x32_bf16 a[20:23], v[56:59], v[12:15], 0
    v_mfma_f32_16x16x32_bf16 a[40:43], v[56:59], v[16:19], 0
    v_mfma_f32_16x16x32_bf16 a[60:63], v[56:59], v[20:23], 0
    v_mfma_f32_16x16x32_bf16 a[4:7], v[60:63], v[8:11], 0
    v_mfma_f32_16x16x32_bf16 a[24:27], v[60:63], v[12:15], 0
    v_mfma_f32_16x16x32_bf16 a[44:47], v[60:63], v[16:19], 0
    v_mfma_f32_16x16x32_bf16 a[64:67], v[60:63], v[20:23], 0
    v_mfma_f32_16x16x32_bf16 a[8:11], v[64:67], v[8:11], 0
    v_mfma_f32_16x16x32_bf16 a[28:31], v[64:67], v[12:15], 0
    v_mfma_f32_16x16x32_bf16 a[48:51], v[64:67], v[16:19], 0
    v_mfma_f32_16x16x32_bf16 a[68:71], v[64:67], v[20:23], 0
    v_mfma_f32_16x16x32_bf16 a[12:15], v[68:71], v[8:11], 0
    s_waitcnt vmcnt(4)
    v_max3_u32 v4, v24, v28, v32
    v_mfma_f32_16x16x32_bf16 a[32:35], v[68:71], v[12:15], 0
    v_max_u32 v4, v4, v36
    v_mfma_f32_16x16x32_bf16 a[52:55], v[68:71], v[16:19], 0
    v_cmp_eq_u32 vcc, -1, v4
    s_nop 1
    s_cbranch_vccnz K2_HL_1_R
K2_HL_1_B:
    v_mfma_f32_16x16x32_bf16 a[72:75], v[68:71], v[20:23], 0
    v_swap_b32 v26, v28
    v_mfma_f32_16x16x32_bf16 a[16:19], v[72:75], v[8:11], 0
    v_swap_b32 v27, v29
    v_mfma_f32_16x16x32_bf16 a[36:39], v[72:75], v[12:15], 0
    v_swap_b32 v34, v36
    v_mfma_f32_16x16x32_bf16 a[56:59], v[72:75], v[16:19], 0
    v_swap_b32 v35, v37
    v_mfma_f32_16x16x32_bf16 a[76:79], v[72:75], v[20:23], 0
    v_mfma_f32_16x16x32_bf16 a[0:3], v[76:79], v[24:27], a[0:3]
    buffer_load_dwordx4 v[56:59], v2, s[20:23], s40 offen offset:0 sc1
    v_mfma_f32_16x16x32_bf16 a[20:23], v[76:79], v[28:31], a[20:23]
    buffer_load_dwordx4 v[64:67], v2, s[20:23], s40 offen offset:1024 sc1
    v_mfma_f32_16x16x32_bf16 a[40:43], v[76:79], v[32:35], a[40:43]
    buffer_load_dwordx4 v[60:63], v2, s[20:23], s40 offen offset:2048 sc1
    v_mfma_f32_16x16x32_bf16 a[60:63], v[76:79], v[36:39], a[60:63]
    buffer_load_dwordx4 v[68:71], v2, s[20:23], s40 offen offset:3072 sc1
    s_add_u32 s40, s40, 4096
    v_mfma_f32_16x16x32_bf16 a[4:7], v[80:83], v[24:27], a[4:7]
    buffer_load_dwordx4 v[8:11], v2, s[20:23], s40 offen offset:0 sc1
    v_mfma_f32_16x16x32_bf16 a[24:27], v[80:83], v[28:31], a[24:27]
    buffer_load_dwordx4 v[16:19], v2, s[20:23], s40 offen offset:1024 sc1
    v_mfma_f32_16x16x32_bf16 a[44:47], v[80:83], v[32:35], a[44:47]
    buffer_load_dwordx4 v[12:15], v2, s[20:23], s40 offen offset:2048 sc1
    v_mfma_f32_16x16x32_bf16 a[64:67], v[80:83], v[36:39], a[64:67]
    buffer_load_dwordx4 v[20:23], v2, s[20:23], s40 offen offset:3072 sc1
    s_add_u32 s40, s40, 4096
    v_mfma_f32_16x16x32_bf16 a[8:11], v[84:87], v[24:27], a[8:11]
    buffer_load_dwordx4 v[72:75], v2, s[24:27], s36 offen offset:1024 sc1
    v_mfma_f32_16x16x32_bf16 a[28:31], v[84:87], v[28:31], a[28:31]
    v_mfma_f32_16x16x32_bf16 a[48:51], v[84:87], v[32:35], a[48:51]
    v_mfma_f32_16x16x32_bf16 a[68:71], v[84:87], v[36:39], a[68:71]
    v_mfma_f32_16x16x32_bf16 a[12:15], v[88:91], v[24:27], a[12:15]
    s_waitcnt vmcnt(9)
    v_max3_u32 v4, v40, v44, v48
    v_mfma_f32_16x16x32_bf16 a[32:35], v[88:91], v[28:31], a[32:35]
    v_max_u32 v4, v4, v52
    v_mfma_f32_16x16x32_bf16 a[52:55], v[88:91], v[32:35], a[52:55]
    v_cmp_eq_u32 vcc, -1, v4
    s_nop 1
    s_cbranch_vccnz K2_HL_2_R
K2_HL_2_B:
    v_mfma_f32_16x16x32_bf16 a[72:75], v[88:91], v[36:39], a[72:75]
    v_swap_b32 v42, v44
    v_mfma_f32_16x16x32_bf16 a[16:19], v[92:95], v[24:27], a[16:19]
    v_swap_b32 v43, v45
    v_mfma_f32_16x16x32_bf16 a[36:39], v[92:95], v[28:31], a[36:39]
    v_swap_b32 v50, v52
    v_mfma_f32_16x16x32_bf16 a[56:59], v[92:95], v[32:35], a[56:59]
    v_swap_b32 v51, v53
    v_mfma_f32_16x16x32_bf16 a[76:79], v[92:95], v[36:39], a[76:79]
    v_mfma_f32_16x16x32_bf16 a[0:3], v[96:99], v[40:43], a[0:3]
    buffer_load_dwordx4 v[24:27], v2, s[20:23], s40 offen offset:0 sc1
    v_mfma_f32_16x16x32_bf16 a[20:23], v[96:99], v[44:47], a[20:23]
    buffer_load_dwordx4 v[32:35], v2, s[20:23], s40 offen offset:1024 sc1
    v_mfma_f32_16x16x32_bf16 a[40:43], v[96:99], v[48:51], a[40:43]
    buffer_load_dwordx4 v[28:31], v2, s[20:23], s40 offen offset:2048 sc1
    v_mfma_f32_16x16x32_bf16 a[60:63], v[96:99], v[52:55], a[60:63]
    buffer_load_dwordx4 v[36:39], v2, s[20:23], s40 offen offset:3072 sc1
    s_add_u32 s40, s40, 4096
    v_mfma_f32_16x16x32_bf16 a[4:7], v[100:103], v[40:43], a[4:7]
    buffer_load_dword v6, v5, s[16:19], s42 offen sc1
    v_mfma_f32_16x16x32_bf16 a[24:27], v[100:103], v[44:47], a[24:27]
    v_mfma_f32_16x16x32_bf16 a[44:47], v[100:103], v[48:51], a[44:47]
    v_mfma_f32_16x16x32_bf16 a[64:67], v[100:103], v[52:55], a[64:67]
    v_mfma_f32_16x16x32_bf16 a[8:11], v[104:107], v[40:43], a[8:11]
    v_mfma_f32_16x16x32_bf16 a[28:31], v[104:107], v[44:47], a[28:31]
    v_mfma_f32_16x16x32_bf16 a[48:51], v[104:107], v[48:51], a[48:51]
    v_mfma_f32_16x16x32_bf16 a[68:71], v[104:107], v[52:55], a[68:71]
    v_mfma_f32_16x16x32_bf16 a[12:15], v[108:111], v[40:43], a[12:15]
    s_waitcnt vmcnt(10)
    v_max3_u32 v4, v56, v60, v64
    v_mfma_f32_16x16x32_bf16 a[32:35], v[108:111], v[44:47], a[32:35]
    v_max_u32 v4, v4, v68
    v_mfma_f32_16x16x32_bf16 a[52:55], v[108:111], v[48:51], a[52:55]
    v_cmp_eq_u32 vcc, -1, v4
    s_nop 1
    s_cbranch_vccnz K2_HL_3_R
K2_HL_3_B:
    v_mfma_f32_16x16x32_bf16 a[72:75], v[108:111], v[52:55], a[72:75]
    v_swap_b32 v58, v60
    v_mfma_f32_16x16x32_bf16 a[16:19], v[116:119], v[40:43], a[16:19]
    v_swap_b32 v59, v61
    v_mfma_f32_16x16x32_bf16 a[36:39], v[116:119], v[44:47], a[36:39]
    v_swap_b32 v66, v68
    v_mfma_f32_16x16x32_bf16 a[56:59], v[116:119], v[48:51], a[56:59]
    v_swap_b32 v67, v69
    v_mfma_f32_16x16x32_bf16 a[76:79], v[116:119], v[52:55], a[76:79]
    v_mfma_f32_16x16x32_bf16 a[0:3], v[120:123], v[56:59], a[0:3]
    v_mfma_f32_16x16x32_bf16 a[20:23], v[120:123], v[60:63], a[20:23]
    v_mfma_f32_16x16x32_bf16 a[40:43], v[120:123], v[64:67], a[40:43]
    v_mfma_f32_16x16x32_bf16 a[60:63], v[120:123], v[68:71], a[60:63]
    v_mfma_f32_16x16x32_bf16 a[4:7], v[124:127], v[56:59], a[4:7]
    s_waitcnt vmcnt(6)
    v_max3_u32 v4, v8, v12, v16
    v_mfma_f32_16x16x32_bf16 a[24:27], v[124:127], v[60:63], a[24:27]
    v_max_u32 v4, v4, v20
    v_mfma_f32_16x16x32_bf16 a[44:47], v[124:127], v[64:67], a[44:47]
    v_cmp_eq_u32 vcc, -1, v4
    s_nop 1
    s_cbranch_vccnz K2_HL_4_R
K2_HL_4_B:
    v_mfma_f32_16x16x32_bf16 a[64:67], v[124:127], v[68:71], a[64:67]
    v_swap_b32 v10, v12
    v_mfma_f32_16x16x32_bf16 a[8:11], a[80:83], v[56:59], a[8:11]
    v_swap_b32 v11, v13
    v_mfma_f32_16x16x32_bf16 a[28:31], a[80:83], v[60:63], a[28:31]
    v_swap_b32 v18, v20
    v_mfma_f32_16x16x32_bf16 a[48:51], a[80:83], v[64:67], a[48:51]
    v_swap_b32 v19, v21
    v_mfma_f32_16x16x32_bf16 a[68:71], a[80:83], v[68:71], a[68:71]
    v_mfma_f32_16x16x32_bf16 a[12:15], a[84:87], v[56:59], a[12:15]
    s_waitcnt vmcnt(1)
    v_max3_u32 v4, v24, v28, v32
    v_mfma_f32_16x16x32_bf16 a[32:35], a[84:87], v[60:63], a[32:35]
    v_max_u32 v4, v4, v36
    v_mfma_f32_16x16x32_bf16 a[52:55], a[84:87], v[64:67], a[52:55]
    v_cmp_eq_u32 vcc, -1, v4
    s_nop 1
    s_cbranch_vccnz K2_HL_5_R
K2_HL_5_B:
    v_mfma_f32_16x16x32_bf16 a[72:75], a[84:87], v[68:71], a[72:75]
    v_swap_b32 v26, v28
    v_mfma_f32_16x16x32_bf16 a[16:19], a[88:91], v[56:59], a[16:19]
    v_swap_b32 v27, v29
    v_mfma_f32_16x16x32_bf16 a[36:39], a[88:91], v[60:63], a[36:39]
    v_swap_b32 v34, v36
    v_mfma_f32_16x16x32_bf16 a[56:59], a[88:91], v[64:67], a[56:59]
    v_swap_b32 v35, v37
    v_mfma_f32_16x16x32_bf16 a[76:79], a[88:91], v[68:71], a[76:79]
    s_cmp_lg_u32 s7, 0
    s_cbranch_scc1 K2_LF1
    s_setprio 1
    v_mfma_f32_16x16x32_bf16 a[0:3], a[92:95], v[8:11], a[0:3]
    v_mfma_f32_16x16x32_bf16 a[20:23], a[92:95], v[12:15], a[20:23]
    v_mfma_f32_16x16x32_bf16 a[40:43], a[92:95], v[16:19], a[40:43]
    v_mfma_f32_16x16x32_bf16 a[60:63], a[92:95], v[20:23], a[60:63]
    v_mfma_f32_16x16x32_bf16 a[0:3], a[112:115], v[24:27], a[0:3]
    v_mfma_f32_16x16x32_bf16 a[20:23], a[112:115], v[28:31], a[20:23]
    v_mfma_f32_16x16x32_bf16 a[40:43], a[112:115], v[32:35], a[40:43]
    v_mfma_f32_16x16x32_bf16 a[60:63], a[112:115], v[36:39], a[60:63]
    v_mfma_f32_16x16x32_bf16 a[4:7], a[96:99], v[8:11], a[4:7]
    v_mfma_f32_16x16x32_bf16 a[24:27], a[96:99], v[12:15], a[24:27]
    v_mfma_f32_16x16x32_bf16 a[44:47], a[96:99], v[16:19], a[44:47]
    v_mfma_f32_16x16x32_bf16 a[64:67], a[96:99], v[20:23], a[64:67]
    v_mfma_f32_16x16x32_bf16 a[4:7], a[116:119], v[24:27], a[4:7]
    ds_write_b128 v2, a[0:3] offset:45056
    v_mfma_f32_16x16x32_bf16 a[24:27], a[116:119], v[28:31], a[24:27]
    ds_write_b128 v2, a[20:23] offset:47104
    v_mfma_f32_16x16x32_bf16 a[44:47], a[116:119], v[32:35], a[44:47]
    ds_write_b128 v2, a[40:43] offset:52224
    v_mfma_f32_16x16x32_bf16 a[64:67], a[116:119], v[36:39], a[64:67]
    ds_write_b128 v2, a[60:63] offset:57344
    v_mfma_f32_16x16x32_bf16 a[28:31], a[100:103], v[12:15], a[28:31]
    v_mfma_f32_16x16x32_bf16 a[48:51], a[100:103], v[16:19], a[48:51]
    v_mfma_f32_16x16x32_bf16 a[68:71], a[100:103], v[20:23], a[68:71]
    v_mfma_f32_16x16x32_bf16 a[8:11], a[100:103], v[8:11], a[8:11]
    v_mfma_f32_16x16x32_bf16 a[28:31], a[120:123], v[28:31], a[28:31]
    ds_write_b128 v2, a[4:7] offset:46080
    v_mfma_f32_16x16x32_bf16 a[48:51], a[120:123], v[32:35], a[48:51]
    ds_write_b128 v2, a[24:27] offset:48128
    v_mfma_f32_16x16x32_bf16 a[68:71], a[120:123], v[36:39], a[68:71]
    ds_write_b128 v2, a[44:47] offset:53248
    v_mfma_f32_16x16x32_bf16 a[8:11], a[120:123], v[24:27], a[8:11]
    ds_write_b128 v2, a[64:67] offset:58368
    v_mfma_f32_16x16x32_bf16 a[32:35], a[104:107], v[12:15], a[32:35]
    v_mfma_f32_16x16x32_bf16 a[52:55], a[104:107], v[16:19], a[52:55]
    v_mfma_f32_16x16x32_bf16 a[72:75], a[104:107], v[20:23], a[72:75]
    v_mfma_f32_16x16x32_bf16 a[12:15], a[104:107], v[8:11], a[12:15]
    v_mfma_f32_16x16x32_bf16 a[32:35], a[124:127], v[28:31], a[32:35]
    ds_write_b128 v2, a[28:31] offset:49152
    v_mfma_f32_16x16x32_bf16 a[52:55], a[124:127], v[32:35], a[52:55]
    ds_write_b128 v2, a[48:51] offset:54272
    v_mfma_f32_16x16x32_bf16 a[72:75], a[124:127], v[36:39], a[72:75]
    ds_write_b128 v2, a[68:71] offset:59392
    v_mfma_f32_16x16x32_bf16 a[12:15], a[124:127], v[24:27], a[12:15]
    v_mfma_f32_16x16x32_bf16 a[36:39], a[108:111], v[12:15], a[36:39]
    v_mfma_f32_16x16x32_bf16 a[56:59], a[108:111], v[16:19], a[56:59]
    v_mfma_f32_16x16x32_bf16 a[76:79], a[108:111], v[20:23], a[76:79]
    v_mfma_f32_16x16x32_bf16 a[16:19], a[108:111], v[8:11], a[16:19]
    v_mfma_f32_16x16x32_bf16 a[36:39], v[72:75], v[28:31], a[36:39]
    ds_write_b128 v2, a[32:35] offset:50176
    v_mfma_f32_16x16x32_bf16 a[56:59], v[72:75], v[32:35], a[56:59]
    ds_write_b128 v2, a[52:55] offset:55296
    v_mfma_f32_16x16x32_bf16 a[76:79], v[72:75], v[36:39], a[76:79]
    ds_write_b128 v2, a[72:75] offset:60416
    v_mfma_f32_16x16x32_bf16 a[16:19], v[72:75], v[24:27], a[16:19]
    v_lshlrev_b32 v1, 3, v3
    v_add_u32 v1, 34816, v1
    v_and_b32 v7, 15, v3
    v_mul_u32_u24 v7, 1280, v7
    v_lshrrev_b32 v4, 4, v3
    v_lshl_add_u32 v7, v4, 3, v7
    ds_write_b128 v2, a[36:39] offset:51200
    ds_write_b128 v2, a[56:59] offset:56320
    ds_write_b128 v2, a[76:79] offset:61440
    v_accvgpr_read_b32 v92, a8
    v_accvgpr_read_b32 v93, a9
    v_accvgpr_read_b32 v94, a10
    v_accvgpr_read_b32 v95, a11
    v_accvgpr_read_b32 v96, a12
    v_accvgpr_read_b32 v97, a13
    v_accvgpr_read_b32 v98, a14
    v_accvgpr_read_b32 v99, a15
    v_accvgpr_read_b32 v100, a16
    v_accvgpr_read_b32 v101, a17
    v_accvgpr_read_b32 v102, a18
    v_accvgpr_read_b32 v103, a19
    s_waitcnt vmcnt(0)
    v_cmp_eq_u32 vcc, -1, v6
    s_nop 1
    s_cbranch_vccnz K2_R2R4
K2_R2B4:
    s_waitcnt lgkmcnt(0)
    s_barrier
    ds_read_b128 v[8:11], v113 offset:47104
    ds_read_b128 v[12:15], v113 offset:61440
    ds_read_b128 v[16:19], v114 offset:8192
    ds_read_b128 v[20:23], v114 offset:20480
    ds_read_b128 v[24:27], v2 offset:64512
    ds_read_b128 v[28:31], v113 offset:16384
    ds_read_b128 v[32:35], v113 offset:33792
    ds_read_b64_tr_b16 v[104:105], v1 offset:1024
    ds_read_b128 v[36:39], v113 offset:48128
    ds_read_b128 v[40:43], v113 offset:62464
    ds_read_b128 v[44:47], v114 offset:9216
    ds_read_b128 v[48:51], v114 offset:21504
    ds_read_b128 v[52:55], v113 offset:0
    ds_read_b128 v[56:59], v113 offset:17408
    ds_read_b128 v[60:63], v113 offset:34816
    s_waitcnt lgkmcnt(14)
    ds_read_b64_tr_b16 v[106:107], v1 offset:1536
    v_pk_add_f32 v[92:93], v[92:93], v[8:9]
    v_pk_add_f32 v[94:95], v[94:95], v[10:11]
    s_waitcnt lgkmcnt(14)
    ds_read_b128 v[64:67], v113 offset:49152
    v_pk_add_f32 v[92:93], v[92:93], v[12:13]
    v_pk_add_f32 v[94:95], v[94:95], v[14:15]
    s_waitcnt lgkmcnt(14)
    ds_read_b128 v[68:71], v113 offset:63488
    v_pk_add_f32 v[92:93], v[92:93], v[16:17]
    v_pk_add_f32 v[94:95], v[94:95], v[18:19]
    s_waitcnt lgkmcnt(14)
    ds_read_b128 v[72:75], v114 offset:10240
    v_pk_add_f32 v[92:93], v[92:93], v[20:21]
    v_pk_add_f32 v[94:95], v[94:95], v[22:23]
    s_waitcnt lgkmcnt(14)
    ds_read_b128 v[76:79], v114 offset:22528
    v_pk_add_f32 v[92:93], v[92:93], v[24:25]
    v_pk_add_f32 v[94:95], v[94:95], v[26:27]
    s_waitcnt lgkmcnt(14)
    ds_read_b128 v[80:83], v113 offset:1024
    v_pk_add_f32 v[92:93], v[92:93], v[28:29]
    v_pk_add_f32 v[94:95], v[94:95], v[30:31]
    s_waitcnt lgkmcnt(14)
    ds_read_b128 v[84:87], v113 offset:18432
    v_pk_add_f32 v[92:93], v[92:93], v[32:33]
    v_pk_add_f32 v[94:95], v[94:95], v[34:35]
    s_waitcnt lgkmcnt(14)
    ds_read_b128 v[88:91], v113 offset:35840
    v_lshlrev_b32 v8, 16, v104
    v_and_b32 v9, 0xffff0000, v104
    v_lshlrev_b32 v10, 16, v105
    v_and_b32 v11, 0xffff0000, v105
    v_fma_f32 v92, v92, v6, v8
    v_fma_f32 v93, v93, v6, v9
    v_fma_f32 v94, v94, v6, v10
    v_fma_f32 v95, v95, v6, v11
    v_cvt_pk_bf16_f32 v92, v92, v93
    v_cvt_pk_bf16_f32 v93, v94, v95
    buffer_store_dwordx2 v[92:93], v7, s[52:55], s43 offen offset:64
    s_waitcnt lgkmcnt(14)
    ds_read_b64_tr_b16 v[108:109], v1 offset:2048
    v_pk_add_f32 v[96:97], v[96:97], v[36:37]
    v_pk_add_f32 v[98:99], v[98:99], v[38:39]
    s_waitcnt lgkmcnt(14)
    v_pk_add_f32 v[96:97], v[96:97], v[40:41]
    v_pk_add_f32 v[98:99], v[98:99], v[42:43]
    s_waitcnt lgkmcnt(13)
    v_pk_add_f32 v[96:97], v[96:97], v[44:45]
    v_pk_add_f32 v[98:99], v[98:99], v[46:47]
    s_waitcnt lgkmcnt(12)
    v_pk_add_f32 v[96:97], v[96:97], v[48:49]
    v_pk_add_f32 v[98:99], v[98:99], v[50:51]
    s_waitcnt lgkmcnt(11)
    v_pk_add_f32 v[96:97], v[96:97], v[52:53]
    v_pk_add_f32 v[98:99], v[98:99], v[54:55]
    s_waitcnt lgkmcnt(10)
    v_pk_add_f32 v[96:97], v[96:97], v[56:57]
    v_pk_add_f32 v[98:99], v[98:99], v[58:59]
    s_waitcnt lgkmcnt(9)
    v_pk_add_f32 v[96:97], v[96:97], v[60:61]
    v_pk_add_f32 v[98:99], v[98:99], v[62:63]
    s_waitcnt lgkmcnt(8)
    v_lshlrev_b32 v36, 16, v106
    v_and_b32 v37, 0xffff0000, v106
    v_lshlrev_b32 v38, 16, v107
    v_and_b32 v39, 0xffff0000, v107
    v_fma_f32 v96, v96, v6, v36
    v_fma_f32 v97, v97, v6, v37
    v_fma_f32 v98, v98, v6, v38
    v_fma_f32 v99, v99, v6, v39
    v_cvt_pk_bf16_f32 v96, v96, v97
    v_cvt_pk_bf16_f32 v97, v98, v99
    buffer_store_dwordx2 v[96:97], v7, s[52:55], s43 offen offset:96
    s_waitcnt lgkmcnt(7)
    v_pk_add_f32 v[100:101], v[100:101], v[64:65]
    v_pk_add_f32 v[102:103], v[102:103], v[66:67]
    s_waitcnt lgkmcnt(6)
    v_pk_add_f32 v[100:101], v[100:101], v[68:69]
    v_pk_add_f32 v[102:103], v[102:103], v[70:71]
    s_waitcnt lgkmcnt(5)
    v_pk_add_f32 v[100:101], v[100:101], v[72:73]
    v_pk_add_f32 v[102:103], v[102:103], v[74:75]
    s_waitcnt lgkmcnt(4)
    v_pk_add_f32 v[100:101], v[100:101], v[76:77]
    v_pk_add_f32 v[102:103], v[102:103], v[78:79]
    s_waitcnt lgkmcnt(3)
    v_pk_add_f32 v[100:101], v[100:101], v[80:81]
    v_pk_add_f32 v[102:103], v[102:103], v[82:83]
    s_waitcnt lgkmcnt(2)
    v_pk_add_f32 v[100:101], v[100:101], v[84:85]
    v_pk_add_f32 v[102:103], v[102:103], v[86:87]
    s_waitcnt lgkmcnt(1)
    v_pk_add_f32 v[100:101], v[100:101], v[88:89]
    v_pk_add_f32 v[102:103], v[102:103], v[90:91]
    s_waitcnt lgkmcnt(0)
    v_lshlrev_b32 v64, 16, v108
    v_and_b32 v65, 0xffff0000, v108
    v_lshlrev_b32 v66, 16, v109
    v_and_b32 v67, 0xffff0000, v109
    v_fma_f32 v100, v100, v6, v64
    v_fma_f32 v101, v101, v6, v65
    v_fma_f32 v102, v102, v6, v66
    v_fma_f32 v103, v103, v6, v67
    v_cvt_pk_bf16_f32 v100, v100, v101
    v_cvt_pk_bf16_f32 v101, v102, v103
    buffer_store_dwordx2 v[100:101], v7, s[52:55], s43 offen offset:128
    s_endpgm
K2_HL_0_R:
    s_mov_b32 s35, 0
K2_HL_0_L:
    s_sub_u32 s34, s40, 12288
    buffer_load_dwordx4 v[8:11], v2, s[20:23], s34 offen offset:0 sc1
    buffer_load_dwordx4 v[16:19], v2, s[20:23], s34 offen offset:1024 sc1
    buffer_load_dwordx4 v[12:15], v2, s[20:23], s34 offen offset:2048 sc1
    buffer_load_dwordx4 v[20:23], v2, s[20:23], s34 offen offset:3072 sc1
    s_sub_u32 s34, s40, 8192
    buffer_load_dwordx4 v[24:27], v2, s[20:23], s34 offen offset:0 sc1
    buffer_load_dwordx4 v[32:35], v2, s[20:23], s34 offen offset:1024 sc1
    buffer_load_dwordx4 v[28:31], v2, s[20:23], s34 offen offset:2048 sc1
    buffer_load_dwordx4 v[36:39], v2, s[20:23], s34 offen offset:3072 sc1
    s_sub_u32 s34, s40, 4096
    buffer_load_dwordx4 v[40:43], v2, s[20:23], s34 offen offset:0 sc1
    buffer_load_dwordx4 v[48:51], v2, s[20:23], s34 offen offset:1024 sc1
    buffer_load_dwordx4 v[44:47], v2, s[20:23], s34 offen offset:2048 sc1
    buffer_load_dwordx4 v[52:55], v2, s[20:23], s34 offen offset:3072 sc1
    s_add_u32 s35, s35, 1
    s_cmp_gt_u32 s35, 4000
    s_waitcnt vmcnt(8)
    s_cbranch_scc1 K2_HL_0_B
    v_max3_u32 v4, v8, v12, v16
    v_max_u32 v4, v4, v20
    v_cmp_eq_u32 vcc, -1, v4
    s_nop 1
    s_cbranch_vccnz K2_HL_0_L
    s_branch K2_HL_0_B
K2_HL_1_R:
    s_mov_b32 s35, 0
K2_HL_1_L:
    s_sub_u32 s34, s40, 8192
    buffer_load_dwordx4 v[24:27], v2, s[20:23], s34 offen offset:0 sc1
    buffer_load_dwordx4 v[32:35], v2, s[20:23], s34 offen offset:1024 sc1
    buffer_load_dwordx4 v[28:31], v2, s[20:23], s34 offen offset:2048 sc1
    buffer_load_dwordx4 v[36:39], v2, s[20:23], s34 offen offset:3072 sc1
    s_add_u32 s35, s35, 1
    s_cmp_gt_u32 s35, 4000
    s_waitcnt vmcnt(0)
    s_cbranch_scc1 K2_HL_1_B
    v_max3_u32 v4, v24, v28, v32
    v_max_u32 v4, v4, v36
    v_cmp_eq_u32 vcc, -1, v4
    s_nop 1
    s_cbranch_vccnz K2_HL_1_L
    s_branch K2_HL_1_B
K2_HL_2_R:
    s_mov_b32 s35, 0
K2_HL_2_L:
    s_sub_u32 s34, s40, 12288
    buffer_load_dwordx4 v[40:43], v2, s[20:23], s34 offen offset:0 sc1
    buffer_load_dwordx4 v[48:51], v2, s[20:23], s34 offen offset:1024 sc1
    buffer_load_dwordx4 v[44:47], v2, s[20:23], s34 offen offset:2048 sc1
    buffer_load_dwordx4 v[52:55], v2, s[20:23], s34 offen offset:3072 sc1
    s_add_u32 s35, s35, 1
    s_cmp_gt_u32 s35, 4000
    s_waitcnt vmcnt(0)
    s_cbranch_scc1 K2_HL_2_B
    v_max3_u32 v4, v40, v44, v48
    v_max_u32 v4, v4, v52
    v_cmp_eq_u32 vcc, -1, v4
    s_nop 1
    s_cbranch_vccnz K2_HL_2_L
    s_branch K2_HL_2_B
K2_HL_3_R:
    s_mov_b32 s35, 0
K2_HL_3_L:
    s_sub_u32 s34, s40, 12288
    buffer_load_dwordx4 v[56:59], v2, s[20:23], s34 offen offset:0 sc1
    buffer_load_dwordx4 v[64:67], v2, s[20:23], s34 offen offset:1024 sc1
    buffer_load_dwordx4 v[60:63], v2, s[20:23], s34 offen offset:2048 sc1
    buffer_load_dwordx4 v[68:71], v2, s[20:23], s34 offen offset:3072 sc1
    s_add_u32 s35, s35, 1
    s_cmp_gt_u32 s35, 4000
    s_waitcnt vmcnt(0)
    s_cbranch_scc1 K2_HL_3_B
    v_max3_u32 v4, v56, v60, v64
    v_max_u32 v4, v4, v68
    v_cmp_eq_u32 vcc, -1, v4
    s_nop 1
    s_cbranch_vccnz K2_HL_3_L
    s_branch K2_HL_3_B
K2_HL_4_R:
    s_mov_b32 s35, 0
K2_HL_4_L:
    s_sub_u32 s34, s40, 8192
    buffer_load_dwordx4 v[8:11], v2, s[20:23], s34 offen offset:0 sc1
    buffer_load_dwordx4 v[16:19], v2, s[20:23], s34 offen offset:1024 sc1
    buffer_load_dwordx4 v[12:15], v2, s[20:23], s34 offen offset:2048 sc1
    buffer_load_dwordx4 v[20:23], v2, s[20:23], s34 offen offset:3072 sc1
    s_add_u32 s35, s35, 1
    s_cmp_gt_u32 s35, 4000
    s_waitcnt vmcnt(0)
    s_cbranch_scc1 K2_HL_4_B
    v_max3_u32 v4, v8, v12, v16
    v_max_u32 v4, v4, v20
    v_cmp_eq_u32 vcc, -1, v4
    s_nop 1
    s_cbranch_vccnz K2_HL_4_L
    s_branch K2_HL_4_B
K2_HL_5_R:
    s_mov_b32 s35, 0
K2_HL_5_L:
    s_sub_u32 s34, s40, 4096
    buffer_load_dwordx4 v[24:27], v2, s[20:23], s34 offen offset:0 sc1
    buffer_load_dwordx4 v[32:35], v2, s[20:23], s34 offen offset:1024 sc1
    buffer_load_dwordx4 v[28:31], v2, s[20:23], s34 offen offset:2048 sc1
    buffer_load_dwordx4 v[36:39], v2, s[20:23], s34 offen offset:3072 sc1
    s_add_u32 s35, s35, 1
    s_cmp_gt_u32 s35, 4000
    s_waitcnt vmcnt(0)
    s_cbranch_scc1 K2_HL_5_B
    v_max3_u32 v4, v24, v28, v32
    v_max_u32 v4, v4, v36
    v_cmp_eq_u32 vcc, -1, v4
    s_nop 1
    s_cbranch_vccnz K2_HL_5_L
    s_branch K2_HL_5_B
K2_R2R4:
    s_mov_b32 s35, 0
K2_R2L4:
    buffer_load_dword v6, v5, s[16:19], s42 offen sc1
    s_add_u32 s35, s35, 1
    s_cmp_gt_u32 s35, 4000
    s_waitcnt vmcnt(0)
    s_cbranch_scc1 K2_R2B4
    v_cmp_eq_u32 vcc, -1, v6
    s_nop 1
    s_cbranch_vccnz K2_R2L4
    s_branch K2_R2B4
K2_LF1:
    s_cmp_lg_u32 s7, 1
    s_cbranch_scc1 K2_LF2
    s_setprio 1
    v_mfma_f32_16x16x32_bf16 a[0:3], a[92:95], v[8:11], a[0:3]
    v_mfma_f32_16x16x32_bf16 a[20:23], a[92:95], v[12:15], a[20:23]
    v_mfma_f32_16x16x32_bf16 a[40:43], a[92:95], v[16:19], a[40:43]
    v_mfma_f32_16x16x32_bf16 a[60:63], a[92:95], v[20:23], a[60:63]
    v_mfma_f32_16x16x32_bf16 a[0:3], a[112:115], v[24:27], a[0:3]
    v_mfma_f32_16x16x32_bf16 a[20:23], a[112:115], v[28:31], a[20:23]
    v_mfma_f32_16x16x32_bf16 a[40:43], a[112:115], v[32:35], a[40:43]
    v_mfma_f32_16x16x32_bf16 a[60:63], a[112:115], v[36:39], a[60:63]
    v_mfma_f32_16x16x32_bf16 a[4:7], a[96:99], v[8:11], a[4:7]
    v_mfma_f32_16x16x32_bf16 a[24:27], a[96:99], v[12:15], a[24:27]
    v_mfma_f32_16x16x32_bf16 a[44:47], a[96:99], v[16:19], a[44:47]
    v_mfma_f32_16x16x32_bf16 a[64:67], a[96:99], v[20:23], a[64:67]
    v_mfma_f32_16x16x32_bf16 a[4:7], a[116:119], v[24:27], a[4:7]
    ds_write_b128 v2, a[0:3] offset:62464
    v_mfma_f32_16x16x32_bf16 a[24:27], a[116:119], v[28:31], a[24:27]
    ds_write_b128 v113, a[20:23] offset:2048
    v_mfma_f32_16x16x32_bf16 a[44:47], a[116:119], v[32:35], a[44:47]
    ds_write_b128 v113, a[40:43] offset:4096
    v_mfma_f32_16x16x32_bf16 a[64:67], a[116:119], v[36:39], a[64:67]
    ds_write_b128 v113, a[60:63] offset:9216
    v_mfma_f32_16x16x32_bf16 a[8:11], a[100:103], v[8:11], a[8:11]
    v_mfma_f32_16x16x32_bf16 a[48:51], a[100:103], v[16:19], a[48:51]
    v_mfma_f32_16x16x32_bf16 a[68:71], a[100:103], v[20:23], a[68:71]
    v_mfma_f32_16x16x32_bf16 a[28:31], a[100:103], v[12:15], a[28:31]
    v_mfma_f32_16x16x32_bf16 a[8:11], a[120:123], v[24:27], a[8:11]
    ds_write_b128 v2, a[4:7] offset:63488
    v_mfma_f32_16x16x32_bf16 a[48:51], a[120:123], v[32:35], a[48:51]
    ds_write_b128 v113, a[24:27] offset:3072
    v_mfma_f32_16x16x32_bf16 a[68:71], a[120:123], v[36:39], a[68:71]
    ds_write_b128 v113, a[44:47] offset:5120
    v_mfma_f32_16x16x32_bf16 a[28:31], a[120:123], v[28:31], a[28:31]
    ds_write_b128 v113, a[64:67] offset:10240
    v_mfma_f32_16x16x32_bf16 a[12:15], a[104:107], v[8:11], a[12:15]
    v_mfma_f32_16x16x32_bf16 a[52:55], a[104:107], v[16:19], a[52:55]
    v_mfma_f32_16x16x32_bf16 a[72:75], a[104:107], v[20:23], a[72:75]
    v_mfma_f32_16x16x32_bf16 a[32:35], a[104:107], v[12:15], a[32:35]
    v_mfma_f32_16x16x32_bf16 a[12:15], a[124:127], v[24:27], a[12:15]
    ds_write_b128 v2, a[8:11] offset:64512
    v_mfma_f32_16x16x32_bf16 a[52:55], a[124:127], v[32:35], a[52:55]
    ds_write_b128 v113, a[48:51] offset:6144
    v_mfma_f32_16x16x32_bf16 a[72:75], a[124:127], v[36:39], a[72:75]
    ds_write_b128 v113, a[68:71] offset:11264
    v_mfma_f32_16x16x32_bf16 a[32:35], a[124:127], v[28:31], a[32:35]
    v_mfma_f32_16x16x32_bf16 a[16:19], a[108:111], v[8:11], a[16:19]
    v_mfma_f32_16x16x32_bf16 a[56:59], a[108:111], v[16:19], a[56:59]
    v_mfma_f32_16x16x32_bf16 a[76:79], a[108:111], v[20:23], a[76:79]
    v_mfma_f32_16x16x32_bf16 a[36:39], a[108:111], v[12:15], a[36:39]
    v_mfma_f32_16x16x32_bf16 a[16:19], v[72:75], v[24:27], a[16:19]
    ds_write_b128 v113, a[12:15] offset:0
    v_mfma_f32_16x16x32_bf16 a[56:59], v[72:75], v[32:35], a[56:59]
    ds_write_b128 v113, a[52:55] offset:7168
    v_mfma_f32_16x16x32_bf16 a[76:79], v[72:75], v[36:39], a[76:79]
    ds_write_b128 v113, a[72:75] offset:12288
    v_mfma_f32_16x16x32_bf16 a[36:39], v[72:75], v[28:31], a[36:39]
    v_lshlrev_b32 v1, 3, v3
    v_add_u32 v1, 37376, v1
    v_and_b32 v7, 15, v3
    v_mul_u32_u24 v7, 1280, v7
    v_lshrrev_b32 v4, 4, v3
    v_lshl_add_u32 v7, v4, 3, v7
    ds_write_b128 v113, a[16:19] offset:1024
    ds_write_b128 v113, a[56:59] offset:8192
    ds_write_b128 v113, a[76:79] offset:13312
    v_accvgpr_read_b32 v92, a28
    v_accvgpr_read_b32 v93, a29
    v_accvgpr_read_b32 v94, a30
    v_accvgpr_read_b32 v95, a31
    v_accvgpr_read_b32 v96, a32
    v_accvgpr_read_b32 v97, a33
    v_accvgpr_read_b32 v98, a34
    v_accvgpr_read_b32 v99, a35
    v_accvgpr_read_b32 v100, a36
    v_accvgpr_read_b32 v101, a37
    v_accvgpr_read_b32 v102, a38
    v_accvgpr_read_b32 v103, a39
    s_waitcnt vmcnt(0)
    v_cmp_eq_u32 vcc, -1, v6
    s_nop 1
    s_cbranch_vccnz K2_R2R5
K2_R2B5:
    s_waitcnt lgkmcnt(0)
    s_barrier
    ds_read_b128 v[8:11], v113 offset:52224
    ds_read_b128 v[12:15], v113 offset:64512
    ds_read_b128 v[16:19], v114 offset:13312
    ds_read_b128 v[20:23], v114 offset:25600
    ds_read_b128 v[24:27], v2 offset:49152
    ds_read_b128 v[28:31], v113 offset:21504
    ds_read_b128 v[32:35], v113 offset:38912
    ds_read_b64_tr_b16 v[104:105], v1 offset:1024
    ds_read_b128 v[36:39], v113 offset:53248
    ds_read_b128 v[40:43], v114 offset:0
    ds_read_b128 v[44:47], v114 offset:14336
    ds_read_b128 v[48:51], v114 offset:26624
    ds_read_b128 v[52:55], v2 offset:50176
    ds_read_b128 v[56:59], v113 offset:22528
    ds_read_b128 v[60:63], v113 offset:39936
    s_waitcnt lgkmcnt(14)
    ds_read_b64_tr_b16 v[106:107], v1 offset:1536
    v_pk_add_f32 v[92:93], v[92:93], v[8:9]
    v_pk_add_f32 v[94:95], v[94:95], v[10:11]
    s_waitcnt lgkmcnt(14)
    ds_read_b128 v[64:67], v113 offset:54272
    v_pk_add_f32 v[92:93], v[92:93], v[12:13]
    v_pk_add_f32 v[94:95], v[94:95], v[14:15]
    s_waitcnt lgkmcnt(14)
    ds_read_b128 v[68:71], v114 offset:1024
    v_pk_add_f32 v[92:93], v[92:93], v[16:17]
    v_pk_add_f32 v[94:95], v[94:95], v[18:19]
    s_waitcnt lgkmcnt(14)
    ds_read_b128 v[72:75], v114 offset:15360
    v_pk_add_f32 v[92:93], v[92:93], v[20:21]
    v_pk_add_f32 v[94:95], v[94:95], v[22:23]
    s_waitcnt lgkmcnt(14)
    ds_read_b128 v[76:79], v114 offset:27648
    v_pk_add_f32 v[92:93], v[92:93], v[24:25]
    v_pk_add_f32 v[94:95], v[94:95], v[26:27]
    s_waitcnt lgkmcnt(14)
    ds_read_b128 v[80:83], v2 offset:51200
    v_pk_add_f32 v[92:93], v[92:93], v[28:29]
    v_pk_add_f32 v[94:95], v[94:95], v[30:31]
    s_waitcnt lgkmcnt(14)
    ds_read_b128 v[84:87], v113 offset:23552
    v_pk_add_f32 v[92:93], v[92:93], v[32:33]
    v_pk_add_f32 v[94:95], v[94:95], v[34:35]
    s_waitcnt lgkmcnt(14)
    ds_read_b128 v[88:91], v113 offset:40960
    v_lshlrev_b32 v8, 16, v104
    v_and_b32 v9, 0xffff0000, v104
    v_lshlrev_b32 v10, 16, v105
    v_and_b32 v11, 0xffff0000, v105
    v_fma_f32 v92, v92, v6, v8
    v_fma_f32 v93, v93, v6, v9
    v_fma_f32 v94, v94, v6, v10
    v_fma_f32 v95, v95, v6, v11
    v_cvt_pk_bf16_f32 v92, v92, v93
    v_cvt_pk_bf16_f32 v93, v94, v95
    buffer_store_dwordx2 v[92:93], v7, s[52:55], s43 offen offset:64
    s_waitcnt lgkmcnt(14)
    ds_read_b64_tr_b16 v[108:109], v1 offset:2048
    v_pk_add_f32 v[96:97], v[96:97], v[36:37]
    v_pk_add_f32 v[98:99], v[98:99], v[38:39]
    s_waitcnt lgkmcnt(14)
    v_pk_add_f32 v[96:97], v[96:97], v[40:41]
    v_pk_add_f32 v[98:99], v[98:99], v[42:43]
    s_waitcnt lgkmcnt(13)
    v_pk_add_f32 v[96:97], v[96:97], v[44:45]
    v_pk_add_f32 v[98:99], v[98:99], v[46:47]
    s_waitcnt lgkmcnt(12)
    v_pk_add_f32 v[96:97], v[96:97], v[48:49]
    v_pk_add_f32 v[98:99], v[98:99], v[50:51]
    s_waitcnt lgkmcnt(11)
    v_pk_add_f32 v[96:97], v[96:97], v[52:53]
    v_pk_add_f32 v[98:99], v[98:99], v[54:55]
    s_waitcnt lgkmcnt(10)
    v_pk_add_f32 v[96:97], v[96:97], v[56:57]
    v_pk_add_f32 v[98:99], v[98:99], v[58:59]
    s_waitcnt lgkmcnt(9)
    v_pk_add_f32 v[96:97], v[96:97], v[60:61]
    v_pk_add_f32 v[98:99], v[98:99], v[62:63]
    s_waitcnt lgkmcnt(8)
    v_lshlrev_b32 v36, 16, v106
    v_and_b32 v37, 0xffff0000, v106
    v_lshlrev_b32 v38, 16, v107
    v_and_b32 v39, 0xffff0000, v107
    v_fma_f32 v96, v96, v6, v36
    v_fma_f32 v97, v97, v6, v37
    v_fma_f32 v98, v98, v6, v38
    v_fma_f32 v99, v99, v6, v39
    v_cvt_pk_bf16_f32 v96, v96, v97
    v_cvt_pk_bf16_f32 v97, v98, v99
    buffer_store_dwordx2 v[96:97], v7, s[52:55], s43 offen offset:96
    s_waitcnt lgkmcnt(7)
    v_pk_add_f32 v[100:101], v[100:101], v[64:65]
    v_pk_add_f32 v[102:103], v[102:103], v[66:67]
    s_waitcnt lgkmcnt(6)
    v_pk_add_f32 v[100:101], v[100:101], v[68:69]
    v_pk_add_f32 v[102:103], v[102:103], v[70:71]
    s_waitcnt lgkmcnt(5)
    v_pk_add_f32 v[100:101], v[100:101], v[72:73]
    v_pk_add_f32 v[102:103], v[102:103], v[74:75]
    s_waitcnt lgkmcnt(4)
    v_pk_add_f32 v[100:101], v[100:101], v[76:77]
    v_pk_add_f32 v[102:103], v[102:103], v[78:79]
    s_waitcnt lgkmcnt(3)
    v_pk_add_f32 v[100:101], v[100:101], v[80:81]
    v_pk_add_f32 v[102:103], v[102:103], v[82:83]
    s_waitcnt lgkmcnt(2)
    v_pk_add_f32 v[100:101], v[100:101], v[84:85]
    v_pk_add_f32 v[102:103], v[102:103], v[86:87]
    s_waitcnt lgkmcnt(1)
    v_pk_add_f32 v[100:101], v[100:101], v[88:89]
    v_pk_add_f32 v[102:103], v[102:103], v[90:91]
    s_waitcnt lgkmcnt(0)
    v_lshlrev_b32 v64, 16, v108
    v_and_b32 v65, 0xffff0000, v108
    v_lshlrev_b32 v66, 16, v109
    v_and_b32 v67, 0xffff0000, v109
    v_fma_f32 v100, v100, v6, v64
    v_fma_f32 v101, v101, v6, v65
    v_fma_f32 v102, v102, v6, v66
    v_fma_f32 v103, v103, v6, v67
    v_cvt_pk_bf16_f32 v100, v100, v101
    v_cvt_pk_bf16_f32 v101, v102, v103
    buffer_store_dwordx2 v[100:101], v7, s[52:55], s43 offen offset:128
    s_endpgm
K2_R2R5:
    s_mov_b32 s35, 0
K2_R2L5:
    buffer_load_dword v6, v5, s[16:19], s42 offen sc1
    s_add_u32 s35, s35, 1
    s_cmp_gt_u32 s35, 4000
    s_waitcnt vmcnt(0)
    s_cbranch_scc1 K2_R2B5
    v_cmp_eq_u32 vcc, -1, v6
    s_nop 1
    s_cbranch_vccnz K2_R2L5
    s_branch K2_R2B5
K2_LF2:
    s_cmp_lg_u32 s7, 2
    s_cbranch_scc1 K2_LF3
    s_setprio 1
    v_mfma_f32_16x16x32_bf16 a[0:3], a[92:95], v[8:11], a[0:3]
    v_mfma_f32_16x16x32_bf16 a[20:23], a[92:95], v[12:15], a[20:23]
    v_mfma_f32_16x16x32_bf16 a[40:43], a[92:95], v[16:19], a[40:43]
    v_mfma_f32_16x16x32_bf16 a[60:63], a[92:95], v[20:23], a[60:63]
    v_mfma_f32_16x16x32_bf16 a[0:3], a[112:115], v[24:27], a[0:3]
    v_mfma_f32_16x16x32_bf16 a[20:23], a[112:115], v[28:31], a[20:23]
    v_mfma_f32_16x16x32_bf16 a[40:43], a[112:115], v[32:35], a[40:43]
    v_mfma_f32_16x16x32_bf16 a[60:63], a[112:115], v[36:39], a[60:63]
    v_mfma_f32_16x16x32_bf16 a[4:7], a[96:99], v[8:11], a[4:7]
    v_mfma_f32_16x16x32_bf16 a[24:27], a[96:99], v[12:15], a[24:27]
    v_mfma_f32_16x16x32_bf16 a[44:47], a[96:99], v[16:19], a[44:47]
    v_mfma_f32_16x16x32_bf16 a[64:67], a[96:99], v[20:23], a[64:67]
    v_mfma_f32_16x16x32_bf16 a[4:7], a[116:119], v[24:27], a[4:7]
    ds_write_b128 v113, a[0:3] offset:14336
    v_mfma_f32_16x16x32_bf16 a[24:27], a[116:119], v[28:31], a[24:27]
    ds_write_b128 v113, a[20:23] offset:19456
    v_mfma_f32_16x16x32_bf16 a[44:47], a[116:119], v[32:35], a[44:47]
    ds_write_b128 v113, a[40:43] offset:24576
    v_mfma_f32_16x16x32_bf16 a[64:67], a[116:119], v[36:39], a[64:67]
    ds_write_b128 v113, a[60:63] offset:26624
    v_mfma_f32_16x16x32_bf16 a[8:11], a[100:103], v[8:11], a[8:11]
    v_mfma_f32_16x16x32_bf16 a[28:31], a[100:103], v[12:15], a[28:31]
    v_mfma_f32_16x16x32_bf16 a[68:71], a[100:103], v[20:23], a[68:71]
    v_mfma_f32_16x16x32_bf16 a[48:51], a[100:103], v[16:19], a[48:51]
    v_mfma_f32_16x16x32_bf16 a[8:11], a[120:123], v[24:27], a[8:11]
    ds_write_b128 v113, a[4:7] offset:15360
    v_mfma_f32_16x16x32_bf16 a[28:31], a[120:123], v[28:31], a[28:31]
    ds_write_b128 v113, a[24:27] offset:20480
    v_mfma_f32_16x16x32_bf16 a[68:71], a[120:123], v[36:39], a[68:71]
    ds_write_b128 v113, a[44:47] offset:25600
    v_mfma_f32_16x16x32_bf16 a[48:51], a[120:123], v[32:35], a[48:51]
    ds_write_b128 v113, a[64:67] offset:27648
    v_mfma_f32_16x16x32_bf16 a[12:15], a[104:107], v[8:11], a[12:15]
    v_mfma_f32_16x16x32_bf16 a[32:35], a[104:107], v[12:15], a[32:35]
    v_mfma_f32_16x16x32_bf16 a[72:75], a[104:107], v[20:23], a[72:75]
    v_mfma_f32_16x16x32_bf16 a[52:55], a[104:107], v[16:19], a[52:55]
    v_mfma_f32_16x16x32_bf16 a[12:15], a[124:127], v[24:27], a[12:15]
    ds_write_b128 v113, a[8:11] offset:16384
    v_mfma_f32_16x16x32_bf16 a[32:35], a[124:127], v[28:31], a[32:35]
    ds_write_b128 v113, a[28:31] offset:21504
    v_mfma_f32_16x16x32_bf16 a[72:75], a[124:127], v[36:39], a[72:75]
    ds_write_b128 v113, a[68:71] offset:28672
    v_mfma_f32_16x16x32_bf16 a[52:55], a[124:127], v[32:35], a[52:55]
    v_mfma_f32_16x16x32_bf16 a[16:19], a[108:111], v[8:11], a[16:19]
    v_mfma_f32_16x16x32_bf16 a[36:39], a[108:111], v[12:15], a[36:39]
    v_mfma_f32_16x16x32_bf16 a[76:79], a[108:111], v[20:23], a[76:79]
    v_mfma_f32_16x16x32_bf16 a[56:59], a[108:111], v[16:19], a[56:59]
    v_mfma_f32_16x16x32_bf16 a[16:19], v[72:75], v[24:27], a[16:19]
    ds_write_b128 v113, a[12:15] offset:17408
    v_mfma_f32_16x16x32_bf16 a[36:39], v[72:75], v[28:31], a[36:39]
    ds_write_b128 v113, a[32:35] offset:22528
    v_mfma_f32_16x16x32_bf16 a[76:79], v[72:75], v[36:39], a[76:79]
    ds_write_b128 v113, a[72:75] offset:29696
    v_mfma_f32_16x16x32_bf16 a[56:59], v[72:75], v[32:35], a[56:59]
    v_lshlrev_b32 v1, 3, v3
    v_add_u32 v1, 39936, v1
    v_and_b32 v7, 15, v3
    v_mul_u32_u24 v7, 1280, v7
    v_lshrrev_b32 v4, 4, v3
    v_lshl_add_u32 v7, v4, 3, v7
    ds_write_b128 v113, a[16:19] offset:18432
    ds_write_b128 v113, a[36:39] offset:23552
    ds_write_b128 v113, a[76:79] offset:30720
    v_accvgpr_read_b32 v92, a48
    v_accvgpr_read_b32 v93, a49
    v_accvgpr_read_b32 v94, a50
    v_accvgpr_read_b32 v95, a51
    v_accvgpr_read_b32 v96, a52
    v_accvgpr_read_b32 v97, a53
    v_accvgpr_read_b32 v98, a54
    v_accvgpr_read_b32 v99, a55
    v_accvgpr_read_b32 v100, a56
    v_accvgpr_read_b32 v101, a57
    v_accvgpr_read_b32 v102, a58
    v_accvgpr_read_b32 v103, a59
    s_waitcnt vmcnt(0)
    v_cmp_eq_u32 vcc, -1, v6
    s_nop 1
    s_cbranch_vccnz K2_R2R6
K2_R2B6:
    s_waitcnt lgkmcnt(0)
    s_barrier
    ds_read_b128 v[8:11], v113 offset:57344
    ds_read_b128 v[12:15], v114 offset:4096
    ds_read_b128 v[16:19], v114 offset:16384
    ds_read_b128 v[20:23], v2 offset:15360
    ds_read_b128 v[24:27], v2 offset:54272
    ds_read_b128 v[28:31], v113 offset:6144
    ds_read_b128 v[32:35], v113 offset:44032
    ds_read_b64_tr_b16 v[104:105], v1 offset:1024
    ds_read_b128 v[36:39], v113 offset:58368
    ds_read_b128 v[40:43], v114 offset:5120
    ds_read_b128 v[44:47], v114 offset:17408
    ds_read_b128 v[48:51], v2 offset:16384
    ds_read_b128 v[52:55], v2 offset:55296
    ds_read_b128 v[56:59], v113 offset:7168
    ds_read_b128 v[60:63], v113 offset:45056
    s_waitcnt lgkmcnt(14)
    ds_read_b64_tr_b16 v[106:107], v1 offset:1536
    v_pk_add_f32 v[92:93], v[92:93], v[8:9]
    v_pk_add_f32 v[94:95], v[94:95], v[10:11]
    s_waitcnt lgkmcnt(14)
    ds_read_b128 v[64:67], v2 offset:0
    v_pk_add_f32 v[92:93], v[92:93], v[12:13]
    v_pk_add_f32 v[94:95], v[94:95], v[14:15]
    s_waitcnt lgkmcnt(14)
    ds_read_b128 v[68:71], v2 offset:5120
    v_pk_add_f32 v[92:93], v[92:93], v[16:17]
    v_pk_add_f32 v[94:95], v[94:95], v[18:19]
    s_waitcnt lgkmcnt(14)
    ds_read_b128 v[72:75], v2 offset:10240
    v_pk_add_f32 v[92:93], v[92:93], v[20:21]
    v_pk_add_f32 v[94:95], v[94:95], v[22:23]
    s_waitcnt lgkmcnt(14)
    ds_read_b128 v[76:79], v2 offset:17408
    v_pk_add_f32 v[92:93], v[92:93], v[24:25]
    v_pk_add_f32 v[94:95], v[94:95], v[26:27]
    s_waitcnt lgkmcnt(14)
    ds_read_b128 v[80:83], v2 offset:56320
    v_pk_add_f32 v[92:93], v[92:93], v[28:29]
    v_pk_add_f32 v[94:95], v[94:95], v[30:31]
    s_waitcnt lgkmcnt(14)
    ds_read_b128 v[84:87], v113 offset:8192
    v_pk_add_f32 v[92:93], v[92:93], v[32:33]
    v_pk_add_f32 v[94:95], v[94:95], v[34:35]
    s_waitcnt lgkmcnt(14)
    ds_read_b128 v[88:91], v113 offset:46080
    v_lshlrev_b32 v8, 16, v104
    v_and_b32 v9, 0xffff0000, v104
    v_lshlrev_b32 v10, 16, v105
    v_and_b32 v11, 0xffff0000, v105
    v_fma_f32 v92, v92, v6, v8
    v_fma_f32 v93, v93, v6, v9
    v_fma_f32 v94, v94, v6, v10
    v_fma_f32 v95, v95, v6, v11
    v_cvt_pk_bf16_f32 v92, v92, v93
    v_cvt_pk_bf16_f32 v93, v94, v95
    buffer_store_dwordx2 v[92:93], v7, s[52:55], s43 offen offset:64
    s_waitcnt lgkmcnt(14)
    ds_read_b64_tr_b16 v[108:109], v1 offset:2048
    v_pk_add_f32 v[96:97], v[96:97], v[36:37]
    v_pk_add_f32 v[98:99], v[98:99], v[38:39]
    s_waitcnt lgkmcnt(14)
    v_pk_add_f32 v[96:97], v[96:97], v[40:41]
    v_pk_add_f32 v[98:99], v[98:99], v[42:43]
    s_waitcnt lgkmcnt(13)
    v_pk_add_f32 v[96:97], v[96:97], v[44:45]
    v_pk_add_f32 v[98:99], v[98:99], v[46:47]
    s_waitcnt lgkmcnt(12)
    v_pk_add_f32 v[96:97], v[96:97], v[48:49]
    v_pk_add_f32 v[98:99], v[98:99], v[50:51]
    s_waitcnt lgkmcnt(11)
    v_pk_add_f32 v[96:97], v[96:97], v[52:53]
    v_pk_add_f32 v[98:99], v[98:99], v[54:55]
    s_waitcnt lgkmcnt(10)
    v_pk_add_f32 v[96:97], v[96:97], v[56:57]
    v_pk_add_f32 v[98:99], v[98:99], v[58:59]
    s_waitcnt lgkmcnt(9)
    v_pk_add_f32 v[96:97], v[96:97], v[60:61]
    v_pk_add_f32 v[98:99], v[98:99], v[62:63]
    s_waitcnt lgkmcnt(8)
    v_lshlrev_b32 v36, 16, v106
    v_and_b32 v37, 0xffff0000, v106
    v_lshlrev_b32 v38, 16, v107
    v_and_b32 v39, 0xffff0000, v107
    v_fma_f32 v96, v96, v6, v36
    v_fma_f32 v97, v97, v6, v37
    v_fma_f32 v98, v98, v6, v38
    v_fma_f32 v99, v99, v6, v39
    v_cvt_pk_bf16_f32 v96, v96, v97
    v_cvt_pk_bf16_f32 v97, v98, v99
    buffer_store_dwordx2 v[96:97], v7, s[52:55], s43 offen offset:96
    s_waitcnt lgkmcnt(7)
    v_pk_add_f32 v[100:101], v[100:101], v[64:65]
    v_pk_add_f32 v[102:103], v[102:103], v[66:67]
    s_waitcnt lgkmcnt(6)
    v_pk_add_f32 v[100:101], v[100:101], v[68:69]
    v_pk_add_f32 v[102:103], v[102:103], v[70:71]
    s_waitcnt lgkmcnt(5)
    v_pk_add_f32 v[100:101], v[100:101], v[72:73]
    v_pk_add_f32 v[102:103], v[102:103], v[74:75]
    s_waitcnt lgkmcnt(4)
    v_pk_add_f32 v[100:101], v[100:101], v[76:77]
    v_pk_add_f32 v[102:103], v[102:103], v[78:79]
    s_waitcnt lgkmcnt(3)
    v_pk_add_f32 v[100:101], v[100:101], v[80:81]
    v_pk_add_f32 v[102:103], v[102:103], v[82:83]
    s_waitcnt lgkmcnt(2)
    v_pk_add_f32 v[100:101], v[100:101], v[84:85]
    v_pk_add_f32 v[102:103], v[102:103], v[86:87]
    s_waitcnt lgkmcnt(1)
    v_pk_add_f32 v[100:101], v[100:101], v[88:89]
    v_pk_add_f32 v[102:103], v[102:103], v[90:91]
    s_waitcnt lgkmcnt(0)
    v_lshlrev_b32 v64, 16, v108
    v_and_b32 v65, 0xffff0000, v108
    v_lshlrev_b32 v66, 16, v109
    v_and_b32 v67, 0xffff0000, v109
    v_fma_f32 v100, v100, v6, v64
    v_fma_f32 v101, v101, v6, v65
    v_fma_f32 v102, v102, v6, v66
    v_fma_f32 v103, v103, v6, v67
    v_cvt_pk_bf16_f32 v100, v100, v101
    v_cvt_pk_bf16_f32 v101, v102, v103
    buffer_store_dwordx2 v[100:101], v7, s[52:55], s43 offen offset:128
    s_endpgm
K2_R2R6:
    s_mov_b32 s35, 0
K2_R2L6:
    buffer_load_dword v6, v5, s[16:19], s42 offen sc1
    s_add_u32 s35, s35, 1
    s_cmp_gt_u32 s35, 4000
    s_waitcnt vmcnt(0)
    s_cbranch_scc1 K2_R2B6
    v_cmp_eq_u32 vcc, -1, v6
    s_nop 1
    s_cbranch_vccnz K2_R2L6
    s_branch K2_R2B6
K2_LF3:
    s_setprio 1
    v_mfma_f32_16x16x32_bf16 a[0:3], a[92:95], v[8:11], a[0:3]
    v_mfma_f32_16x16x32_bf16 a[20:23], a[92:95], v[12:15], a[20:23]
    v_mfma_f32_16x16x32_bf16 a[40:43], a[92:95], v[16:19], a[40:43]
    v_mfma_f32_16x16x32_bf16 a[60:63], a[92:95], v[20:23], a[60:63]
    v_mfma_f32_16x16x32_bf16 a[0:3], a[112:115], v[24:27], a[0:3]
    v_mfma_f32_16x16x32_bf16 a[20:23], a[112:115], v[28:31], a[20:23]
    v_mfma_f32_16x16x32_bf16 a[40:43], a[112:115], v[32:35], a[40:43]
    v_mfma_f32_16x16x32_bf16 a[60:63], a[112:115], v[36:39], a[60:63]
    v_mfma_f32_16x16x32_bf16 a[4:7], a[96:99], v[8:11], a[4:7]
    v_mfma_f32_16x16x32_bf16 a[24:27], a[96:99], v[12:15], a[24:27]
    v_mfma_f32_16x16x32_bf16 a[44:47], a[96:99], v[16:19], a[44:47]
    v_mfma_f32_16x16x32_bf16 a[64:67], a[96:99], v[20:23], a[64:67]
    v_mfma_f32_16x16x32_bf16 a[4:7], a[116:119], v[24:27], a[4:7]
    ds_write_b128 v113, a[0:3] offset:31744
    v_mfma_f32_16x16x32_bf16 a[24:27], a[116:119], v[28:31], a[24:27]
    ds_write_b128 v113, a[20:23] offset:36864
    v_mfma_f32_16x16x32_bf16 a[44:47], a[116:119], v[32:35], a[44:47]
    ds_write_b128 v113, a[40:43] offset:41984
    v_mfma_f32_16x16x32_bf16 a[64:67], a[116:119], v[36:39], a[64:67]
    ds_write_b128 v2, a[60:63] offset:20480
    v_mfma_f32_16x16x32_bf16 a[8:11], a[100:103], v[8:11], a[8:11]
    v_mfma_f32_16x16x32_bf16 a[28:31], a[100:103], v[12:15], a[28:31]
    v_mfma_f32_16x16x32_bf16 a[48:51], a[100:103], v[16:19], a[48:51]
    v_mfma_f32_16x16x32_bf16 a[68:71], a[100:103], v[20:23], a[68:71]
    v_mfma_f32_16x16x32_bf16 a[8:11], a[120:123], v[24:27], a[8:11]
    ds_write_b128 v113, a[4:7] offset:32768
    v_mfma_f32_16x16x32_bf16 a[28:31], a[120:123], v[28:31], a[28:31]
    ds_write_b128 v113, a[24:27] offset:37888
    v_mfma_f32_16x16x32_bf16 a[48:51], a[120:123], v[32:35], a[48:51]
    ds_write_b128 v113, a[44:47] offset:43008
    v_mfma_f32_16x16x32_bf16 a[68:71], a[120:123], v[36:39], a[68:71]
    ds_write_b128 v2, a[64:67] offset:21504
    v_mfma_f32_16x16x32_bf16 a[12:15], a[104:107], v[8:11], a[12:15]
    v_mfma_f32_16x16x32_bf16 a[32:35], a[104:107], v[12:15], a[32:35]
    v_mfma_f32_16x16x32_bf16 a[52:55], a[104:107], v[16:19], a[52:55]
    v_mfma_f32_16x16x32_bf16 a[72:75], a[104:107], v[20:23], a[72:75]
    v_mfma_f32_16x16x32_bf16 a[12:15], a[124:127], v[24:27], a[12:15]
    ds_write_b128 v113, a[8:11] offset:33792
    v_mfma_f32_16x16x32_bf16 a[32:35], a[124:127], v[28:31], a[32:35]
    ds_write_b128 v113, a[28:31] offset:38912
    v_mfma_f32_16x16x32_bf16 a[52:55], a[124:127], v[32:35], a[52:55]
    ds_write_b128 v113, a[48:51] offset:44032
    v_mfma_f32_16x16x32_bf16 a[72:75], a[124:127], v[36:39], a[72:75]
    v_mfma_f32_16x16x32_bf16 a[16:19], a[108:111], v[8:11], a[16:19]
    v_mfma_f32_16x16x32_bf16 a[36:39], a[108:111], v[12:15], a[36:39]
    v_mfma_f32_16x16x32_bf16 a[56:59], a[108:111], v[16:19], a[56:59]
    v_mfma_f32_16x16x32_bf16 a[76:79], a[108:111], v[20:23], a[76:79]
    v_mfma_f32_16x16x32_bf16 a[16:19], v[72:75], v[24:27], a[16:19]
    ds_write_b128 v113, a[12:15] offset:34816
    v_mfma_f32_16x16x32_bf16 a[36:39], v[72:75], v[28:31], a[36:39]
    ds_write_b128 v113, a[32:35] offset:39936
    v_mfma_f32_16x16x32_bf16 a[56:59], v[72:75], v[32:35], a[56:59]
    ds_write_b128 v113, a[52:55] offset:45056
    v_mfma_f32_16x16x32_bf16 a[76:79], v[72:75], v[36:39], a[76:79]
    v_lshlrev_b32 v1, 3, v3
    v_add_u32 v1, 42496, v1
    v_and_b32 v7, 15, v3
    v_mul_u32_u24 v7, 1280, v7
    v_lshrrev_b32 v4, 4, v3
    v_lshl_add_u32 v7, v4, 3, v7
    ds_write_b128 v113, a[16:19] offset:35840
    ds_write_b128 v113, a[36:39] offset:40960
    ds_write_b128 v113, a[56:59] offset:46080
    v_accvgpr_read_b32 v92, a68
    v_accvgpr_read_b32 v93, a69
    v_accvgpr_read_b32 v94, a70
    v_accvgpr_read_b32 v95, a71
    v_accvgpr_read_b32 v96, a72
    v_accvgpr_read_b32 v97, a73
    v_accvgpr_read_b32 v98, a74
    v_accvgpr_read_b32 v99, a75
    v_accvgpr_read_b32 v100, a76
    v_accvgpr_read_b32 v101, a77
    v_accvgpr_read_b32 v102, a78
    v_accvgpr_read_b32 v103, a79
    s_waitcnt vmcnt(0)
    v_cmp_eq_u32 vcc, -1, v6
    s_nop 1
    s_cbranch_vccnz K2_R2R7
K2_R2B7:
    s_waitcnt lgkmcnt(0)
    s_barrier
    ds_read_b128 v[8:11], v2 offset:3072
    ds_read_b128 v[12:15], v2 offset:8192
    ds_read_b128 v[16:19], v2 offset:13312
    ds_read_b128 v[20:23], v2 offset:18432
    ds_read_b128 v[24:27], v2 offset:59392
    ds_read_b128 v[28:31], v113 offset:11264
    ds_read_b128 v[32:35], v113 offset:28672
    ds_read_b64_tr_b16 v[104:105], v1 offset:1024
    ds_read_b128 v[36:39], v2 offset:4096
    ds_read_b128 v[40:43], v2 offset:9216
    ds_read_b128 v[44:47], v2 offset:14336
    ds_read_b128 v[48:51], v2 offset:19456
    ds_read_b128 v[52:55], v2 offset:60416
    ds_read_b128 v[56:59], v113 offset:12288
    ds_read_b128 v[60:63], v113 offset:29696
    s_waitcnt lgkmcnt(14)
    ds_read_b64_tr_b16 v[106:107], v1 offset:1536
    v_pk_add_f32 v[92:93], v[92:93], v[8:9]
    v_pk_add_f32 v[94:95], v[94:95], v[10:11]
    s_waitcnt lgkmcnt(14)
    ds_read_b128 v[64:67], v2 offset:22528
    v_pk_add_f32 v[92:93], v[92:93], v[12:13]
    v_pk_add_f32 v[94:95], v[94:95], v[14:15]
    s_waitcnt lgkmcnt(14)
    ds_read_b128 v[68:71], v2 offset:25600
    v_pk_add_f32 v[92:93], v[92:93], v[16:17]
    v_pk_add_f32 v[94:95], v[94:95], v[18:19]
    s_waitcnt lgkmcnt(14)
    ds_read_b128 v[72:75], v2 offset:28672
    v_pk_add_f32 v[92:93], v[92:93], v[20:21]
    v_pk_add_f32 v[94:95], v[94:95], v[22:23]
    s_waitcnt lgkmcnt(14)
    ds_read_b128 v[76:79], v2 offset:31744
    v_pk_add_f32 v[92:93], v[92:93], v[24:25]
    v_pk_add_f32 v[94:95], v[94:95], v[26:27]
    s_waitcnt lgkmcnt(14)
    ds_read_b128 v[80:83], v2 offset:61440
    v_pk_add_f32 v[92:93], v[92:93], v[28:29]
    v_pk_add_f32 v[94:95], v[94:95], v[30:31]
    s_waitcnt lgkmcnt(14)
    ds_read_b128 v[84:87], v113 offset:13312
    v_pk_add_f32 v[92:93], v[92:93], v[32:33]
    v_pk_add_f32 v[94:95], v[94:95], v[34:35]
    s_waitcnt lgkmcnt(14)
    ds_read_b128 v[88:91], v113 offset:30720
    v_lshlrev_b32 v8, 16, v104
    v_and_b32 v9, 0xffff0000, v104
    v_lshlrev_b32 v10, 16, v105
    v_and_b32 v11, 0xffff0000, v105
    v_fma_f32 v92, v92, v6, v8
    v_fma_f32 v93, v93, v6, v9
    v_fma_f32 v94, v94, v6, v10
    v_fma_f32 v95, v95, v6, v11
    v_cvt_pk_bf16_f32 v92, v92, v93
    v_cvt_pk_bf16_f32 v93, v94, v95
    buffer_store_dwordx2 v[92:93], v7, s[52:55], s43 offen offset:64
    s_waitcnt lgkmcnt(14)
    ds_read_b64_tr_b16 v[108:109], v1 offset:2048
    v_pk_add_f32 v[96:97], v[96:97], v[36:37]
    v_pk_add_f32 v[98:99], v[98:99], v[38:39]
    s_waitcnt lgkmcnt(14)
    v_pk_add_f32 v[96:97], v[96:97], v[40:41]
    v_pk_add_f32 v[98:99], v[98:99], v[42:43]
    s_waitcnt lgkmcnt(13)
    v_pk_add_f32 v[96:97], v[96:97], v[44:45]
    v_pk_add_f32 v[98:99], v[98:99], v[46:47]
    s_waitcnt lgkmcnt(12)
    v_pk_add_f32 v[96:97], v[96:97], v[48:49]
    v_pk_add_f32 v[98:99], v[98:99], v[50:51]
    s_waitcnt lgkmcnt(11)
    v_pk_add_f32 v[96:97], v[96:97], v[52:53]
    v_pk_add_f32 v[98:99], v[98:99], v[54:55]
    s_waitcnt lgkmcnt(10)
    v_pk_add_f32 v[96:97], v[96:97], v[56:57]
    v_pk_add_f32 v[98:99], v[98:99], v[58:59]
    s_waitcnt lgkmcnt(9)
    v_pk_add_f32 v[96:97], v[96:97], v[60:61]
    v_pk_add_f32 v[98:99], v[98:99], v[62:63]
    s_waitcnt lgkmcnt(8)
    v_lshlrev_b32 v36, 16, v106
    v_and_b32 v37, 0xffff0000, v106
    v_lshlrev_b32 v38, 16, v107
    v_and_b32 v39, 0xffff0000, v107
    v_fma_f32 v96, v96, v6, v36
    v_fma_f32 v97, v97, v6, v37
    v_fma_f32 v98, v98, v6, v38
    v_fma_f32 v99, v99, v6, v39
    v_cvt_pk_bf16_f32 v96, v96, v97
    v_cvt_pk_bf16_f32 v97, v98, v99
    buffer_store_dwordx2 v[96:97], v7, s[52:55], s43 offen offset:96
    s_waitcnt lgkmcnt(7)
    v_pk_add_f32 v[100:101], v[100:101], v[64:65]
    v_pk_add_f32 v[102:103], v[102:103], v[66:67]
    s_waitcnt lgkmcnt(6)
    v_pk_add_f32 v[100:101], v[100:101], v[68:69]
    v_pk_add_f32 v[102:103], v[102:103], v[70:71]
    s_waitcnt lgkmcnt(5)
    v_pk_add_f32 v[100:101], v[100:101], v[72:73]
    v_pk_add_f32 v[102:103], v[102:103], v[74:75]
    s_waitcnt lgkmcnt(4)
    v_pk_add_f32 v[100:101], v[100:101], v[76:77]
    v_pk_add_f32 v[102:103], v[102:103], v[78:79]
    s_waitcnt lgkmcnt(3)
    v_pk_add_f32 v[100:101], v[100:101], v[80:81]
    v_pk_add_f32 v[102:103], v[102:103], v[82:83]
    s_waitcnt lgkmcnt(2)
    v_pk_add_f32 v[100:101], v[100:101], v[84:85]
    v_pk_add_f32 v[102:103], v[102:103], v[86:87]
    s_waitcnt lgkmcnt(1)
    v_pk_add_f32 v[100:101], v[100:101], v[88:89]
    v_pk_add_f32 v[102:103], v[102:103], v[90:91]
    s_waitcnt lgkmcnt(0)
    v_lshlrev_b32 v64, 16, v108
    v_and_b32 v65, 0xffff0000, v108
    v_lshlrev_b32 v66, 16, v109
    v_and_b32 v67, 0xffff0000, v109
    v_fma_f32 v100, v100, v6, v64
    v_fma_f32 v101, v101, v6, v65
    v_fma_f32 v102, v102, v6, v66
    v_fma_f32 v103, v103, v6, v67
    v_cvt_pk_bf16_f32 v100, v100, v101
    v_cvt_pk_bf16_f32 v101, v102, v103
    buffer_store_dwordx2 v[100:101], v7, s[52:55], s43 offen offset:128
    s_endpgm
K2_R2R7:
    s_mov_b32 s35, 0
K2_R2L7:
    buffer_load_dword v6, v5, s[16:19], s42 offen sc1
    s_add_u32 s35, s35, 1
    s_cmp_gt_u32 s35, 4000
    s_waitcnt vmcnt(0)
    s_cbranch_scc1 K2_R2B7
    v_cmp_eq_u32 vcc, -1, v6
    s_nop 1
    s_cbranch_vccnz K2_R2L7
    s_branch K2_R2B7
K_PK:
    s_sub_u32 s6, s94, 160
    s_cmp_ge_u32 s6, 84
    s_waitcnt lgkmcnt(0)
    s_cbranch_scc1 K_BEAT
    v_and_b32 v3, 63, v0
    v_bfe_u32 v8, v0, 4, 2
    v_lshlrev_b32 v2, 4, v3
    v_mov_b32 v1, 161856
    s_add_u32 s48, s44, 0x530000
    s_addc_u32 s49, s45, 0
    s_mov_b32 s50, 0x4000
    s_mov_b32 s51, 0x20000
    s_mov_b32 s24, s52
    s_mov_b32 s25, s53
    s_mov_b32 s26, 0x21c000
    s_mov_b32 s27, 0x20000
    s_cmp_ge_u32 s6, 54
    s_cbranch_scc1 K1_SRC_D
    s_cmp_ge_u32 s6, 27
    s_cselect_b32 s5, 1, 0
    s_cselect_b32 s24, s54, s52
    s_cselect_b32 s25, s55, s53
    s_mul_i32 s28, s5, 27
    s_sub_u32 s6, s6, s28
    s_mov_b32 s7, 3456
    s_lshl_b32 s28, s6, 7
    s_branch K1_SRC_E
K1_SRC_D:
    s_mov_b32 s24, s56
    s_mov_b32 s25, s57
    s_sub_u32 s6, s6, 54
    s_cmp_ge_u32 s6, 10
    s_cselect_b32 s5, 1, 0
    s_cmp_ge_u32 s6, 20
    s_cselect_b32 s5, 2, s5
    s_mul_i32 s28, s5, 10
    s_sub_u32 s6, s6, s28
    s_mul_i32 s28, s5, 737280
    s_lshl_b32 s7, s6, 7
    s_add_u32 s28, s28, s7
    s_mov_b32 s7, 1280
    s_add_u32 s5, s5, 2
K1_SRC_E:
    v_lshrrev_b32 v5, 3, v3
    v_lshl_add_u32 v5, v4, 3, v5
    v_mul_lo_u32 v5, v5, s7
    v_lshrrev_b32 v6, 1, v3
    v_xor_b32 v6, v6, v8
    v_and_b32 v6, 3, v6
    v_lshl_add_u32 v5, v6, 5, v5
    v_and_b32 v6, 1, v3
    v_lshl_add_u32 v5, v6, 4, v5
    s_lshl_b32 s35, s7, 5
    s_lshl_b32 s34, s3, 10
    s_add_u32 s34, s34, 45056
    s_mov_b32 m0, s34
    s_add_u32 s34, s34, 4096
    buffer_load_dwordx4 v5, s[24:27], s28 offen nt lds
    s_add_u32 s28, s28, s35
    s_mov_b32 m0, s34
    s_add_u32 s34, s34, 4096
    buffer_load_dwordx4 v5, s[24:27], s28 offen nt lds
    s_add_u32 s28, s28, s35
    s_mov_b32 m0, s34
    s_add_u32 s34, s34, 4096
    buffer_load_dwordx4 v5, s[24:27], s28 offen nt lds
    s_add_u32 s28, s28, s35
    s_mov_b32 m0, s34
    s_add_u32 s34, s34, 4096
    buffer_load_dwordx4 v5, s[24:27], s28 offen nt lds
    s_add_u32 s28, s28, s35
    s_cmp_ge_u32 s94, 214
    s_cbranch_scc1 K_PW_X
    s_mov_b32 s42, 0
K_PW:
    ds_read_b32 v22, v1 offset:8
    s_add_u32 s42, s42, 1
    s_cmp_gt_u32 s42, 256000
    s_cbranch_scc1 K_PW_X
    s_waitcnt lgkmcnt(0)
    v_cmp_gt_u32 vcc, 1, v22
    s_nop 1
    s_cbranch_vccnz K_PW
K_PW_X:
    s_waitcnt lgkmcnt(0)
    s_mov_b32 m0, s34
    s_add_u32 s34, s34, 4096
    buffer_load_dwordx4 v5, s[24:27], s28 offen nt lds
    s_add_u32 s28, s28, s35
    s_mov_b32 m0, s34
    s_add_u32 s34, s34, 4096
    buffer_load_dwordx4 v5, s[24:27], s28 offen nt lds
    s_add_u32 s28, s28, s35
    s_mov_b32 m0, s34
    s_add_u32 s34, s34, 4096
    buffer_load_dwordx4 v5, s[24:27], s28 offen nt lds
    s_add_u32 s28, s28, s35
    s_mov_b32 m0, s34
    s_add_u32 s34, s34, 4096
    buffer_load_dwordx4 v5, s[24:27], s28 offen nt lds
    s_add_u32 s28, s28, s35
    s_mov_b32 m0, s34
    s_add_u32 s34, s34, 4096
    buffer_load_dwordx4 v5, s[24:27], s28 offen nt lds
    s_add_u32 s28, s28, s35
    s_mov_b32 m0, s34
    s_add_u32 s34, s34, 4096
    buffer_load_dwordx4 v5, s[24:27], s28 offen nt lds
    s_add_u32 s28, s28, s35
    s_mov_b32 m0, s34
    s_add_u32 s34, s34, 4096
    buffer_load_dwordx4 v5, s[24:27], s28 offen nt lds
    s_add_u32 s28, s28, s35
    s_mov_b32 m0, s34
    s_add_u32 s34, s34, 4096
    buffer_load_dwordx4 v5, s[24:27], s28 offen nt lds
    s_add_u32 s28, s28, s35
    s_mov_b32 m0, s34
    s_add_u32 s34, s34, 4096
    buffer_load_dwordx4 v5, s[24:27], s28 offen nt lds
    s_add_u32 s28, s28, s35
    s_mov_b32 m0, s34
    s_add_u32 s34, s34, 4096
    buffer_load_dwordx4 v5, s[24:27], s28 offen nt lds
    s_add_u32 s28, s28, s35
    s_mov_b32 m0, s34
    s_add_u32 s34, s34, 4096
    buffer_load_dwordx4 v5, s[24:27], s28 offen nt lds
    s_add_u32 s28, s28, s35
    s_mov_b32 m0, s34
    s_add_u32 s34, s34, 4096
    buffer_load_dwordx4 v5, s[24:27], s28 offen nt lds
    s_add_u32 s28, s28, s35
    s_mov_b32 m0, s34
    s_add_u32 s34, s34, 4096
    buffer_load_dwordx4 v5, s[24:27], s28 offen nt lds
    s_add_u32 s28, s28, s35
    s_mov_b32 m0, s34
    s_add_u32 s34, s34, 4096
    buffer_load_dwordx4 v5, s[24:27], s28 offen nt lds
    s_add_u32 s28, s28, s35
    s_mov_b32 m0, s34
    s_add_u32 s34, s34, 4096
    buffer_load_dwordx4 v5, s[24:27], s28 offen nt lds
    s_add_u32 s28, s28, s35
    s_mov_b32 m0, s34
    s_add_u32 s34, s34, 4096
    buffer_load_dwordx4 v5, s[24:27], s28 offen nt lds
    s_add_u32 s28, s28, s35
    s_mov_b32 s12, s44
    s_mov_b32 s13, s45
    s_mov_b32 s14, 0x101c000
    s_mov_b32 s15, 0x20000
    v_lshrrev_b32 v6, 3, v3
    v_xor_b32 v6, v6, v4
    v_and_b32 v6, 3, v6
    v_lshlrev_b32 v6, 5, v6
    v_lshrrev_b32 v7, 2, v3
    v_lshl_add_u32 v6, v7, 7, v6
    v_and_b32 v7, 3, v3
    v_lshl_add_u32 v6, v7, 3, v6
    v_add_u32 v6, 45056, v6
    v_add_u32 v7, 40960, v6
    s_lshl_b32 s29, s6, 2
    s_add_u32 s29, s29, s3
    s_cmp_ge_u32 s5, 2
    s_cbranch_scc1 K_PACK_D
    s_mul_i32 s30, s29, 9363
    s_lshr_b32 s30, s30, 16
    s_mul_i32 s31, s30, 7
    s_sub_u32 s31, s29, s31
    s_lshl_b32 s32, s31, 1
    s_add_u32 s32, s32, s5
    s_sub_u32 s33, s32, 1
    s_cmp_gt_u32 s31, 3
    s_cselect_b32 s32, s33, s32
    s_cmp_eq_u32 s32, 7
    s_cselect_b32 s33, 1, 0
    s_cmp_eq_u32 s31, 3
    s_cselect_b32 s33, s33, 0
    s_mul_i32 s33, s33, 6
    s_add_u32 s32, s32, s33
    s_mul_i32 s29, s30, 286720
    s_lshl_b32 s32, s32, 10
    s_add_u32 s29, s29, s32
    s_add_u32 s29, s29, 0x900000
    v_bfe_u32 v8, v3, 2, 2
    v_lshrrev_b32 v9, 4, v3
    v_cmp_eq_u32 vcc, v8, v9
    v_and_b32 v8, 1, v3
    v_lshlrev_b32 v8, 4, v8
    v_mov_b32 v9, 0x3f80
    v_lshlrev_b32 v8, v8, v9
    v_cndmask_b32 v8, 0, v8, vcc
    v_and_b32 v9, 2, v3
    v_cmp_eq_u32 vcc, 0, v9
    s_nop 1
    v_cndmask_b32 v18, 0, v8, vcc
    v_sub_u32 v19, v8, v18
    v_mov_b32 v16, 0
    v_mov_b32 v17, 0
    v_mov_b32 v20, 0
    v_mov_b32 v21, 0
    v_mov_b32 v8, 0x3f803f80
    v_mov_b32 v9, 0x3f803f80
    v_mov_b32 v10, 0x3f803f80
    v_mov_b32 v11, 0x3f803f80
    s_waitcnt vmcnt(15)
    s_mov_b64 exec, 1
    ds_inc_u32 v1, v1 offset:16
    s_mov_b64 exec, -1
    s_mov_b32 s35, 0
K_PA0:
    ds_read_b32 v22, v1 offset:16
    s_add_u32 s35, s35, 1
    s_cmp_gt_u32 s35, 256000
    s_cbranch_scc1 K_PA0_X
    s_waitcnt lgkmcnt(0)
    v_cmp_gt_u32 vcc, 4, v22
    s_nop 1
    s_cbranch_vccnz K_PA0
K_PA0_X:
    s_waitcnt lgkmcnt(0)
    ds_read_b64_tr_b16 a[0:1], v6 offset:0
    ds_read_b64_tr_b16 a[2:3], v6 offset:2048
    ds_read_b64_tr_b16 a[4:5], v6 offset:4096
    ds_read_b64_tr_b16 a[6:7], v6 offset:6144
    ds_read_b64_tr_b16 a[8:9], v6 offset:8192
    ds_read_b64_tr_b16 a[10:11], v6 offset:10240
    ds_read_b64_tr_b16 a[12:13], v6 offset:12288
    ds_read_b64_tr_b16 a[14:15], v6 offset:14336
    ds_read_b64_tr_b16 a[16:17], v6 offset:16384
    ds_read_b64_tr_b16 a[18:19], v6 offset:18432
    s_waitcnt lgkmcnt(8)
    v_mfma_f32_16x16x32_bf16 v[12:15], v[8:11], a[0:3], 0
    s_waitcnt lgkmcnt(6)
    v_mfma_f32_16x16x32_bf16 v[12:15], v[8:11], a[4:7], v[12:15]
    s_waitcnt lgkmcnt(4)
    v_mfma_f32_16x16x32_bf16 v[12:15], v[8:11], a[8:11], v[12:15]
    s_waitcnt lgkmcnt(2)
    v_mfma_f32_16x16x32_bf16 v[12:15], v[8:11], a[12:15], v[12:15]
    s_waitcnt lgkmcnt(0)
    v_mfma_f32_16x16x32_bf16 v[12:15], v[8:11], a[16:19], v[12:15]
    s_waitcnt vmcnt(10)
    s_mov_b64 exec, 1
    ds_inc_u32 v1, v1 offset:16
    s_mov_b64 exec, -1
    s_mov_b32 s35, 0
K_PA1:
    ds_read_b32 v22, v1 offset:16
    s_add_u32 s35, s35, 1
    s_cmp_gt_u32 s35, 256000
    s_cbranch_scc1 K_PA1_X
    s_waitcnt lgkmcnt(0)
    v_cmp_gt_u32 vcc, 8, v22
    s_nop 1
    s_cbranch_vccnz K_PA1
K_PA1_X:
    s_waitcnt lgkmcnt(0)
    ds_read_b64_tr_b16 a[20:21], v6 offset:20480
    ds_read_b64_tr_b16 a[22:23], v6 offset:22528
    ds_read_b64_tr_b16 a[24:25], v6 offset:24576
    ds_read_b64_tr_b16 a[26:27], v6 offset:26624
    ds_read_b64_tr_b16 a[28:29], v6 offset:28672
    ds_read_b64_tr_b16 a[30:31], v6 offset:30720
    ds_read_b64_tr_b16 a[32:33], v6 offset:32768
    ds_read_b64_tr_b16 a[34:35], v6 offset:34816
    ds_read_b64_tr_b16 a[36:37], v6 offset:36864
    ds_read_b64_tr_b16 a[38:39], v6 offset:38912
    s_waitcnt lgkmcnt(8)
    v_mfma_f32_16x16x32_bf16 v[12:15], v[8:11], a[20:23], v[12:15]
    s_waitcnt lgkmcnt(6)
    v_mfma_f32_16x16x32_bf16 v[12:15], v[8:11], a[24:27], v[12:15]
    s_waitcnt lgkmcnt(4)
    v_mfma_f32_16x16x32_bf16 v[12:15], v[8:11], a[28:31], v[12:15]
    s_waitcnt lgkmcnt(2)
    v_mfma_f32_16x16x32_bf16 v[12:15], v[8:11], a[32:35], v[12:15]
    s_waitcnt lgkmcnt(0)
    v_mfma_f32_16x16x32_bf16 v[12:15], v[8:11], a[36:39], v[12:15]
    s_waitcnt vmcnt(5)
    s_mov_b64 exec, 1
    ds_inc_u32 v1, v1 offset:16
    s_mov_b64 exec, -1
    s_mov_b32 s35, 0
K_PA2:
    ds_read_b32 v22, v1 offset:16
    s_add_u32 s35, s35, 1
    s_cmp_gt_u32 s35, 256000
    s_cbranch_scc1 K_PA2_X
    s_waitcnt lgkmcnt(0)
    v_cmp_gt_u32 vcc, 12, v22
    s_nop 1
    s_cbranch_vccnz K_PA2
K_PA2_X:
    s_waitcnt lgkmcnt(0)
    ds_read_b64_tr_b16 a[40:41], v7 offset:0
    ds_read_b64_tr_b16 a[42:43], v7 offset:2048
    ds_read_b64_tr_b16 a[44:45], v7 offset:4096
    ds_read_b64_tr_b16 a[46:47], v7 offset:6144
    ds_read_b64_tr_b16 a[48:49], v7 offset:8192
    ds_read_b64_tr_b16 a[50:51], v7 offset:10240
    ds_read_b64_tr_b16 a[52:53], v7 offset:12288
    ds_read_b64_tr_b16 a[54:55], v7 offset:14336
    ds_read_b64_tr_b16 a[56:57], v7 offset:16384
    ds_read_b64_tr_b16 a[58:59], v7 offset:18432
    s_waitcnt lgkmcnt(8)
    v_mfma_f32_16x16x32_bf16 v[12:15], v[8:11], a[40:43], v[12:15]
    s_waitcnt lgkmcnt(6)
    v_mfma_f32_16x16x32_bf16 v[12:15], v[8:11], a[44:47], v[12:15]
    s_waitcnt lgkmcnt(4)
    v_mfma_f32_16x16x32_bf16 v[12:15], v[8:11], a[48:51], v[12:15]
    s_waitcnt lgkmcnt(2)
    v_mfma_f32_16x16x32_bf16 v[12:15], v[8:11], a[52:55], v[12:15]
    s_waitcnt lgkmcnt(0)
    v_mfma_f32_16x16x32_bf16 v[12:15], v[8:11], a[56:59], v[12:15]
    s_waitcnt vmcnt(0)
    s_mov_b64 exec, 1
    ds_inc_u32 v1, v1 offset:16
    s_mov_b64 exec, -1
    s_mov_b32 s35, 0
K_PA3:
    ds_read_b32 v22, v1 offset:16
    s_add_u32 s35, s35, 1
    s_cmp_gt_u32 s35, 256000
    s_cbranch_scc1 K_PA3_X
    s_waitcnt lgkmcnt(0)
    v_cmp_gt_u32 vcc, 16, v22
    s_nop 1
    s_cbranch_vccnz K_PA3
K_PA3_X:
    s_waitcnt lgkmcnt(0)
    ds_read_b64_tr_b16 a[60:61], v7 offset:20480
    ds_read_b64_tr_b16 a[62:63], v7 offset:22528
    ds_read_b64_tr_b16 a[64:65], v7 offset:24576
    ds_read_b64_tr_b16 a[66:67], v7 offset:26624
    ds_read_b64_tr_b16 a[68:69], v7 offset:28672
    ds_read_b64_tr_b16 a[70:71], v7 offset:30720
    ds_read_b64_tr_b16 a[72:73], v7 offset:32768
    ds_read_b64_tr_b16 a[74:75], v7 offset:34816
    ds_read_b64_tr_b16 a[76:77], v7 offset:36864
    ds_read_b64_tr_b16 a[78:79], v7 offset:38912
    s_waitcnt lgkmcnt(8)
    v_mfma_f32_16x16x32_bf16 v[12:15], v[8:11], a[60:63], v[12:15]
    s_waitcnt lgkmcnt(6)
    v_mfma_f32_16x16x32_bf16 v[12:15], v[8:11], a[64:67], v[12:15]
    s_waitcnt lgkmcnt(4)
    v_mfma_f32_16x16x32_bf16 v[12:15], v[8:11], a[68:71], v[12:15]
    s_waitcnt lgkmcnt(2)
    v_mfma_f32_16x16x32_bf16 v[12:15], v[8:11], a[72:75], v[12:15]
    s_waitcnt lgkmcnt(0)
    v_mfma_f32_16x16x32_bf16 v[12:15], v[8:11], a[76:79], v[12:15]
    s_nop 7
    v_mul_f32 v12, 0xbacccccd, v12
    v_mul_f32 v13, 0xbacccccd, v13
    v_mul_f32 v14, 0xbacccccd, v14
    v_mul_f32 v15, 0xbacccccd, v15
    s_nop 1
    v_mfma_f32_16x16x32_bf16 v[32:35], v[18:21], a[0:3], v[12:15]
    v_mfma_f32_16x16x32_bf16 v[36:39], v[16:19], a[0:3], v[12:15]
    v_mfma_f32_16x16x32_bf16 v[40:43], v[18:21], a[4:7], v[12:15]
    v_mfma_f32_16x16x32_bf16 v[44:47], v[16:19], a[4:7], v[12:15]
    v_mfma_f32_16x16x32_bf16 v[48:51], v[18:21], a[8:11], v[12:15]
    v_mfma_f32_16x16x32_bf16 v[52:55], v[16:19], a[8:11], v[12:15]
    s_nop 2
    v_cvt_pk_bf16_f32 v64, v32, v33
    v_cvt_pk_bf16_f32 v65, v34, v35
    v_cvt_pk_bf16_f32 v66, v36, v37
    v_cvt_pk_bf16_f32 v67, v38, v39
    buffer_store_dwordx4 v[64:67], v2, s[12:15], s29 offen sc1
    s_add_u32 s29, s29, 14336
    v_mfma_f32_16x16x32_bf16 v[56:59], v[18:21], a[12:15], v[12:15]
    v_mfma_f32_16x16x32_bf16 v[60:63], v[16:19], a[12:15], v[12:15]
    v_cvt_pk_bf16_f32 v68, v40, v41
    v_cvt_pk_bf16_f32 v69, v42, v43
    v_cvt_pk_bf16_f32 v70, v44, v45
    v_cvt_pk_bf16_f32 v71, v46, v47
    buffer_store_dwordx4 v[68:71], v2, s[12:15], s29 offen sc1
    s_add_u32 s29, s29, 14336
    v_mfma_f32_16x16x32_bf16 v[32:35], v[18:21], a[16:19], v[12:15]
    v_mfma_f32_16x16x32_bf16 v[36:39], v[16:19], a[16:19], v[12:15]
    v_cvt_pk_bf16_f32 v72, v48, v49
    v_cvt_pk_bf16_f32 v73, v50, v51
    v_cvt_pk_bf16_f32 v74, v52, v53
    v_cvt_pk_bf16_f32 v75, v54, v55
    buffer_store_dwordx4 v[72:75], v2, s[12:15], s29 offen sc1
    s_add_u32 s29, s29, 14336
    v_mfma_f32_16x16x32_bf16 v[40:43], v[18:21], a[20:23], v[12:15]
    v_mfma_f32_16x16x32_bf16 v[44:47], v[16:19], a[20:23], v[12:15]
    v_cvt_pk_bf16_f32 v76, v56, v57
    v_cvt_pk_bf16_f32 v77, v58, v59
    v_cvt_pk_bf16_f32 v78, v60, v61
    v_cvt_pk_bf16_f32 v79, v62, v63
    buffer_store_dwordx4 v[76:79], v2, s[12:15], s29 offen sc1
    s_add_u32 s29, s29, 14336
    v_mfma_f32_16x16x32_bf16 v[48:51], v[18:21], a[24:27], v[12:15]
    v_mfma_f32_16x16x32_bf16 v[52:55], v[16:19], a[24:27], v[12:15]
    v_cvt_pk_bf16_f32 v80, v32, v33
    v_cvt_pk_bf16_f32 v81, v34, v35
    v_cvt_pk_bf16_f32 v82, v36, v37
    v_cvt_pk_bf16_f32 v83, v38, v39
    buffer_store_dwordx4 v[80:83], v2, s[12:15], s29 offen sc1
    s_add_u32 s29, s29, 14336
    v_mfma_f32_16x16x32_bf16 v[56:59], v[18:21], a[28:31], v[12:15]
    v_mfma_f32_16x16x32_bf16 v[60:63], v[16:19], a[28:31], v[12:15]
    v_cvt_pk_bf16_f32 v84, v40, v41
    v_cvt_pk_bf16_f32 v85, v42, v43
    v_cvt_pk_bf16_f32 v86, v44, v45
    v_cvt_pk_bf16_f32 v87, v46, v47
    buffer_store_dwordx4 v[84:87], v2, s[12:15], s29 offen sc1
    s_add_u32 s29, s29, 14336
    v_mfma_f32_16x16x32_bf16 v[32:35], v[18:21], a[32:35], v[12:15]
    v_mfma_f32_16x16x32_bf16 v[36:39], v[16:19], a[32:35], v[12:15]
    v_cvt_pk_bf16_f32 v88, v48, v49
    v_cvt_pk_bf16_f32 v89, v50, v51
    v_cvt_pk_bf16_f32 v90, v52, v53
    v_cvt_pk_bf16_f32 v91, v54, v55
    buffer_store_dwordx4 v[88:91], v2, s[12:15], s29 offen sc1
    s_add_u32 s29, s29, 14336
    v_mfma_f32_16x16x32_bf16 v[40:43], v[18:21], a[36:39], v[12:15]
    v_mfma_f32_16x16x32_bf16 v[44:47], v[16:19], a[36:39], v[12:15]
    v_cvt_pk_bf16_f32 v92, v56, v57
    v_cvt_pk_bf16_f32 v93, v58, v59
    v_cvt_pk_bf16_f32 v94, v60, v61
    v_cvt_pk_bf16_f32 v95, v62, v63
    buffer_store_dwordx4 v[92:95], v2, s[12:15], s29 offen sc1
    s_add_u32 s29, s29, 14336
    v_mfma_f32_16x16x32_bf16 v[48:51], v[18:21], a[40:43], v[12:15]
    v_mfma_f32_16x16x32_bf16 v[52:55], v[16:19], a[40:43], v[12:15]
    v_cvt_pk_bf16_f32 v96, v32, v33
    v_cvt_pk_bf16_f32 v97, v34, v35
    v_cvt_pk_bf16_f32 v98, v36, v37
    v_cvt_pk_bf16_f32 v99, v38, v39
    buffer_store_dwordx4 v[96:99], v2, s[12:15], s29 offen sc1
    s_add_u32 s29, s29, 14336
    v_mfma_f32_16x16x32_bf16 v[56:59], v[18:21], a[44:47], v[12:15]
    v_mfma_f32_16x16x32_bf16 v[60:63], v[16:19], a[44:47], v[12:15]
    v_cvt_pk_bf16_f32 v100, v40, v41
    v_cvt_pk_bf16_f32 v101, v42, v43
    v_cvt_pk_bf16_f32 v102, v44, v45
    v_cvt_pk_bf16_f32 v103, v46, v47
    buffer_store_dwordx4 v[100:103], v2, s[12:15], s29 offen sc1
    s_add_u32 s29, s29, 14336
    v_mfma_f32_16x16x32_bf16 v[32:35], v[18:21], a[48:51], v[12:15]
    v_mfma_f32_16x16x32_bf16 v[36:39], v[16:19], a[48:51], v[12:15]
    v_cvt_pk_bf16_f32 v104, v48, v49
    v_cvt_pk_bf16_f32 v105, v50, v51
    v_cvt_pk_bf16_f32 v106, v52, v53
    v_cvt_pk_bf16_f32 v107, v54, v55
    buffer_store_dwordx4 v[104:107], v2, s[12:15], s29 offen sc1
    s_add_u32 s29, s29, 14336
    v_mfma_f32_16x16x32_bf16 v[40:43], v[18:21], a[52:55], v[12:15]
    v_mfma_f32_16x16x32_bf16 v[44:47], v[16:19], a[52:55], v[12:15]
    v_cvt_pk_bf16_f32 v108, v56, v57
    v_cvt_pk_bf16_f32 v109, v58, v59
    v_cvt_pk_bf16_f32 v110, v60, v61
    v_cvt_pk_bf16_f32 v111, v62, v63
    buffer_store_dwordx4 v[108:111], v2, s[12:15], s29 offen sc1
    s_add_u32 s29, s29, 14336
    v_mfma_f32_16x16x32_bf16 v[48:51], v[18:21], a[56:59], v[12:15]
    v_mfma_f32_16x16x32_bf16 v[52:55], v[16:19], a[56:59], v[12:15]
    v_cvt_pk_bf16_f32 v112, v32, v33
    v_cvt_pk_bf16_f32 v113, v34, v35
    v_cvt_pk_bf16_f32 v114, v36, v37
    v_cvt_pk_bf16_f32 v115, v38, v39
    buffer_store_dwordx4 v[112:115], v2, s[12:15], s29 offen sc1
    s_add_u32 s29, s29, 14336
    v_mfma_f32_16x16x32_bf16 v[56:59], v[18:21], a[60:63], v[12:15]
    v_mfma_f32_16x16x32_bf16 v[60:63], v[16:19], a[60:63], v[12:15]
    v_cvt_pk_bf16_f32 v116, v40, v41
    v_cvt_pk_bf16_f32 v117, v42, v43
    v_cvt_pk_bf16_f32 v118, v44, v45
    v_cvt_pk_bf16_f32 v119, v46, v47
    buffer_store_dwordx4 v[116:119], v2, s[12:15], s29 offen sc1
    s_add_u32 s29, s29, 14336
    v_mfma_f32_16x16x32_bf16 v[32:35], v[18:21], a[64:67], v[12:15]
    v_mfma_f32_16x16x32_bf16 v[36:39], v[16:19], a[64:67], v[12:15]
    v_cvt_pk_bf16_f32 v120, v48, v49
    v_cvt_pk_bf16_f32 v121, v50, v51
    v_cvt_pk_bf16_f32 v122, v52, v53
    v_cvt_pk_bf16_f32 v123, v54, v55
    buffer_store_dwordx4 v[120:123], v2, s[12:15], s29 offen sc1
    s_add_u32 s29, s29, 14336
    v_mfma_f32_16x16x32_bf16 v[40:43], v[18:21], a[68:71], v[12:15]
    v_mfma_f32_16x16x32_bf16 v[44:47], v[16:19], a[68:71], v[12:15]
    v_cvt_pk_bf16_f32 v124, v56, v57
    v_cvt_pk_bf16_f32 v125, v58, v59
    v_cvt_pk_bf16_f32 v126, v60, v61
    v_cvt_pk_bf16_f32 v127, v62, v63
    buffer_store_dwordx4 v[124:127], v2, s[12:15], s29 offen sc1
    s_add_u32 s29, s29, 14336
    v_mfma_f32_16x16x32_bf16 v[48:51], v[18:21], a[72:75], v[12:15]
    v_mfma_f32_16x16x32_bf16 v[52:55], v[16:19], a[72:75], v[12:15]
    v_cvt_pk_bf16_f32 v64, v32, v33
    v_cvt_pk_bf16_f32 v65, v34, v35
    v_cvt_pk_bf16_f32 v66, v36, v37
    v_cvt_pk_bf16_f32 v67, v38, v39
    buffer_store_dwordx4 v[64:67], v2, s[12:15], s29 offen sc1
    s_add_u32 s29, s29, 14336
    v_mfma_f32_16x16x32_bf16 v[56:59], v[18:21], a[76:79], v[12:15]
    v_mfma_f32_16x16x32_bf16 v[60:63], v[16:19], a[76:79], v[12:15]
    v_cvt_pk_bf16_f32 v68, v40, v41
    v_cvt_pk_bf16_f32 v69, v42, v43
    v_cvt_pk_bf16_f32 v70, v44, v45
    v_cvt_pk_bf16_f32 v71, v46, v47
    buffer_store_dwordx4 v[68:71], v2, s[12:15], s29 offen sc1
    s_add_u32 s29, s29, 14336
    v_cvt_pk_bf16_f32 v72, v48, v49
    v_cvt_pk_bf16_f32 v73, v50, v51
    v_cvt_pk_bf16_f32 v74, v52, v53
    v_cvt_pk_bf16_f32 v75, v54, v55
    buffer_store_dwordx4 v[72:75], v2, s[12:15], s29 offen sc1
    s_add_u32 s29, s29, 14336
    v_cvt_pk_bf16_f32 v76, v56, v57
    v_cvt_pk_bf16_f32 v77, v58, v59
    v_cvt_pk_bf16_f32 v78, v60, v61
    v_cvt_pk_bf16_f32 v79, v62, v63
    buffer_store_dwordx4 v[76:79], v2, s[12:15], s29 offen sc1
    s_add_u32 s29, s29, 14336
    s_branch K_PE
K_PACK_D:
    s_mul_i32 s30, s29, 52429
    s_lshr_b32 s30, s30, 18
    s_mul_i32 s31, s30, 5
    s_sub_u32 s31, s29, s31
    s_mul_i32 s29, s30, 276480
    s_lshl_b32 s31, s31, 10
    s_add_u32 s29, s29, s31
    s_sub_u32 s31, s5, 2
    s_mul_i32 s31, s31, 92160
    s_add_u32 s29, s29, s31
    s_add_u32 s29, s29, 0xe00000
    s_waitcnt vmcnt(14)
    s_mov_b64 exec, 1
    ds_inc_u32 v1, v1 offset:16
    s_mov_b64 exec, -1
    s_mov_b32 s35, 0
K_PD0:
    ds_read_b32 v22, v1 offset:16
    s_add_u32 s35, s35, 1
    s_cmp_gt_u32 s35, 256000
    s_cbranch_scc1 K_PD0_X
    s_waitcnt lgkmcnt(0)
    v_cmp_gt_u32 vcc, 4, v22
    s_nop 1
    s_cbranch_vccnz K_PD0
K_PD0_X:
    s_waitcnt lgkmcnt(0)
    ds_read_b64_tr_b16 a[0:1], v6 offset:0
    ds_read_b64_tr_b16 a[2:3], v6 offset:2048
    ds_read_b64_tr_b16 a[4:5], v6 offset:4096
    ds_read_b64_tr_b16 a[6:7], v6 offset:6144
    ds_read_b64_tr_b16 a[8:9], v6 offset:8192
    ds_read_b64_tr_b16 a[10:11], v6 offset:10240
    ds_read_b64_tr_b16 a[12:13], v6 offset:12288
    ds_read_b64_tr_b16 a[14:15], v6 offset:14336
    ds_read_b64_tr_b16 a[16:17], v6 offset:16384
    ds_read_b64_tr_b16 a[18:19], v6 offset:18432
    ds_read_b64_tr_b16 a[20:21], v6 offset:20480
    ds_read_b64_tr_b16 a[22:23], v6 offset:22528
    s_waitcnt lgkmcnt(10)
    buffer_store_dwordx4 a[0:3], v2, s[12:15], s29 offen sc1
    s_add_u32 s29, s29, 5120
    s_waitcnt lgkmcnt(8)
    buffer_store_dwordx4 a[4:7], v2, s[12:15], s29 offen sc1
    s_add_u32 s29, s29, 5120
    s_waitcnt lgkmcnt(6)
    buffer_store_dwordx4 a[8:11], v2, s[12:15], s29 offen sc1
    s_add_u32 s29, s29, 5120
    s_waitcnt lgkmcnt(4)
    buffer_store_dwordx4 a[12:15], v2, s[12:15], s29 offen sc1
    s_add_u32 s29, s29, 5120
    s_waitcnt lgkmcnt(2)
    buffer_store_dwordx4 a[16:19], v2, s[12:15], s29 offen sc1
    s_add_u32 s29, s29, 5120
    s_waitcnt lgkmcnt(0)
    buffer_store_dwordx4 a[20:23], v2, s[12:15], s29 offen sc1
    s_add_u32 s29, s29, 5120
    s_waitcnt vmcnt(14)
    s_mov_b64 exec, 1
    ds_inc_u32 v1, v1 offset:16
    s_mov_b64 exec, -1
    s_mov_b32 s35, 0
K_PD1:
    ds_read_b32 v22, v1 offset:16
    s_add_u32 s35, s35, 1
    s_cmp_gt_u32 s35, 256000
    s_cbranch_scc1 K_PD1_X
    s_waitcnt lgkmcnt(0)
    v_cmp_gt_u32 vcc, 8, v22
    s_nop 1
    s_cbranch_vccnz K_PD1
K_PD1_X:
    s_waitcnt lgkmcnt(0)
    ds_read_b64_tr_b16 a[24:25], v6 offset:24576
    ds_read_b64_tr_b16 a[26:27], v6 offset:26624
    ds_read_b64_tr_b16 a[28:29], v6 offset:28672
    ds_read_b64_tr_b16 a[30:31], v6 offset:30720
    ds_read_b64_tr_b16 a[32:33], v6 offset:32768
    ds_read_b64_tr_b16 a[34:35], v6 offset:34816
    ds_read_b64_tr_b16 a[36:37], v6 offset:36864
    ds_read_b64_tr_b16 a[38:39], v6 offset:38912
    ds_read_b64_tr_b16 a[40:41], v7 offset:0
    ds_read_b64_tr_b16 a[42:43], v7 offset:2048
    ds_read_b64_tr_b16 a[44:45], v7 offset:4096
    ds_read_b64_tr_b16 a[46:47], v7 offset:6144
    s_waitcnt lgkmcnt(10)
    buffer_store_dwordx4 a[24:27], v2, s[12:15], s29 offen sc1
    s_add_u32 s29, s29, 5120
    s_waitcnt lgkmcnt(8)
    buffer_store_dwordx4 a[28:31], v2, s[12:15], s29 offen sc1
    s_add_u32 s29, s29, 5120
    s_waitcnt lgkmcnt(6)
    buffer_store_dwordx4 a[32:35], v2, s[12:15], s29 offen sc1
    s_add_u32 s29, s29, 5120
    s_waitcnt lgkmcnt(4)
    buffer_store_dwordx4 a[36:39], v2, s[12:15], s29 offen sc1
    s_add_u32 s29, s29, 5120
    s_waitcnt lgkmcnt(2)
    buffer_store_dwordx4 a[40:43], v2, s[12:15], s29 offen sc1
    s_add_u32 s29, s29, 5120
    s_waitcnt lgkmcnt(0)
    buffer_store_dwordx4 a[44:47], v2, s[12:15], s29 offen sc1
    s_add_u32 s29, s29, 5120
    s_waitcnt vmcnt(14)
    s_mov_b64 exec, 1
    ds_inc_u32 v1, v1 offset:16
    s_mov_b64 exec, -1
    s_mov_b32 s35, 0
K_PD2:
    ds_read_b32 v22, v1 offset:16
    s_add_u32 s35, s35, 1
    s_cmp_gt_u32 s35, 256000
    s_cbranch_scc1 K_PD2_X
    s_waitcnt lgkmcnt(0)
    v_cmp_gt_u32 vcc, 12, v22
    s_nop 1
    s_cbranch_vccnz K_PD2
K_PD2_X:
    s_waitcnt lgkmcnt(0)
    ds_read_b64_tr_b16 a[48:49], v7 offset:8192
    ds_read_b64_tr_b16 a[50:51], v7 offset:10240
    ds_read_b64_tr_b16 a[52:53], v7 offset:12288
    ds_read_b64_tr_b16 a[54:55], v7 offset:14336
    ds_read_b64_tr_b16 a[56:57], v7 offset:16384
    ds_read_b64_tr_b16 a[58:59], v7 offset:18432
    ds_read_b64_tr_b16 a[60:61], v7 offset:20480
    ds_read_b64_tr_b16 a[62:63], v7 offset:22528
    ds_read_b64_tr_b16 a[64:65], v7 offset:24576
    ds_read_b64_tr_b16 a[66:67], v7 offset:26624
    ds_read_b64_tr_b16 a[68:69], v7 offset:28672
    ds_read_b64_tr_b16 a[70:71], v7 offset:30720
    s_waitcnt lgkmcnt(10)
    buffer_store_dwordx4 a[48:51], v2, s[12:15], s29 offen sc1
    s_add_u32 s29, s29, 5120
    s_waitcnt lgkmcnt(8)
    buffer_store_dwordx4 a[52:55], v2, s[12:15], s29 offen sc1
    s_add_u32 s29, s29, 5120
    s_waitcnt lgkmcnt(6)
    buffer_store_dwordx4 a[56:59], v2, s[12:15], s29 offen sc1
    s_add_u32 s29, s29, 5120
    s_waitcnt lgkmcnt(4)
    buffer_store_dwordx4 a[60:63], v2, s[12:15], s29 offen sc1
    s_add_u32 s29, s29, 5120
    s_waitcnt lgkmcnt(2)
    buffer_store_dwordx4 a[64:67], v2, s[12:15], s29 offen sc1
    s_add_u32 s29, s29, 5120
    s_waitcnt lgkmcnt(0)
    buffer_store_dwordx4 a[68:71], v2, s[12:15], s29 offen sc1
    s_add_u32 s29, s29, 5120
K_PE:
    v_mov_b32 v12, 0
    s_waitcnt vmcnt(0)
    s_mov_b64 exec, 1
    ds_inc_rtn_u32 v22, v1, v1 offset:32
    s_mov_b64 exec, -1
    s_waitcnt lgkmcnt(0)
    v_readfirstlane_b32 s42, v22
    s_nop 1
    s_cmp_lg_u32 s42, 3
    s_cbranch_scc1 K_PF
    s_mov_b32 s35, 0
K_PF_OK:
    ds_read_b32 v22, v1 offset:8
    s_add_u32 s35, s35, 1
    s_cmp_gt_u32 s35, 256000
    s_cbranch_scc1 K_PF_OK_X
    s_waitcnt lgkmcnt(0)
    v_cmp_gt_u32 vcc, 1, v22
    s_nop 1
    s_cbranch_vccnz K_PF_OK
K_PF_OK_X:
    s_waitcnt lgkmcnt(0)
    s_bfe_u32 s41, s94, 0x40002
    s_lshl_b32 s41, s41, 4
    s_lshr_b32 s40, s94, 6
    s_add_u32 s41, s41, s40
    s_lshl_b32 s41, s41, 2
    s_and_b32 s40, s94, 3
    s_add_u32 s41, s41, s40
    s_lshl_b32 s41, s41, 2
    s_mov_b64 exec, 1
    s_add_u32 s40, s41, 12288
    s_cmp_ge_u32 s94, 214
    s_cselect_b32 s40, s40, 0x4000
    buffer_store_dword v22, v12, s[48:51], s40 offen sc1
    buffer_store_dword v22, v12, s[48:51], s41 offen offset:128 sc1
    s_mov_b64 exec, -1
K_PF:
    s_branch K_IDLE
K_BEAT:
    v_and_b32 v3, 63, v0
    v_mov_b32 v20, 161856
    s_add_u32 s48, s44, 0x530000
    s_addc_u32 s49, s45, 0
    s_mov_b32 s50, 0x4000
    s_mov_b32 s51, 0x20000
    s_cmp_lg_u32 s94, 255
    s_cbranch_scc1 K_IDLE
    s_cmp_ge_u32 s3, 1
    s_cbranch_scc1 K_IDLE
    s_mov_b32 s35, 0
K_BO:
    ds_read_b32 v24, v20 offset:8
    s_add_u32 s35, s35, 1
    s_cmp_gt_u32 s35, 256000
    s_cbranch_scc1 K_BO_X
    s_waitcnt lgkmcnt(0)
    v_cmp_gt_u32 vcc, 1, v24
    s_nop 1
    s_cbranch_vccnz K_BO
K_BO_X:
    s_waitcnt lgkmcnt(0)
    v_and_b32 v21, 15, v3
    v_lshlrev_b32 v21, 8, v21
    v_lshrrev_b32 v22, 4, v3
    v_lshl_add_u32 v21, v22, 4, v21
    s_mov_b32 s43, 8192
    s_mov_b32 s42, 4096
    s_mov_b32 s39, 12288
    v_sub_u32 v25, -1, v24
    v_mov_b32 v26, v24
    v_mov_b32 v27, v24
    s_mov_b32 s35, 0
K_M1:
    v_add_u32 v25, 1, v25
    s_mov_b64 exec, 0xffff
    buffer_store_dwordx2 v[24:25], v21, s[48:51], s43 offen sc1
    s_mov_b64 exec, -1
    buffer_load_dwordx4 v[32:35], v21, s[48:51], 0 offen offset:0 sc1
    s_add_u32 s35, s35, 1
    s_cmp_gt_u32 s35, 4000
    s_waitcnt vmcnt(0)
    s_cbranch_scc1 K_M1_X
K_M1_T:
    s_mov_b32 exec_hi, 0xff
    v_cmp_ne_u64 vcc, v[32:33], v[26:27]
    v_cmp_ne_u64 s[4:5], v[34:35], v[26:27]
    s_nop 1
    s_or_b64 vcc, vcc, s[4:5]
    s_mov_b64 exec, -1
    s_cbranch_vccnz K_M1
K_M1_X:
    s_mov_b64 exec, 0xffff
    buffer_store_dword v26, v21, s[48:51], s42 offen offset:0 sc1
    s_mov_b64 exec, -1
    s_mov_b32 s35, 0
K_M2:
    v_add_u32 v25, 1, v25
    s_mov_b64 exec, 0xffff
    buffer_store_dwordx2 v[24:25], v21, s[48:51], s43 offen sc1
    s_mov_b64 exec, -1
    buffer_load_dwordx4 v[32:35], v21, s[48:51], 0 offen offset:64 sc1
    s_add_u32 s35, s35, 1
    s_cmp_gt_u32 s35, 4000
    s_waitcnt vmcnt(0)
    s_cbranch_scc1 K_M2_X
K_M2_T:
    s_mov_b32 exec_hi, 0x0
    v_cmp_ne_u64 vcc, v[32:33], v[26:27]
    v_cmp_ne_u64 s[4:5], v[34:35], v[26:27]
    s_nop 1
    s_or_b64 vcc, vcc, s[4:5]
    s_mov_b64 exec, -1
    s_cbranch_vccnz K_M2
K_M2_X:
    s_mov_b64 exec, 0xffff
    buffer_store_dword v26, v21, s[48:51], s42 offen offset:4 sc1
    s_mov_b64 exec, -1
    s_mov_b32 s35, 0
K_MA:
    v_add_u32 v25, 1, v25
    s_mov_b64 exec, 0xffff
    buffer_store_dwordx2 v[24:25], v21, s[48:51], s43 offen sc1
    s_mov_b64 exec, -1
    buffer_load_dwordx4 v[32:35], v21, s[48:51], s39 offen offset:0 sc1
    s_add_u32 s35, s35, 1
    s_cmp_gt_u32 s35, 4000
    s_waitcnt vmcnt(0)
    s_cbranch_scc1 K_MA_X
K_MA_T:
    s_mov_b32 exec_lo, 0x0
    s_mov_b32 exec_hi, 0x1fe00000
    v_cmp_ne_u64 vcc, v[32:33], v[26:27]
    v_cmp_ne_u64 s[4:5], v[34:35], v[26:27]
    s_nop 1
    s_or_b64 vcc, vcc, s[4:5]
    s_mov_b64 exec, -1
    s_cbranch_vccnz K_MA
K_MA_X:
    s_mov_b64 exec, 0xffff
    buffer_store_dword v26, v21, s[48:51], s42 offen offset:12 sc1
    s_mov_b64 exec, -1
    s_mov_b32 s35, 0
K_M3:
    v_add_u32 v25, 1, v25
    s_mov_b64 exec, 0xffff
    buffer_store_dwordx2 v[24:25], v21, s[48:51], s43 offen sc1
    s_mov_b64 exec, -1
    buffer_load_dwordx4 v[32:35], v21, s[48:51], 0 offen offset:128 sc1
    s_add_u32 s35, s35, 1
    s_cmp_gt_u32 s35, 4000
    s_waitcnt vmcnt(0)
    s_cbranch_scc1 K_M3_X
K_M3_T:
    v_cmp_ne_u64 vcc, v[32:33], v[26:27]
    v_cmp_ne_u64 s[4:5], v[34:35], v[26:27]
    s_nop 1
    s_or_b64 vcc, vcc, s[4:5]
    s_cbranch_vccnz K_M3
K_M3_X:
    s_mov_b64 exec, 0xffff
    buffer_store_dword v26, v21, s[48:51], s42 offen offset:8 sc1
    s_mov_b64 exec, -1
K_IDLE:
    s_barrier
K2_COMP:
    s_setprio 2
    v_and_b32 v3, 63, v0
    v_lshlrev_b32 v2, 4, v3
    s_and_b32 s4, s2, 1
    s_lshl_b32 s4, s4, 3
    s_bfe_u32 s5, s2, 0x30003
    s_add_u32 s4, s4, s5
    s_bfe_u32 s5, s2, 0x20001
    s_lshl_b32 s5, s5, 2
    s_lshr_b32 s6, s2, 6
    s_add_u32 s5, s5, s6
    s_and_b32 s56, s2, 7
    s_lshl_b32 s56, s56, 2
    s_bfe_u32 s57, s2, 0x20003
    s_add_u32 s56, s56, s57
    s_lshr_b32 s57, s2, 5
    s_mul_i32 s59, s3, 14
    s_cmp_eq_u32 s3, 3
    s_subb_u32 s59, s59, 0
    s_mul_i32 s36, s57, 54
    s_add_u32 s36, s36, s59
    s_add_u32 s36, s36, 4
    s_mul_i32 s36, s36, 5120
    s_add_u32 s24, s44, 0xe00000
    s_addc_u32 s25, s45, 0
    s_mov_b32 s26, 0x21c000
    s_mov_b32 s27, 0x20000
    s_lshr_b32 s6, s3, 1
    s_and_b32 s7, s3, 1
    s_lshl_b32 s28, s6, 12
    s_lshl_b32 s29, s7, 11
    s_add_u32 s30, s28, s29
    v_lshl_add_u32 v5, v3, 3, s30
    s_sub_u32 s30, s28, s29
    s_add_u32 s30, s30, 2048
    v_lshl_add_u32 v1, v3, 3, s30
    s_mul_i32 s28, s7, 7168
    s_add_u32 s28, s28, 8192
    v_add_u32 v8, s28, v2
    v_add_u32 v11, 14336, v2
    v_add_u32 v6, 67584, v5
    v_add_u32 v14, 67584, v1
    v_add_u32 v9, 67584, v8
    v_add_u32 v12, 67584, v11
    s_lshl_b32 s32, s4, 1
    s_add_u32 s32, s32, s6
    s_mul_i32 s33, s32, 221184
    s_mul_i32 s34, s5, 14336
    s_add_u32 s33, s33, s34
    s_lshl_b32 s34, s7, 10
    s_add_u32 s31, s34, s33
    s_add_u32 s31, s31, 6144
    s_lshl_b32 s35, s7, 13
    s_add_u32 s33, s33, s35
    s_add_u32 s28, s33, s34
    s_xor_b32 s34, s34, 1024
    s_add_u32 s29, s33, s34
    s_mul_i32 s40, s56, 54
    s_add_u32 s40, s40, s59
    s_lshl_b32 s40, s40, 12
    s_add_u32 s20, s44, 0x1100000
    s_addc_u32 s21, s45, 0
    s_mov_b32 s22, 0x6c0000
    s_mov_b32 s23, 0x20000
    s_add_u32 s16, s44, 0x504000
    s_addc_u32 s17, s45, 0
    s_mov_b32 s18, 0x2000
    s_mov_b32 s19, 0x20000
    s_mov_b32 s52, s46
    s_mov_b32 s53, s47
    s_mov_b32 s54, 0x280000
    s_mov_b32 s55, 0x20000
    s_add_u32 s8, s44, 0x600000
    s_addc_u32 s9, s45, 0
    s_mov_b32 s10, 0x280000
    s_mov_b32 s11, 0x20000
    s_cmp_eq_u32 s5, 15
    s_cselect_b32 s37, s7, 0
    s_cmp_eq_u32 s37, 1
    s_cbranch_scc1 K2_STATS
    s_barrier
    ds_read_b64_tr_b16 a[32:33], v5 offset:0
    ds_read_b64_tr_b16 a[34:35], v5 offset:512
    ds_read_b64_tr_b16 a[36:37], v5 offset:1024
    ds_read_b64_tr_b16 a[38:39], v5 offset:1536
    ds_read_b64_tr_b16 a[40:41], v1 offset:0
    ds_read_b64_tr_b16 a[42:43], v1 offset:512
    ds_read_b64_tr_b16 a[44:45], v1 offset:1024
    ds_read_b64_tr_b16 a[46:47], v1 offset:1536
    ds_read_b128 a[0:3], v8 offset:0
    ds_read_b128 a[4:7], v8 offset:1024
    ds_read_b128 a[8:11], v8 offset:2048
    ds_read_b128 a[12:15], v8 offset:3072
    ds_read_b128 a[16:19], v8 offset:4096
    ds_read_b128 a[20:23], v8 offset:5120
    ds_read_b128 a[24:27], v11 offset:0
    ds_read_b128 a[28:31], v11 offset:7168
    s_waitcnt lgkmcnt(7)
    v_mfma_f32_16x16x32_bf16 v[16:19], a[0:3], a[32:35], 0
    s_barrier
    v_mfma_f32_16x16x32_bf16 v[20:23], a[0:3], a[36:39], 0
    ds_read_b64_tr_b16 a[48:49], v5 offset:22528
    v_mfma_f32_16x16x32_bf16 v[24:27], a[0:3], a[40:43], 0
    ds_read_b64_tr_b16 a[50:51], v5 offset:23040
    v_mfma_f32_16x16x32_bf16 v[28:31], a[0:3], a[44:47], 0
    ds_read_b128 a[0:3], v8 offset:22528
    s_waitcnt lgkmcnt(9)
    v_mfma_f32_16x16x32_bf16 v[32:35], a[4:7], a[32:35], 0
    ds_read_b64_tr_b16 a[52:53], v5 offset:23552
    v_mfma_f32_16x16x32_bf16 v[36:39], a[4:7], a[36:39], 0
    ds_read_b64_tr_b16 a[54:55], v5 offset:24064
    v_mfma_f32_16x16x32_bf16 v[40:43], a[4:7], a[40:43], 0
    ds_read_b64_tr_b16 a[56:57], v1 offset:22528
    v_mfma_f32_16x16x32_bf16 v[44:47], a[4:7], a[44:47], 0
    ds_read_b128 a[4:7], v8 offset:23552
    s_waitcnt lgkmcnt(12)
    v_mfma_f32_16x16x32_bf16 v[48:51], a[8:11], a[32:35], 0
    ds_read_b64_tr_b16 a[58:59], v1 offset:23040
    v_mfma_f32_16x16x32_bf16 v[52:55], a[8:11], a[36:39], 0
    ds_read_b64_tr_b16 a[60:61], v1 offset:23552
    v_mfma_f32_16x16x32_bf16 v[56:59], a[8:11], a[40:43], 0
    ds_read_b64_tr_b16 a[62:63], v1 offset:24064
    v_mfma_f32_16x16x32_bf16 v[60:63], a[8:11], a[44:47], 0
    ds_read_b128 a[8:11], v8 offset:24576
    s_waitcnt lgkmcnt(15)
    v_mfma_f32_16x16x32_bf16 v[64:67], a[12:15], a[32:35], 0
    v_mfma_f32_16x16x32_bf16 v[68:71], a[12:15], a[36:39], 0
    v_mfma_f32_16x16x32_bf16 v[72:75], a[12:15], a[40:43], 0
    v_mfma_f32_16x16x32_bf16 v[76:79], a[12:15], a[44:47], 0
    ds_read_b128 a[12:15], v8 offset:25600
    s_waitcnt lgkmcnt(15)
    v_mfma_f32_16x16x32_bf16 v[80:83], a[16:19], a[32:35], 0
    v_mfma_f32_16x16x32_bf16 v[84:87], a[16:19], a[36:39], 0
    v_mfma_f32_16x16x32_bf16 v[88:91], a[16:19], a[40:43], 0
    v_mfma_f32_16x16x32_bf16 v[92:95], a[16:19], a[44:47], 0
    ds_read_b128 a[16:19], v8 offset:26624
    s_waitcnt lgkmcnt(15)
    v_mfma_f32_16x16x32_bf16 v[96:99], a[20:23], a[32:35], 0
    v_mfma_f32_16x16x32_bf16 v[100:103], a[20:23], a[36:39], 0
    v_mfma_f32_16x16x32_bf16 v[104:107], a[20:23], a[40:43], 0
    v_mfma_f32_16x16x32_bf16 v[108:111], a[20:23], a[44:47], 0
    ds_read_b128 a[20:23], v8 offset:27648
    s_waitcnt lgkmcnt(15)
    v_mfma_f32_16x16x32_bf16 v[112:115], a[24:27], a[32:35], 0
    v_mfma_f32_16x16x32_bf16 v[116:119], a[24:27], a[36:39], 0
    ds_read_b128 a[24:27], v11 offset:22528
    s_waitcnt lgkmcnt(15)
    v_mfma_f32_16x16x32_bf16 v[120:123], a[28:31], a[32:35], 0
    v_mfma_f32_16x16x32_bf16 v[124:127], a[28:31], a[36:39], 0
    ds_read_b128 a[28:31], v11 offset:29696
    s_waitcnt lgkmcnt(6)
    v_mfma_f32_16x16x32_bf16 v[16:19], a[0:3], a[48:51], v[16:19]
    s_barrier
    v_mfma_f32_16x16x32_bf16 v[20:23], a[0:3], a[52:55], v[20:23]
    ds_read_b64_tr_b16 a[32:33], v5 offset:45056
    v_mfma_f32_16x16x32_bf16 v[24:27], a[0:3], a[56:59], v[24:27]
    ds_read_b64_tr_b16 a[34:35], v5 offset:45568
    v_mfma_f32_16x16x32_bf16 v[28:31], a[0:3], a[60:63], v[28:31]
    ds_read_b128 a[0:3], v8 offset:45056
    s_waitcnt lgkmcnt(12)
    v_mfma_f32_16x16x32_bf16 v[32:35], a[4:7], a[48:51], v[32:35]
    ds_read_b64_tr_b16 a[36:37], v5 offset:46080
    v_mfma_f32_16x16x32_bf16 v[36:39], a[4:7], a[52:55], v[36:39]
    ds_read_b64_tr_b16 a[38:39], v5 offset:46592
    v_mfma_f32_16x16x32_bf16 v[40:43], a[4:7], a[56:59], v[40:43]
    ds_read_b64_tr_b16 a[40:41], v1 offset:45056
    v_mfma_f32_16x16x32_bf16 v[44:47], a[4:7], a[60:63], v[44:47]
    ds_read_b128 a[4:7], v8 offset:46080
    s_waitcnt lgkmcnt(12)
    v_mfma_f32_16x16x32_bf16 v[48:51], a[8:11], a[48:51], v[48:51]
    ds_read_b64_tr_b16 a[42:43], v1 offset:45568
    v_mfma_f32_16x16x32_bf16 v[52:55], a[8:11], a[52:55], v[52:55]
    ds_read_b64_tr_b16 a[44:45], v1 offset:46080
    v_mfma_f32_16x16x32_bf16 v[56:59], a[8:11], a[56:59], v[56:59]
    ds_read_b64_tr_b16 a[46:47], v1 offset:46592
    v_mfma_f32_16x16x32_bf16 v[60:63], a[8:11], a[60:63], v[60:63]
    ds_read_b128 a[8:11], v8 offset:47104
    s_waitcnt lgkmcnt(15)
    v_mfma_f32_16x16x32_bf16 v[64:67], a[12:15], a[48:51], v[64:67]
    v_mfma_f32_16x16x32_bf16 v[68:71], a[12:15], a[52:55], v[68:71]
    v_mfma_f32_16x16x32_bf16 v[72:75], a[12:15], a[56:59], v[72:75]
    v_mfma_f32_16x16x32_bf16 v[76:79], a[12:15], a[60:63], v[76:79]
    ds_read_b128 a[12:15], v8 offset:48128
    s_waitcnt lgkmcnt(15)
    v_mfma_f32_16x16x32_bf16 v[80:83], a[16:19], a[48:51], v[80:83]
    v_mfma_f32_16x16x32_bf16 v[84:87], a[16:19], a[52:55], v[84:87]
    v_mfma_f32_16x16x32_bf16 v[88:91], a[16:19], a[56:59], v[88:91]
    v_mfma_f32_16x16x32_bf16 v[92:95], a[16:19], a[60:63], v[92:95]
    ds_read_b128 a[16:19], v8 offset:49152
    s_waitcnt lgkmcnt(15)
    v_mfma_f32_16x16x32_bf16 v[96:99], a[20:23], a[48:51], v[96:99]
    v_mfma_f32_16x16x32_bf16 v[100:103], a[20:23], a[52:55], v[100:103]
    v_mfma_f32_16x16x32_bf16 v[104:107], a[20:23], a[56:59], v[104:107]
    v_mfma_f32_16x16x32_bf16 v[108:111], a[20:23], a[60:63], v[108:111]
    ds_read_b128 a[20:23], v8 offset:50176
    s_waitcnt lgkmcnt(15)
    v_mfma_f32_16x16x32_bf16 v[112:115], a[24:27], a[48:51], v[112:115]
    v_mfma_f32_16x16x32_bf16 v[116:119], a[24:27], a[52:55], v[116:119]
    ds_read_b128 a[24:27], v11 offset:45056
    s_waitcnt lgkmcnt(15)
    v_mfma_f32_16x16x32_bf16 v[120:123], a[28:31], a[48:51], v[120:123]
    v_mfma_f32_16x16x32_bf16 v[124:127], a[28:31], a[52:55], v[124:127]
    ds_read_b128 a[28:31], v11 offset:52224
    s_waitcnt lgkmcnt(6)
    v_mfma_f32_16x16x32_bf16 v[16:19], a[0:3], a[32:35], v[16:19]
    s_barrier
    v_mfma_f32_16x16x32_bf16 v[20:23], a[0:3], a[36:39], v[20:23]
    ds_read_b64_tr_b16 a[48:49], v6 offset:0
    v_mfma_f32_16x16x32_bf16 v[24:27], a[0:3], a[40:43], v[24:27]
    ds_read_b64_tr_b16 a[50:51], v6 offset:512
    v_mfma_f32_16x16x32_bf16 v[28:31], a[0:3], a[44:47], v[28:31]
    ds_read_b128 a[0:3], v9 offset:0
    s_waitcnt lgkmcnt(12)
    v_mfma_f32_16x16x32_bf16 v[32:35], a[4:7], a[32:35], v[32:35]
    ds_read_b64_tr_b16 a[52:53], v6 offset:1024
    v_mfma_f32_16x16x32_bf16 v[36:39], a[4:7], a[36:39], v[36:39]
    ds_read_b64_tr_b16 a[54:55], v6 offset:1536
    v_mfma_f32_16x16x32_bf16 v[40:43], a[4:7], a[40:43], v[40:43]
    ds_read_b64_tr_b16 a[56:57], v14 offset:0
    v_mfma_f32_16x16x32_bf16 v[44:47], a[4:7], a[44:47], v[44:47]
    ds_read_b128 a[4:7], v9 offset:1024
    s_waitcnt lgkmcnt(12)
    v_mfma_f32_16x16x32_bf16 v[48:51], a[8:11], a[32:35], v[48:51]
    ds_read_b64_tr_b16 a[58:59], v14 offset:512
    v_mfma_f32_16x16x32_bf16 v[52:55], a[8:11], a[36:39], v[52:55]
    ds_read_b64_tr_b16 a[60:61], v14 offset:1024
    v_mfma_f32_16x16x32_bf16 v[56:59], a[8:11], a[40:43], v[56:59]
    ds_read_b64_tr_b16 a[62:63], v14 offset:1536
    v_mfma_f32_16x16x32_bf16 v[60:63], a[8:11], a[44:47], v[60:63]
    ds_read_b128 a[8:11], v9 offset:2048
    s_waitcnt lgkmcnt(15)
    v_mfma_f32_16x16x32_bf16 v[64:67], a[12:15], a[32:35], v[64:67]
    v_mfma_f32_16x16x32_bf16 v[68:71], a[12:15], a[36:39], v[68:71]
    buffer_load_dwordx4 a[64:67], v2, s[24:27], s36 offen offset:0 sc1
    v_mfma_f32_16x16x32_bf16 v[72:75], a[12:15], a[40:43], v[72:75]
    v_mfma_f32_16x16x32_bf16 v[76:79], a[12:15], a[44:47], v[76:79]
    ds_read_b128 a[12:15], v9 offset:3072
    s_waitcnt lgkmcnt(15)
    v_mfma_f32_16x16x32_bf16 v[80:83], a[16:19], a[32:35], v[80:83]
    v_mfma_f32_16x16x32_bf16 v[84:87], a[16:19], a[36:39], v[84:87]
    v_mfma_f32_16x16x32_bf16 v[88:91], a[16:19], a[40:43], v[88:91]
    v_mfma_f32_16x16x32_bf16 v[92:95], a[16:19], a[44:47], v[92:95]
    ds_read_b128 a[16:19], v9 offset:4096
    s_waitcnt lgkmcnt(15)
    v_mfma_f32_16x16x32_bf16 v[96:99], a[20:23], a[32:35], v[96:99]
    v_mfma_f32_16x16x32_bf16 v[100:103], a[20:23], a[36:39], v[100:103]
    v_mfma_f32_16x16x32_bf16 v[104:107], a[20:23], a[40:43], v[104:107]
    v_mfma_f32_16x16x32_bf16 v[108:111], a[20:23], a[44:47], v[108:111]
    ds_read_b128 a[20:23], v9 offset:5120
    s_waitcnt lgkmcnt(15)
    v_mfma_f32_16x16x32_bf16 v[112:115], a[24:27], a[32:35], v[112:115]
    v_mfma_f32_16x16x32_bf16 v[116:119], a[24:27], a[36:39], v[116:119]
    ds_read_b128 a[24:27], v12 offset:0
    s_waitcnt lgkmcnt(15)
    v_mfma_f32_16x16x32_bf16 v[120:123], a[28:31], a[32:35], v[120:123]
    v_mfma_f32_16x16x32_bf16 v[124:127], a[28:31], a[36:39], v[124:127]
    ds_read_b128 a[28:31], v12 offset:7168
    s_waitcnt lgkmcnt(6)
    v_mfma_f32_16x16x32_bf16 v[16:19], a[0:3], a[48:51], v[16:19]
    s_barrier
    v_mfma_f32_16x16x32_bf16 v[20:23], a[0:3], a[52:55], v[20:23]
    ds_read_b64_tr_b16 a[32:33], v6 offset:22528
    v_mfma_f32_16x16x32_bf16 v[24:27], a[0:3], a[56:59], v[24:27]
    ds_read_b64_tr_b16 a[34:35], v6 offset:23040
    v_mfma_f32_16x16x32_bf16 v[28:31], a[0:3], a[60:63], v[28:31]
    ds_read_b128 a[0:3], v9 offset:22528
    s_waitcnt lgkmcnt(12)
    v_mfma_f32_16x16x32_bf16 v[32:35], a[4:7], a[48:51], v[32:35]
    ds_read_b64_tr_b16 a[36:37], v6 offset:23552
    v_mfma_f32_16x16x32_bf16 v[36:39], a[4:7], a[52:55], v[36:39]
    ds_read_b64_tr_b16 a[38:39], v6 offset:24064
    v_mfma_f32_16x16x32_bf16 v[40:43], a[4:7], a[56:59], v[40:43]
    ds_read_b64_tr_b16 a[40:41], v14 offset:22528
    v_mfma_f32_16x16x32_bf16 v[44:47], a[4:7], a[60:63], v[44:47]
    ds_read_b128 a[4:7], v9 offset:23552
    s_waitcnt lgkmcnt(12)
    v_mfma_f32_16x16x32_bf16 v[48:51], a[8:11], a[48:51], v[48:51]
    ds_read_b64_tr_b16 a[42:43], v14 offset:23040
    v_mfma_f32_16x16x32_bf16 v[52:55], a[8:11], a[52:55], v[52:55]
    ds_read_b64_tr_b16 a[44:45], v14 offset:23552
    v_mfma_f32_16x16x32_bf16 v[56:59], a[8:11], a[56:59], v[56:59]
    ds_read_b64_tr_b16 a[46:47], v14 offset:24064
    v_mfma_f32_16x16x32_bf16 v[60:63], a[8:11], a[60:63], v[60:63]
    ds_read_b128 a[8:11], v9 offset:24576
    s_waitcnt lgkmcnt(15)
    v_mfma_f32_16x16x32_bf16 v[64:67], a[12:15], a[48:51], v[64:67]
    v_mfma_f32_16x16x32_bf16 v[68:71], a[12:15], a[52:55], v[68:71]
    buffer_load_dwordx4 a[68:71], v2, s[24:27], s36 offen offset:1024 sc1
    v_mfma_f32_16x16x32_bf16 v[72:75], a[12:15], a[56:59], v[72:75]
    v_mfma_f32_16x16x32_bf16 v[76:79], a[12:15], a[60:63], v[76:79]
    ds_read_b128 a[12:15], v9 offset:25600
    s_waitcnt lgkmcnt(15)
    v_mfma_f32_16x16x32_bf16 v[80:83], a[16:19], a[48:51], v[80:83]
    v_mfma_f32_16x16x32_bf16 v[84:87], a[16:19], a[52:55], v[84:87]
    v_mfma_f32_16x16x32_bf16 v[88:91], a[16:19], a[56:59], v[88:91]
    v_mfma_f32_16x16x32_bf16 v[92:95], a[16:19], a[60:63], v[92:95]
    ds_read_b128 a[16:19], v9 offset:26624
    s_waitcnt lgkmcnt(15)
    v_mfma_f32_16x16x32_bf16 v[96:99], a[20:23], a[48:51], v[96:99]
    v_mfma_f32_16x16x32_bf16 v[100:103], a[20:23], a[52:55], v[100:103]
    v_mfma_f32_16x16x32_bf16 v[104:107], a[20:23], a[56:59], v[104:107]
    v_mfma_f32_16x16x32_bf16 v[108:111], a[20:23], a[60:63], v[108:111]
    ds_read_b128 a[20:23], v9 offset:27648
    s_waitcnt lgkmcnt(15)
    v_mfma_f32_16x16x32_bf16 v[112:115], a[24:27], a[48:51], v[112:115]
    v_mfma_f32_16x16x32_bf16 v[116:119], a[24:27], a[52:55], v[116:119]
    ds_read_b128 a[24:27], v12 offset:22528
    s_waitcnt lgkmcnt(15)
    v_mfma_f32_16x16x32_bf16 v[120:123], a[28:31], a[48:51], v[120:123]
    v_mfma_f32_16x16x32_bf16 v[124:127], a[28:31], a[52:55], v[124:127]
    ds_read_b128 a[28:31], v12 offset:29696
    s_waitcnt lgkmcnt(6)
    v_mfma_f32_16x16x32_bf16 v[16:19], a[0:3], a[32:35], v[16:19]
    s_barrier
    v_mfma_f32_16x16x32_bf16 v[20:23], a[0:3], a[36:39], v[20:23]
    ds_read_b64_tr_b16 a[48:49], v5 offset:0
    v_mfma_f32_16x16x32_bf16 v[24:27], a[0:3], a[40:43], v[24:27]
    ds_read_b64_tr_b16 a[50:51], v5 offset:512
    v_mfma_f32_16x16x32_bf16 v[28:31], a[0:3], a[44:47], v[28:31]
    ds_read_b128 a[0:3], v8 offset:0
    s_waitcnt lgkmcnt(12)
    v_mfma_f32_16x16x32_bf16 v[32:35], a[4:7], a[32:35], v[32:35]
    ds_read_b64_tr_b16 a[52:53], v5 offset:1024
    v_mfma_f32_16x16x32_bf16 v[36:39], a[4:7], a[36:39], v[36:39]
    ds_read_b64_tr_b16 a[54:55], v5 offset:1536
    v_mfma_f32_16x16x32_bf16 v[40:43], a[4:7], a[40:43], v[40:43]
    ds_read_b64_tr_b16 a[56:57], v1 offset:0
    v_mfma_f32_16x16x32_bf16 v[44:47], a[4:7], a[44:47], v[44:47]
    ds_read_b128 a[4:7], v8 offset:1024
    s_waitcnt lgkmcnt(12)
    v_mfma_f32_16x16x32_bf16 v[48:51], a[8:11], a[32:35], v[48:51]
    ds_read_b64_tr_b16 a[58:59], v1 offset:512
    v_mfma_f32_16x16x32_bf16 v[52:55], a[8:11], a[36:39], v[52:55]
    ds_read_b64_tr_b16 a[60:61], v1 offset:1024
    v_mfma_f32_16x16x32_bf16 v[56:59], a[8:11], a[40:43], v[56:59]
    ds_read_b64_tr_b16 a[62:63], v1 offset:1536
    v_mfma_f32_16x16x32_bf16 v[60:63], a[8:11], a[44:47], v[60:63]
    ds_read_b128 a[8:11], v8 offset:2048
    s_waitcnt lgkmcnt(15)
    v_mfma_f32_16x16x32_bf16 v[64:67], a[12:15], a[32:35], v[64:67]
    v_mfma_f32_16x16x32_bf16 v[68:71], a[12:15], a[36:39], v[68:71]
    buffer_load_dwordx4 a[72:75], v2, s[24:27], s36 offen offset:2048 sc1
    v_mfma_f32_16x16x32_bf16 v[72:75], a[12:15], a[40:43], v[72:75]
    v_mfma_f32_16x16x32_bf16 v[76:79], a[12:15], a[44:47], v[76:79]
    ds_read_b128 a[12:15], v8 offset:3072
    s_waitcnt lgkmcnt(15)
    v_mfma_f32_16x16x32_bf16 v[80:83], a[16:19], a[32:35], v[80:83]
    v_mfma_f32_16x16x32_bf16 v[84:87], a[16:19], a[36:39], v[84:87]
    v_mfma_f32_16x16x32_bf16 v[88:91], a[16:19], a[40:43], v[88:91]
    v_mfma_f32_16x16x32_bf16 v[92:95], a[16:19], a[44:47], v[92:95]
    ds_read_b128 a[16:19], v8 offset:4096
    s_waitcnt lgkmcnt(15)
    v_mfma_f32_16x16x32_bf16 v[96:99], a[20:23], a[32:35], v[96:99]
    v_mfma_f32_16x16x32_bf16 v[100:103], a[20:23], a[36:39], v[100:103]
    v_mfma_f32_16x16x32_bf16 v[104:107], a[20:23], a[40:43], v[104:107]
    v_mfma_f32_16x16x32_bf16 v[108:111], a[20:23], a[44:47], v[108:111]
    ds_read_b128 a[20:23], v8 offset:5120
    s_waitcnt lgkmcnt(15)
    v_mfma_f32_16x16x32_bf16 v[112:115], a[24:27], a[32:35], v[112:115]
    v_mfma_f32_16x16x32_bf16 v[116:119], a[24:27], a[36:39], v[116:119]
    ds_read_b128 a[24:27], v11 offset:0
    s_waitcnt lgkmcnt(15)
    v_mfma_f32_16x16x32_bf16 v[120:123], a[28:31], a[32:35], v[120:123]
    v_mfma_f32_16x16x32_bf16 v[124:127], a[28:31], a[36:39], v[124:127]
    ds_read_b128 a[28:31], v11 offset:7168
    s_waitcnt lgkmcnt(6)
    v_mfma_f32_16x16x32_bf16 v[16:19], a[0:3], a[48:51], v[16:19]
    s_barrier
    v_mfma_f32_16x16x32_bf16 v[20:23], a[0:3], a[52:55], v[20:23]
    ds_read_b64_tr_b16 a[32:33], v5 offset:22528
    v_mfma_f32_16x16x32_bf16 v[24:27], a[0:3], a[56:59], v[24:27]
    ds_read_b64_tr_b16 a[34:35], v5 offset:23040
    v_mfma_f32_16x16x32_bf16 v[28:31], a[0:3], a[60:63], v[28:31]
    ds_read_b128 a[0:3], v8 offset:22528
    s_waitcnt lgkmcnt(12)
    v_mfma_f32_16x16x32_bf16 v[32:35], a[4:7], a[48:51], v[32:35]
    ds_read_b64_tr_b16 a[36:37], v5 offset:23552
    v_mfma_f32_16x16x32_bf16 v[36:39], a[4:7], a[52:55], v[36:39]
    ds_read_b64_tr_b16 a[38:39], v5 offset:24064
    v_mfma_f32_16x16x32_bf16 v[40:43], a[4:7], a[56:59], v[40:43]
    ds_read_b64_tr_b16 a[40:41], v1 offset:22528
    v_mfma_f32_16x16x32_bf16 v[44:47], a[4:7], a[60:63], v[44:47]
    ds_read_b128 a[4:7], v8 offset:23552
    s_waitcnt lgkmcnt(12)
    v_mfma_f32_16x16x32_bf16 v[48:51], a[8:11], a[48:51], v[48:51]
    ds_read_b64_tr_b16 a[42:43], v1 offset:23040
    v_mfma_f32_16x16x32_bf16 v[52:55], a[8:11], a[52:55], v[52:55]
    ds_read_b64_tr_b16 a[44:45], v1 offset:23552
    v_mfma_f32_16x16x32_bf16 v[56:59], a[8:11], a[56:59], v[56:59]
    ds_read_b64_tr_b16 a[46:47], v1 offset:24064
    v_mfma_f32_16x16x32_bf16 v[60:63], a[8:11], a[60:63], v[60:63]
    ds_read_b128 a[8:11], v8 offset:24576
    s_waitcnt lgkmcnt(15)
    v_mfma_f32_16x16x32_bf16 v[64:67], a[12:15], a[48:51], v[64:67]
    v_mfma_f32_16x16x32_bf16 v[68:71], a[12:15], a[52:55], v[68:71]
    buffer_load_dwordx4 a[76:79], v2, s[24:27], s36 offen offset:3072 sc1
    s_add_u32 s36, s36, 4096
    v_mfma_f32_16x16x32_bf16 v[72:75], a[12:15], a[56:59], v[72:75]
    v_mfma_f32_16x16x32_bf16 v[76:79], a[12:15], a[60:63], v[76:79]
    ds_read_b128 a[12:15], v8 offset:25600
    s_waitcnt lgkmcnt(15)
    v_mfma_f32_16x16x32_bf16 v[80:83], a[16:19], a[48:51], v[80:83]
    v_mfma_f32_16x16x32_bf16 v[84:87], a[16:19], a[52:55], v[84:87]
    v_mfma_f32_16x16x32_bf16 v[88:91], a[16:19], a[56:59], v[88:91]
    v_mfma_f32_16x16x32_bf16 v[92:95], a[16:19], a[60:63], v[92:95]
    ds_read_b128 a[16:19], v8 offset:26624
    s_waitcnt lgkmcnt(15)
    v_mfma_f32_16x16x32_bf16 v[96:99], a[20:23], a[48:51], v[96:99]
    v_mfma_f32_16x16x32_bf16 v[100:103], a[20:23], a[52:55], v[100:103]
    v_mfma_f32_16x16x32_bf16 v[104:107], a[20:23], a[56:59], v[104:107]
    v_mfma_f32_16x16x32_bf16 v[108:111], a[20:23], a[60:63], v[108:111]
    ds_read_b128 a[20:23], v8 offset:27648
    s_waitcnt lgkmcnt(15)
    v_mfma_f32_16x16x32_bf16 v[112:115], a[24:27], a[48:51], v[112:115]
    v_mfma_f32_16x16x32_bf16 v[116:119], a[24:27], a[52:55], v[116:119]
    ds_read_b128 a[24:27], v11 offset:22528
    s_waitcnt lgkmcnt(15)
    v_mfma_f32_16x16x32_bf16 v[120:123], a[28:31], a[48:51], v[120:123]
    v_mfma_f32_16x16x32_bf16 v[124:127], a[28:31], a[52:55], v[124:127]
    ds_read_b128 a[28:31], v11 offset:29696
    s_waitcnt lgkmcnt(6)
    v_mfma_f32_16x16x32_bf16 v[16:19], a[0:3], a[32:35], v[16:19]
    s_barrier
    v_mfma_f32_16x16x32_bf16 v[20:23], a[0:3], a[36:39], v[20:23]
    ds_read_b64_tr_b16 a[48:49], v5 offset:45056
    v_mfma_f32_16x16x32_bf16 v[24:27], a[0:3], a[40:43], v[24:27]
    ds_read_b64_tr_b16 a[50:51], v5 offset:45568
    v_mfma_f32_16x16x32_bf16 v[28:31], a[0:3], a[44:47], v[28:31]
    ds_read_b128 a[0:3], v8 offset:45056
    s_waitcnt lgkmcnt(12)
    v_mfma_f32_16x16x32_bf16 v[32:35], a[4:7], a[32:35], v[32:35]
    ds_read_b64_tr_b16 a[52:53], v5 offset:46080
    v_mfma_f32_16x16x32_bf16 v[36:39], a[4:7], a[36:39], v[36:39]
    ds_read_b64_tr_b16 a[54:55], v5 offset:46592
    v_mfma_f32_16x16x32_bf16 v[40:43], a[4:7], a[40:43], v[40:43]
    ds_read_b64_tr_b16 a[56:57], v1 offset:45056
    v_mfma_f32_16x16x32_bf16 v[44:47], a[4:7], a[44:47], v[44:47]
    ds_read_b128 a[4:7], v8 offset:46080
    s_waitcnt lgkmcnt(12)
    v_mfma_f32_16x16x32_bf16 v[48:51], a[8:11], a[32:35], v[48:51]
    ds_read_b64_tr_b16 a[58:59], v1 offset:45568
    v_mfma_f32_16x16x32_bf16 v[52:55], a[8:11], a[36:39], v[52:55]
    ds_read_b64_tr_b16 a[60:61], v1 offset:46080
    v_mfma_f32_16x16x32_bf16 v[56:59], a[8:11], a[40:43], v[56:59]
    ds_read_b64_tr_b16 a[62:63], v1 offset:46592
    v_mfma_f32_16x16x32_bf16 v[60:63], a[8:11], a[44:47], v[60:63]
    ds_read_b128 a[8:11], v8 offset:47104
    s_waitcnt lgkmcnt(15)
    v_mfma_f32_16x16x32_bf16 v[64:67], a[12:15], a[32:35], v[64:67]
    v_mfma_f32_16x16x32_bf16 v[68:71], a[12:15], a[36:39], v[68:71]
    buffer_load_dwordx4 a[80:83], v2, s[24:27], s36 offen offset:0 sc1
    v_mfma_f32_16x16x32_bf16 v[72:75], a[12:15], a[40:43], v[72:75]
    v_mfma_f32_16x16x32_bf16 v[76:79], a[12:15], a[44:47], v[76:79]
    ds_read_b128 a[12:15], v8 offset:48128
    s_waitcnt lgkmcnt(15)
    v_mfma_f32_16x16x32_bf16 v[80:83], a[16:19], a[32:35], v[80:83]
    v_mfma_f32_16x16x32_bf16 v[84:87], a[16:19], a[36:39], v[84:87]
    v_mfma_f32_16x16x32_bf16 v[88:91], a[16:19], a[40:43], v[88:91]
    v_mfma_f32_16x16x32_bf16 v[92:95], a[16:19], a[44:47], v[92:95]
    ds_read_b128 a[16:19], v8 offset:49152
    s_waitcnt lgkmcnt(15)
    v_mfma_f32_16x16x32_bf16 v[96:99], a[20:23], a[32:35], v[96:99]
    v_mfma_f32_16x16x32_bf16 v[100:103], a[20:23], a[36:39], v[100:103]
    v_mfma_f32_16x16x32_bf16 v[104:107], a[20:23], a[40:43], v[104:107]
    v_mfma_f32_16x16x32_bf16 v[108:111], a[20:23], a[44:47], v[108:111]
    ds_read_b128 a[20:23], v8 offset:50176
    s_waitcnt lgkmcnt(15)
    v_mfma_f32_16x16x32_bf16 v[112:115], a[24:27], a[32:35], v[112:115]
    v_mfma_f32_16x16x32_bf16 v[116:119], a[24:27], a[36:39], v[116:119]
    ds_read_b128 a[24:27], v11 offset:45056
    s_waitcnt lgkmcnt(15)
    v_mfma_f32_16x16x32_bf16 v[120:123], a[28:31], a[32:35], v[120:123]
    v_mfma_f32_16x16x32_bf16 v[124:127], a[28:31], a[36:39], v[124:127]
    ds_read_b128 a[28:31], v11 offset:52224
    s_waitcnt lgkmcnt(6)
    v_mfma_f32_16x16x32_bf16 v[16:19], a[0:3], a[48:51], v[16:19]
    s_barrier
    v_mfma_f32_16x16x32_bf16 v[20:23], a[0:3], a[52:55], v[20:23]
    ds_read_b64_tr_b16 a[32:33], v6 offset:0
    v_mfma_f32_16x16x32_bf16 v[24:27], a[0:3], a[56:59], v[24:27]
    ds_read_b64_tr_b16 a[34:35], v6 offset:512
    v_mfma_f32_16x16x32_bf16 v[28:31], a[0:3], a[60:63], v[28:31]
    ds_read_b128 a[0:3], v9 offset:0
    s_waitcnt lgkmcnt(12)
    v_mfma_f32_16x16x32_bf16 v[32:35], a[4:7], a[48:51], v[32:35]
    ds_read_b64_tr_b16 a[36:37], v6 offset:1024
    v_mfma_f32_16x16x32_bf16 v[36:39], a[4:7], a[52:55], v[36:39]
    ds_read_b64_tr_b16 a[38:39], v6 offset:1536
    v_mfma_f32_16x16x32_bf16 v[40:43], a[4:7], a[56:59], v[40:43]
    ds_read_b64_tr_b16 a[40:41], v14 offset:0
    v_mfma_f32_16x16x32_bf16 v[44:47], a[4:7], a[60:63], v[44:47]
    ds_read_b128 a[4:7], v9 offset:1024
    s_waitcnt lgkmcnt(12)
    v_mfma_f32_16x16x32_bf16 v[48:51], a[8:11], a[48:51], v[48:51]
    ds_read_b64_tr_b16 a[42:43], v14 offset:512
    v_mfma_f32_16x16x32_bf16 v[52:55], a[8:11], a[52:55], v[52:55]
    ds_read_b64_tr_b16 a[44:45], v14 offset:1024
    v_mfma_f32_16x16x32_bf16 v[56:59], a[8:11], a[56:59], v[56:59]
    ds_read_b64_tr_b16 a[46:47], v14 offset:1536
    v_mfma_f32_16x16x32_bf16 v[60:63], a[8:11], a[60:63], v[60:63]
    ds_read_b128 a[8:11], v9 offset:2048
    s_waitcnt lgkmcnt(15)
    v_mfma_f32_16x16x32_bf16 v[64:67], a[12:15], a[48:51], v[64:67]
    v_mfma_f32_16x16x32_bf16 v[68:71], a[12:15], a[52:55], v[68:71]
    buffer_load_dwordx4 a[84:87], v2, s[24:27], s36 offen offset:1024 sc1
    v_mfma_f32_16x16x32_bf16 v[72:75], a[12:15], a[56:59], v[72:75]
    v_mfma_f32_16x16x32_bf16 v[76:79], a[12:15], a[60:63], v[76:79]
    ds_read_b128 a[12:15], v9 offset:3072
    s_waitcnt lgkmcnt(15)
    v_mfma_f32_16x16x32_bf16 v[80:83], a[16:19], a[48:51], v[80:83]
    v_mfma_f32_16x16x32_bf16 v[84:87], a[16:19], a[52:55], v[84:87]
    v_mfma_f32_16x16x32_bf16 v[88:91], a[16:19], a[56:59], v[88:91]
    v_mfma_f32_16x16x32_bf16 v[92:95], a[16:19], a[60:63], v[92:95]
    ds_read_b128 a[16:19], v9 offset:4096
    s_waitcnt lgkmcnt(15)
    v_mfma_f32_16x16x32_bf16 v[96:99], a[20:23], a[48:51], v[96:99]
    v_mfma_f32_16x16x32_bf16 v[100:103], a[20:23], a[52:55], v[100:103]
    v_mfma_f32_16x16x32_bf16 v[104:107], a[20:23], a[56:59], v[104:107]
    v_mfma_f32_16x16x32_bf16 v[108:111], a[20:23], a[60:63], v[108:111]
    ds_read_b128 a[20:23], v9 offset:5120
    s_waitcnt lgkmcnt(15)
    v_mfma_f32_16x16x32_bf16 v[112:115], a[24:27], a[48:51], v[112:115]
    v_mfma_f32_16x16x32_bf16 v[116:119], a[24:27], a[52:55], v[116:119]
    ds_read_b128 a[24:27], v12 offset:0
    s_waitcnt lgkmcnt(15)
    v_mfma_f32_16x16x32_bf16 v[120:123], a[28:31], a[48:51], v[120:123]
    v_mfma_f32_16x16x32_bf16 v[124:127], a[28:31], a[52:55], v[124:127]
    ds_read_b128 a[28:31], v12 offset:7168
    s_waitcnt lgkmcnt(6)
    v_mfma_f32_16x16x32_bf16 v[16:19], a[0:3], a[32:35], v[16:19]
    s_barrier
    v_mfma_f32_16x16x32_bf16 v[20:23], a[0:3], a[36:39], v[20:23]
    ds_read_b64_tr_b16 a[48:49], v6 offset:22528
    v_mfma_f32_16x16x32_bf16 v[24:27], a[0:3], a[40:43], v[24:27]
    ds_read_b64_tr_b16 a[50:51], v6 offset:23040
    v_mfma_f32_16x16x32_bf16 v[28:31], a[0:3], a[44:47], v[28:31]
    ds_read_b128 a[0:3], v9 offset:22528
    s_waitcnt lgkmcnt(12)
    v_mfma_f32_16x16x32_bf16 v[32:35], a[4:7], a[32:35], v[32:35]
    ds_read_b64_tr_b16 a[52:53], v6 offset:23552
    v_mfma_f32_16x16x32_bf16 v[36:39], a[4:7], a[36:39], v[36:39]
    ds_read_b64_tr_b16 a[54:55], v6 offset:24064
    v_mfma_f32_16x16x32_bf16 v[40:43], a[4:7], a[40:43], v[40:43]
    ds_read_b64_tr_b16 a[56:57], v14 offset:22528
    v_mfma_f32_16x16x32_bf16 v[44:47], a[4:7], a[44:47], v[44:47]
    ds_read_b128 a[4:7], v9 offset:23552
    s_waitcnt lgkmcnt(12)
    v_mfma_f32_16x16x32_bf16 v[48:51], a[8:11], a[32:35], v[48:51]
    ds_read_b64_tr_b16 a[58:59], v14 offset:23040
    v_mfma_f32_16x16x32_bf16 v[52:55], a[8:11], a[36:39], v[52:55]
    ds_read_b64_tr_b16 a[60:61], v14 offset:23552
    v_mfma_f32_16x16x32_bf16 v[56:59], a[8:11], a[40:43], v[56:59]
    ds_read_b64_tr_b16 a[62:63], v14 offset:24064
    v_mfma_f32_16x16x32_bf16 v[60:63], a[8:11], a[44:47], v[60:63]
    ds_read_b128 a[8:11], v9 offset:24576
    s_waitcnt lgkmcnt(15)
    v_mfma_f32_16x16x32_bf16 v[64:67], a[12:15], a[32:35], v[64:67]
    v_mfma_f32_16x16x32_bf16 v[68:71], a[12:15], a[36:39], v[68:71]
    buffer_load_dwordx4 a[88:91], v2, s[24:27], s36 offen offset:2048 sc1
    v_mfma_f32_16x16x32_bf16 v[72:75], a[12:15], a[40:43], v[72:75]
    v_mfma_f32_16x16x32_bf16 v[76:79], a[12:15], a[44:47], v[76:79]
    ds_read_b128 a[12:15], v9 offset:25600
    s_waitcnt lgkmcnt(15)
    v_mfma_f32_16x16x32_bf16 v[80:83], a[16:19], a[32:35], v[80:83]
    v_mfma_f32_16x16x32_bf16 v[84:87], a[16:19], a[36:39], v[84:87]
    v_mfma_f32_16x16x32_bf16 v[88:91], a[16:19], a[40:43], v[88:91]
    v_mfma_f32_16x16x32_bf16 v[92:95], a[16:19], a[44:47], v[92:95]
    ds_read_b128 a[16:19], v9 offset:26624
    s_waitcnt lgkmcnt(15)
    v_mfma_f32_16x16x32_bf16 v[96:99], a[20:23], a[32:35], v[96:99]
    v_mfma_f32_16x16x32_bf16 v[100:103], a[20:23], a[36:39], v[100:103]
    v_mfma_f32_16x16x32_bf16 v[104:107], a[20:23], a[40:43], v[104:107]
    v_mfma_f32_16x16x32_bf16 v[108:111], a[20:23], a[44:47], v[108:111]
    ds_read_b128 a[20:23], v9 offset:27648
    s_waitcnt lgkmcnt(15)
    v_mfma_f32_16x16x32_bf16 v[112:115], a[24:27], a[32:35], v[112:115]
    v_mfma_f32_16x16x32_bf16 v[116:119], a[24:27], a[36:39], v[116:119]
    ds_read_b128 a[24:27], v12 offset:22528
    s_waitcnt lgkmcnt(15)
    v_mfma_f32_16x16x32_bf16 v[120:123], a[28:31], a[32:35], v[120:123]
    v_mfma_f32_16x16x32_bf16 v[124:127], a[28:31], a[36:39], v[124:127]
    ds_read_b128 a[28:31], v12 offset:29696
    s_waitcnt lgkmcnt(6)
    v_mfma_f32_16x16x32_bf16 v[16:19], a[0:3], a[48:51], v[16:19]
    s_barrier
    v_mfma_f32_16x16x32_bf16 v[20:23], a[0:3], a[52:55], v[20:23]
    ds_read_b64_tr_b16 a[32:33], v5 offset:0
    v_mfma_f32_16x16x32_bf16 v[24:27], a[0:3], a[56:59], v[24:27]
    ds_read_b64_tr_b16 a[34:35], v5 offset:512
    v_mfma_f32_16x16x32_bf16 v[28:31], a[0:3], a[60:63], v[28:31]
    ds_read_b128 a[0:3], v8 offset:0
    s_waitcnt lgkmcnt(12)
    v_mfma_f32_16x16x32_bf16 v[32:35], a[4:7], a[48:51], v[32:35]
    ds_read_b64_tr_b16 a[36:37], v5 offset:1024
    v_mfma_f32_16x16x32_bf16 v[36:39], a[4:7], a[52:55], v[36:39]
    ds_read_b64_tr_b16 a[38:39], v5 offset:1536
    v_mfma_f32_16x16x32_bf16 v[40:43], a[4:7], a[56:59], v[40:43]
    ds_read_b64_tr_b16 a[40:41], v1 offset:0
    v_mfma_f32_16x16x32_bf16 v[44:47], a[4:7], a[60:63], v[44:47]
    ds_read_b128 a[4:7], v8 offset:1024
    s_waitcnt lgkmcnt(12)
    v_mfma_f32_16x16x32_bf16 v[48:51], a[8:11], a[48:51], v[48:51]
    ds_read_b64_tr_b16 a[42:43], v1 offset:512
    v_mfma_f32_16x16x32_bf16 v[52:55], a[8:11], a[52:55], v[52:55]
    ds_read_b64_tr_b16 a[44:45], v1 offset:1024
    v_mfma_f32_16x16x32_bf16 v[56:59], a[8:11], a[56:59], v[56:59]
    ds_read_b64_tr_b16 a[46:47], v1 offset:1536
    v_mfma_f32_16x16x32_bf16 v[60:63], a[8:11], a[60:63], v[60:63]
    ds_read_b128 a[8:11], v8 offset:2048
    s_waitcnt lgkmcnt(15)
    v_mfma_f32_16x16x32_bf16 v[64:67], a[12:15], a[48:51], v[64:67]
    v_mfma_f32_16x16x32_bf16 v[68:71], a[12:15], a[52:55], v[68:71]
    buffer_load_dwordx4 a[92:95], v2, s[24:27], s36 offen offset:3072 sc1
    s_add_u32 s36, s36, 4096
    v_mfma_f32_16x16x32_bf16 v[72:75], a[12:15], a[56:59], v[72:75]
    v_mfma_f32_16x16x32_bf16 v[76:79], a[12:15], a[60:63], v[76:79]
    ds_read_b128 a[12:15], v8 offset:3072
    s_waitcnt lgkmcnt(15)
    v_mfma_f32_16x16x32_bf16 v[80:83], a[16:19], a[48:51], v[80:83]
    v_mfma_f32_16x16x32_bf16 v[84:87], a[16:19], a[52:55], v[84:87]
    v_mfma_f32_16x16x32_bf16 v[88:91], a[16:19], a[56:59], v[88:91]
    v_mfma_f32_16x16x32_bf16 v[92:95], a[16:19], a[60:63], v[92:95]
    ds_read_b128 a[16:19], v8 offset:4096
    s_waitcnt lgkmcnt(15)
    v_mfma_f32_16x16x32_bf16 v[96:99], a[20:23], a[48:51], v[96:99]
    v_mfma_f32_16x16x32_bf16 v[100:103], a[20:23], a[52:55], v[100:103]
    v_mfma_f32_16x16x32_bf16 v[104:107], a[20:23], a[56:59], v[104:107]
    v_mfma_f32_16x16x32_bf16 v[108:111], a[20:23], a[60:63], v[108:111]
    ds_read_b128 a[20:23], v8 offset:5120
    s_waitcnt lgkmcnt(15)
    v_mfma_f32_16x16x32_bf16 v[112:115], a[24:27], a[48:51], v[112:115]
    v_mfma_f32_16x16x32_bf16 v[116:119], a[24:27], a[52:55], v[116:119]
    ds_read_b128 a[24:27], v11 offset:0
    s_waitcnt lgkmcnt(15)
    v_mfma_f32_16x16x32_bf16 v[120:123], a[28:31], a[48:51], v[120:123]
    v_mfma_f32_16x16x32_bf16 v[124:127], a[28:31], a[52:55], v[124:127]
    ds_read_b128 a[28:31], v11 offset:7168
    s_waitcnt lgkmcnt(6)
    v_mfma_f32_16x16x32_bf16 v[16:19], a[0:3], a[32:35], v[16:19]
    s_barrier
    v_mfma_f32_16x16x32_bf16 v[20:23], a[0:3], a[36:39], v[20:23]
    ds_read_b64_tr_b16 a[48:49], v5 offset:22528
    v_mfma_f32_16x16x32_bf16 v[24:27], a[0:3], a[40:43], v[24:27]
    ds_read_b64_tr_b16 a[50:51], v5 offset:23040
    v_mfma_f32_16x16x32_bf16 v[28:31], a[0:3], a[44:47], v[28:31]
    ds_read_b128 a[0:3], v8 offset:22528
    s_waitcnt lgkmcnt(12)
    v_mfma_f32_16x16x32_bf16 v[32:35], a[4:7], a[32:35], v[32:35]
    ds_read_b64_tr_b16 a[52:53], v5 offset:23552
    v_mfma_f32_16x16x32_bf16 v[36:39], a[4:7], a[36:39], v[36:39]
    ds_read_b64_tr_b16 a[54:55], v5 offset:24064
    v_mfma_f32_16x16x32_bf16 v[40:43], a[4:7], a[40:43], v[40:43]
    ds_read_b64_tr_b16 a[56:57], v1 offset:22528
    v_mfma_f32_16x16x32_bf16 v[44:47], a[4:7], a[44:47], v[44:47]
    ds_read_b128 a[4:7], v8 offset:23552
    s_waitcnt lgkmcnt(12)
    v_mfma_f32_16x16x32_bf16 v[48:51], a[8:11], a[32:35], v[48:51]
    ds_read_b64_tr_b16 a[58:59], v1 offset:23040
    v_mfma_f32_16x16x32_bf16 v[52:55], a[8:11], a[36:39], v[52:55]
    ds_read_b64_tr_b16 a[60:61], v1 offset:23552
    v_mfma_f32_16x16x32_bf16 v[56:59], a[8:11], a[40:43], v[56:59]
    ds_read_b64_tr_b16 a[62:63], v1 offset:24064
    v_mfma_f32_16x16x32_bf16 v[60:63], a[8:11], a[44:47], v[60:63]
    ds_read_b128 a[8:11], v8 offset:24576
    s_waitcnt lgkmcnt(15)
    v_mfma_f32_16x16x32_bf16 v[64:67], a[12:15], a[32:35], v[64:67]
    v_mfma_f32_16x16x32_bf16 v[68:71], a[12:15], a[36:39], v[68:71]
    buffer_load_dwordx4 a[96:99], v2, s[24:27], s36 offen offset:0 sc1
    v_mfma_f32_16x16x32_bf16 v[72:75], a[12:15], a[40:43], v[72:75]
    v_mfma_f32_16x16x32_bf16 v[76:79], a[12:15], a[44:47], v[76:79]
    ds_read_b128 a[12:15], v8 offset:25600
    s_waitcnt lgkmcnt(15)
    v_mfma_f32_16x16x32_bf16 v[80:83], a[16:19], a[32:35], v[80:83]
    v_mfma_f32_16x16x32_bf16 v[84:87], a[16:19], a[36:39], v[84:87]
    v_mfma_f32_16x16x32_bf16 v[88:91], a[16:19], a[40:43], v[88:91]
    v_mfma_f32_16x16x32_bf16 v[92:95], a[16:19], a[44:47], v[92:95]
    ds_read_b128 a[16:19], v8 offset:26624
    s_waitcnt lgkmcnt(15)
    v_mfma_f32_16x16x32_bf16 v[96:99], a[20:23], a[32:35], v[96:99]
    v_mfma_f32_16x16x32_bf16 v[100:103], a[20:23], a[36:39], v[100:103]
    v_mfma_f32_16x16x32_bf16 v[104:107], a[20:23], a[40:43], v[104:107]
    v_mfma_f32_16x16x32_bf16 v[108:111], a[20:23], a[44:47], v[108:111]
    ds_read_b128 a[20:23], v8 offset:27648
    s_waitcnt lgkmcnt(15)
    v_mfma_f32_16x16x32_bf16 v[112:115], a[24:27], a[32:35], v[112:115]
    v_mfma_f32_16x16x32_bf16 v[116:119], a[24:27], a[36:39], v[116:119]
    ds_read_b128 a[24:27], v11 offset:22528
    s_waitcnt lgkmcnt(15)
    v_mfma_f32_16x16x32_bf16 v[120:123], a[28:31], a[32:35], v[120:123]
    v_mfma_f32_16x16x32_bf16 v[124:127], a[28:31], a[36:39], v[124:127]
    ds_read_b128 a[28:31], v11 offset:29696
    s_waitcnt lgkmcnt(6)
    v_mfma_f32_16x16x32_bf16 v[16:19], a[0:3], a[48:51], v[16:19]
    s_barrier
    v_mfma_f32_16x16x32_bf16 v[20:23], a[0:3], a[52:55], v[20:23]
    ds_read_b64_tr_b16 a[32:33], v5 offset:45056
    v_mfma_f32_16x16x32_bf16 v[24:27], a[0:3], a[56:59], v[24:27]
    ds_read_b64_tr_b16 a[34:35], v5 offset:45568
    v_mfma_f32_16x16x32_bf16 v[28:31], a[0:3], a[60:63], v[28:31]
    ds_read_b128 a[0:3], v8 offset:45056
    s_waitcnt lgkmcnt(12)
    v_mfma_f32_16x16x32_bf16 v[32:35], a[4:7], a[48:51], v[32:35]
    ds_read_b64_tr_b16 a[36:37], v5 offset:46080
    v_mfma_f32_16x16x32_bf16 v[36:39], a[4:7], a[52:55], v[36:39]
    ds_read_b64_tr_b16 a[38:39], v5 offset:46592
    v_mfma_f32_16x16x32_bf16 v[40:43], a[4:7], a[56:59], v[40:43]
    ds_read_b64_tr_b16 a[40:41], v1 offset:45056
    v_mfma_f32_16x16x32_bf16 v[44:47], a[4:7], a[60:63], v[44:47]
    ds_read_b128 a[4:7], v8 offset:46080
    s_waitcnt lgkmcnt(12)
    v_mfma_f32_16x16x32_bf16 v[48:51], a[8:11], a[48:51], v[48:51]
    ds_read_b64_tr_b16 a[42:43], v1 offset:45568
    v_mfma_f32_16x16x32_bf16 v[52:55], a[8:11], a[52:55], v[52:55]
    ds_read_b64_tr_b16 a[44:45], v1 offset:46080
    v_mfma_f32_16x16x32_bf16 v[56:59], a[8:11], a[56:59], v[56:59]
    ds_read_b64_tr_b16 a[46:47], v1 offset:46592
    v_mfma_f32_16x16x32_bf16 v[60:63], a[8:11], a[60:63], v[60:63]
    ds_read_b128 a[8:11], v8 offset:47104
    s_waitcnt lgkmcnt(15)
    v_mfma_f32_16x16x32_bf16 v[64:67], a[12:15], a[48:51], v[64:67]
    v_mfma_f32_16x16x32_bf16 v[68:71], a[12:15], a[52:55], v[68:71]
    buffer_load_dwordx4 a[100:103], v2, s[24:27], s36 offen offset:1024 sc1
    v_mfma_f32_16x16x32_bf16 v[72:75], a[12:15], a[56:59], v[72:75]
    v_mfma_f32_16x16x32_bf16 v[76:79], a[12:15], a[60:63], v[76:79]
    ds_read_b128 a[12:15], v8 offset:48128
    s_waitcnt lgkmcnt(15)
    v_mfma_f32_16x16x32_bf16 v[80:83], a[16:19], a[48:51], v[80:83]
    v_mfma_f32_16x16x32_bf16 v[84:87], a[16:19], a[52:55], v[84:87]
    v_mfma_f32_16x16x32_bf16 v[88:91], a[16:19], a[56:59], v[88:91]
    v_mfma_f32_16x16x32_bf16 v[92:95], a[16:19], a[60:63], v[92:95]
    ds_read_b128 a[16:19], v8 offset:49152
    s_waitcnt lgkmcnt(15)
    v_mfma_f32_16x16x32_bf16 v[96:99], a[20:23], a[48:51], v[96:99]
    v_mfma_f32_16x16x32_bf16 v[100:103], a[20:23], a[52:55], v[100:103]
    v_mfma_f32_16x16x32_bf16 v[104:107], a[20:23], a[56:59], v[104:107]
    v_mfma_f32_16x16x32_bf16 v[108:111], a[20:23], a[60:63], v[108:111]
    ds_read_b128 a[20:23], v8 offset:50176
    s_waitcnt lgkmcnt(15)
    v_mfma_f32_16x16x32_bf16 v[112:115], a[24:27], a[48:51], v[112:115]
    v_mfma_f32_16x16x32_bf16 v[116:119], a[24:27], a[52:55], v[116:119]
    ds_read_b128 a[24:27], v11 offset:45056
    s_waitcnt lgkmcnt(15)
    v_mfma_f32_16x16x32_bf16 v[120:123], a[28:31], a[48:51], v[120:123]
    v_mfma_f32_16x16x32_bf16 v[124:127], a[28:31], a[52:55], v[124:127]
    ds_read_b128 a[28:31], v11 offset:52224
    s_waitcnt lgkmcnt(6)
    v_mfma_f32_16x16x32_bf16 v[16:19], a[0:3], a[32:35], v[16:19]
    s_barrier
    v_mfma_f32_16x16x32_bf16 v[20:23], a[0:3], a[36:39], v[20:23]
    ds_read_b64_tr_b16 a[48:49], v6 offset:0
    v_mfma_f32_16x16x32_bf16 v[24:27], a[0:3], a[40:43], v[24:27]
    ds_read_b64_tr_b16 a[50:51], v6 offset:512
    v_mfma_f32_16x16x32_bf16 v[28:31], a[0:3], a[44:47], v[28:31]
    ds_read_b128 a[0:3], v9 offset:0
    s_waitcnt lgkmcnt(12)
    v_mfma_f32_16x16x32_bf16 v[32:35], a[4:7], a[32:35], v[32:35]
    ds_read_b64_tr_b16 a[52:53], v6 offset:1024
    v_mfma_f32_16x16x32_bf16 v[36:39], a[4:7], a[36:39], v[36:39]
    ds_read_b64_tr_b16 a[54:55], v6 offset:1536
    v_mfma_f32_16x16x32_bf16 v[40:43], a[4:7], a[40:43], v[40:43]
    ds_read_b64_tr_b16 a[56:57], v14 offset:0
    v_mfma_f32_16x16x32_bf16 v[44:47], a[4:7], a[44:47], v[44:47]
    ds_read_b128 a[4:7], v9 offset:1024
    s_waitcnt lgkmcnt(12)
    v_mfma_f32_16x16x32_bf16 v[48:51], a[8:11], a[32:35], v[48:51]
    ds_read_b64_tr_b16 a[58:59], v14 offset:512
    v_mfma_f32_16x16x32_bf16 v[52:55], a[8:11], a[36:39], v[52:55]
    ds_read_b64_tr_b16 a[60:61], v14 offset:1024
    v_mfma_f32_16x16x32_bf16 v[56:59], a[8:11], a[40:43], v[56:59]
    ds_read_b64_tr_b16 a[62:63], v14 offset:1536
    v_mfma_f32_16x16x32_bf16 v[60:63], a[8:11], a[44:47], v[60:63]
    ds_read_b128 a[8:11], v9 offset:2048
    s_waitcnt lgkmcnt(15)
    v_mfma_f32_16x16x32_bf16 v[64:67], a[12:15], a[32:35], v[64:67]
    v_mfma_f32_16x16x32_bf16 v[68:71], a[12:15], a[36:39], v[68:71]
    buffer_load_dwordx4 a[104:107], v2, s[24:27], s36 offen offset:2048 sc1
    v_mfma_f32_16x16x32_bf16 v[72:75], a[12:15], a[40:43], v[72:75]
    v_mfma_f32_16x16x32_bf16 v[76:79], a[12:15], a[44:47], v[76:79]
    ds_read_b128 a[12:15], v9 offset:3072
    s_waitcnt lgkmcnt(15)
    v_mfma_f32_16x16x32_bf16 v[80:83], a[16:19], a[32:35], v[80:83]
    v_mfma_f32_16x16x32_bf16 v[84:87], a[16:19], a[36:39], v[84:87]
    v_mfma_f32_16x16x32_bf16 v[88:91], a[16:19], a[40:43], v[88:91]
    v_mfma_f32_16x16x32_bf16 v[92:95], a[16:19], a[44:47], v[92:95]
    ds_read_b128 a[16:19], v9 offset:4096
    s_waitcnt lgkmcnt(15)
    v_mfma_f32_16x16x32_bf16 v[96:99], a[20:23], a[32:35], v[96:99]
    v_mfma_f32_16x16x32_bf16 v[100:103], a[20:23], a[36:39], v[100:103]
    v_mfma_f32_16x16x32_bf16 v[104:107], a[20:23], a[40:43], v[104:107]
    v_mfma_f32_16x16x32_bf16 v[108:111], a[20:23], a[44:47], v[108:111]
    ds_read_b128 a[20:23], v9 offset:5120
    s_waitcnt lgkmcnt(15)
    v_mfma_f32_16x16x32_bf16 v[112:115], a[24:27], a[32:35], v[112:115]
    v_mfma_f32_16x16x32_bf16 v[116:119], a[24:27], a[36:39], v[116:119]
    ds_read_b128 a[24:27], v12 offset:0
    s_waitcnt lgkmcnt(15)
    v_mfma_f32_16x16x32_bf16 v[120:123], a[28:31], a[32:35], v[120:123]
    v_mfma_f32_16x16x32_bf16 v[124:127], a[28:31], a[36:39], v[124:127]
    ds_read_b128 a[28:31], v12 offset:7168
    s_waitcnt lgkmcnt(6)
    v_mfma_f32_16x16x32_bf16 v[16:19], a[0:3], a[48:51], v[16:19]
    s_barrier
    v_mfma_f32_16x16x32_bf16 v[20:23], a[0:3], a[52:55], v[20:23]
    ds_read_b64_tr_b16 a[32:33], v6 offset:22528
    v_mfma_f32_16x16x32_bf16 v[24:27], a[0:3], a[56:59], v[24:27]
    ds_read_b64_tr_b16 a[34:35], v6 offset:23040
    v_mfma_f32_16x16x32_bf16 v[28:31], a[0:3], a[60:63], v[28:31]
    ds_read_b128 a[0:3], v9 offset:22528
    s_waitcnt lgkmcnt(12)
    v_mfma_f32_16x16x32_bf16 v[32:35], a[4:7], a[48:51], v[32:35]
    ds_read_b64_tr_b16 a[36:37], v6 offset:23552
    v_mfma_f32_16x16x32_bf16 v[36:39], a[4:7], a[52:55], v[36:39]
    ds_read_b64_tr_b16 a[38:39], v6 offset:24064
    v_mfma_f32_16x16x32_bf16 v[40:43], a[4:7], a[56:59], v[40:43]
    ds_read_b64_tr_b16 a[40:41], v14 offset:22528
    v_mfma_f32_16x16x32_bf16 v[44:47], a[4:7], a[60:63], v[44:47]
    ds_read_b128 a[4:7], v9 offset:23552
    s_waitcnt lgkmcnt(12)
    v_mfma_f32_16x16x32_bf16 v[48:51], a[8:11], a[48:51], v[48:51]
    ds_read_b64_tr_b16 a[42:43], v14 offset:23040
    v_mfma_f32_16x16x32_bf16 v[52:55], a[8:11], a[52:55], v[52:55]
    ds_read_b64_tr_b16 a[44:45], v14 offset:23552
    v_mfma_f32_16x16x32_bf16 v[56:59], a[8:11], a[56:59], v[56:59]
    ds_read_b64_tr_b16 a[46:47], v14 offset:24064
    v_mfma_f32_16x16x32_bf16 v[60:63], a[8:11], a[60:63], v[60:63]
    ds_read_b128 a[8:11], v9 offset:24576
    s_waitcnt lgkmcnt(15)
    v_mfma_f32_16x16x32_bf16 v[64:67], a[12:15], a[48:51], v[64:67]
    v_mfma_f32_16x16x32_bf16 v[68:71], a[12:15], a[52:55], v[68:71]
    buffer_load_dwordx4 a[108:111], v2, s[24:27], s36 offen offset:3072 sc1
    s_add_u32 s36, s36, 4096
    v_mfma_f32_16x16x32_bf16 v[72:75], a[12:15], a[56:59], v[72:75]
    v_mfma_f32_16x16x32_bf16 v[76:79], a[12:15], a[60:63], v[76:79]
    ds_read_b128 a[12:15], v9 offset:25600
    s_waitcnt lgkmcnt(15)
    v_mfma_f32_16x16x32_bf16 v[80:83], a[16:19], a[48:51], v[80:83]
    v_mfma_f32_16x16x32_bf16 v[84:87], a[16:19], a[52:55], v[84:87]
    v_mfma_f32_16x16x32_bf16 v[88:91], a[16:19], a[56:59], v[88:91]
    v_mfma_f32_16x16x32_bf16 v[92:95], a[16:19], a[60:63], v[92:95]
    ds_read_b128 a[16:19], v9 offset:26624
    s_waitcnt lgkmcnt(15)
    v_mfma_f32_16x16x32_bf16 v[96:99], a[20:23], a[48:51], v[96:99]
    v_mfma_f32_16x16x32_bf16 v[100:103], a[20:23], a[52:55], v[100:103]
    v_mfma_f32_16x16x32_bf16 v[104:107], a[20:23], a[56:59], v[104:107]
    v_mfma_f32_16x16x32_bf16 v[108:111], a[20:23], a[60:63], v[108:111]
    ds_read_b128 a[20:23], v9 offset:27648
    s_waitcnt lgkmcnt(15)
    v_mfma_f32_16x16x32_bf16 v[112:115], a[24:27], a[48:51], v[112:115]
    v_mfma_f32_16x16x32_bf16 v[116:119], a[24:27], a[52:55], v[116:119]
    ds_read_b128 a[24:27], v12 offset:22528
    s_waitcnt lgkmcnt(15)
    v_mfma_f32_16x16x32_bf16 v[120:123], a[28:31], a[48:51], v[120:123]
    v_mfma_f32_16x16x32_bf16 v[124:127], a[28:31], a[52:55], v[124:127]
    ds_read_b128 a[28:31], v12 offset:29696
    s_waitcnt lgkmcnt(6)
    v_mfma_f32_16x16x32_bf16 v[16:19], a[0:3], a[32:35], v[16:19]
    s_barrier
    v_mfma_f32_16x16x32_bf16 v[20:23], a[0:3], a[36:39], v[20:23]
    ds_read_b64_tr_b16 a[48:49], v5 offset:0
    v_mfma_f32_16x16x32_bf16 v[24:27], a[0:3], a[40:43], v[24:27]
    ds_read_b64_tr_b16 a[50:51], v5 offset:512
    v_mfma_f32_16x16x32_bf16 v[28:31], a[0:3], a[44:47], v[28:31]
    ds_read_b128 a[0:3], v8 offset:0
    s_waitcnt lgkmcnt(12)
    v_mfma_f32_16x16x32_bf16 v[32:35], a[4:7], a[32:35], v[32:35]
    ds_read_b64_tr_b16 a[52:53], v5 offset:1024
    v_mfma_f32_16x16x32_bf16 v[36:39], a[4:7], a[36:39], v[36:39]
    ds_read_b64_tr_b16 a[54:55], v5 offset:1536
    v_mfma_f32_16x16x32_bf16 v[40:43], a[4:7], a[40:43], v[40:43]
    ds_read_b64_tr_b16 a[56:57], v1 offset:0
    v_mfma_f32_16x16x32_bf16 v[44:47], a[4:7], a[44:47], v[44:47]
    ds_read_b128 a[4:7], v8 offset:1024
    s_waitcnt lgkmcnt(12)
    v_mfma_f32_16x16x32_bf16 v[48:51], a[8:11], a[32:35], v[48:51]
    ds_read_b64_tr_b16 a[58:59], v1 offset:512
    v_mfma_f32_16x16x32_bf16 v[52:55], a[8:11], a[36:39], v[52:55]
    ds_read_b64_tr_b16 a[60:61], v1 offset:1024
    v_mfma_f32_16x16x32_bf16 v[56:59], a[8:11], a[40:43], v[56:59]
    ds_read_b64_tr_b16 a[62:63], v1 offset:1536
    v_mfma_f32_16x16x32_bf16 v[60:63], a[8:11], a[44:47], v[60:63]
    ds_read_b128 a[8:11], v8 offset:2048
    s_waitcnt lgkmcnt(15)
    v_mfma_f32_16x16x32_bf16 v[64:67], a[12:15], a[32:35], v[64:67]
    v_mfma_f32_16x16x32_bf16 v[68:71], a[12:15], a[36:39], v[68:71]
    buffer_load_dwordx4 a[112:115], v2, s[24:27], s36 offen offset:0 sc1
    v_mfma_f32_16x16x32_bf16 v[72:75], a[12:15], a[40:43], v[72:75]
    v_mfma_f32_16x16x32_bf16 v[76:79], a[12:15], a[44:47], v[76:79]
    ds_read_b128 a[12:15], v8 offset:3072
    s_waitcnt lgkmcnt(15)
    v_mfma_f32_16x16x32_bf16 v[80:83], a[16:19], a[32:35], v[80:83]
    v_mfma_f32_16x16x32_bf16 v[84:87], a[16:19], a[36:39], v[84:87]
    v_mfma_f32_16x16x32_bf16 v[88:91], a[16:19], a[40:43], v[88:91]
    v_mfma_f32_16x16x32_bf16 v[92:95], a[16:19], a[44:47], v[92:95]
    ds_read_b128 a[16:19], v8 offset:4096
    s_waitcnt lgkmcnt(15)
    v_mfma_f32_16x16x32_bf16 v[96:99], a[20:23], a[32:35], v[96:99]
    v_mfma_f32_16x16x32_bf16 v[100:103], a[20:23], a[36:39], v[100:103]
    v_mfma_f32_16x16x32_bf16 v[104:107], a[20:23], a[40:43], v[104:107]
    v_mfma_f32_16x16x32_bf16 v[108:111], a[20:23], a[44:47], v[108:111]
    ds_read_b128 a[20:23], v8 offset:5120
    s_waitcnt lgkmcnt(15)
    v_mfma_f32_16x16x32_bf16 v[112:115], a[24:27], a[32:35], v[112:115]
    v_mfma_f32_16x16x32_bf16 v[116:119], a[24:27], a[36:39], v[116:119]
    ds_read_b128 a[24:27], v11 offset:0
    s_waitcnt lgkmcnt(15)
    v_mfma_f32_16x16x32_bf16 v[120:123], a[28:31], a[32:35], v[120:123]
    v_mfma_f32_16x16x32_bf16 v[124:127], a[28:31], a[36:39], v[124:127]
    ds_read_b128 a[28:31], v11 offset:7168
    s_waitcnt lgkmcnt(6)
    v_mfma_f32_16x16x32_bf16 v[16:19], a[0:3], a[48:51], v[16:19]
    s_barrier
    v_mfma_f32_16x16x32_bf16 v[20:23], a[0:3], a[52:55], v[20:23]
    ds_read_b64_tr_b16 a[32:33], v5 offset:22528
    v_mfma_f32_16x16x32_bf16 v[24:27], a[0:3], a[56:59], v[24:27]
    ds_read_b64_tr_b16 a[34:35], v5 offset:23040
    v_mfma_f32_16x16x32_bf16 v[28:31], a[0:3], a[60:63], v[28:31]
    ds_read_b128 a[0:3], v8 offset:22528
    s_waitcnt lgkmcnt(12)
    v_mfma_f32_16x16x32_bf16 v[32:35], a[4:7], a[48:51], v[32:35]
    ds_read_b64_tr_b16 a[36:37], v5 offset:23552
    v_mfma_f32_16x16x32_bf16 v[36:39], a[4:7], a[52:55], v[36:39]
    ds_read_b64_tr_b16 a[38:39], v5 offset:24064
    v_mfma_f32_16x16x32_bf16 v[40:43], a[4:7], a[56:59], v[40:43]
    ds_read_b64_tr_b16 a[40:41], v1 offset:22528
    v_mfma_f32_16x16x32_bf16 v[44:47], a[4:7], a[60:63], v[44:47]
    ds_read_b128 a[4:7], v8 offset:23552
    s_waitcnt lgkmcnt(12)
    v_mfma_f32_16x16x32_bf16 v[48:51], a[8:11], a[48:51], v[48:51]
    ds_read_b64_tr_b16 a[42:43], v1 offset:23040
    v_mfma_f32_16x16x32_bf16 v[52:55], a[8:11], a[52:55], v[52:55]
    ds_read_b64_tr_b16 a[44:45], v1 offset:23552
    v_mfma_f32_16x16x32_bf16 v[56:59], a[8:11], a[56:59], v[56:59]
    ds_read_b64_tr_b16 a[46:47], v1 offset:24064
    v_mfma_f32_16x16x32_bf16 v[60:63], a[8:11], a[60:63], v[60:63]
    ds_read_b128 a[8:11], v8 offset:24576
    s_waitcnt lgkmcnt(15)
    v_mfma_f32_16x16x32_bf16 v[64:67], a[12:15], a[48:51], v[64:67]
    v_mfma_f32_16x16x32_bf16 v[68:71], a[12:15], a[52:55], v[68:71]
    buffer_load_dwordx4 a[116:119], v2, s[24:27], s36 offen offset:1024 sc1
    v_mfma_f32_16x16x32_bf16 v[72:75], a[12:15], a[56:59], v[72:75]
    v_mfma_f32_16x16x32_bf16 v[76:79], a[12:15], a[60:63], v[76:79]
    ds_read_b128 a[12:15], v8 offset:25600
    s_waitcnt lgkmcnt(15)
    v_mfma_f32_16x16x32_bf16 v[80:83], a[16:19], a[48:51], v[80:83]
    v_mfma_f32_16x16x32_bf16 v[84:87], a[16:19], a[52:55], v[84:87]
    v_mfma_f32_16x16x32_bf16 v[88:91], a[16:19], a[56:59], v[88:91]
    v_mfma_f32_16x16x32_bf16 v[92:95], a[16:19], a[60:63], v[92:95]
    ds_read_b128 a[16:19], v8 offset:26624
    s_waitcnt lgkmcnt(15)
    v_mfma_f32_16x16x32_bf16 v[96:99], a[20:23], a[48:51], v[96:99]
    v_mfma_f32_16x16x32_bf16 v[100:103], a[20:23], a[52:55], v[100:103]
    v_mfma_f32_16x16x32_bf16 v[104:107], a[20:23], a[56:59], v[104:107]
    v_mfma_f32_16x16x32_bf16 v[108:111], a[20:23], a[60:63], v[108:111]
    ds_read_b128 a[20:23], v8 offset:27648
    s_waitcnt lgkmcnt(15)
    v_mfma_f32_16x16x32_bf16 v[112:115], a[24:27], a[48:51], v[112:115]
    v_mfma_f32_16x16x32_bf16 v[116:119], a[24:27], a[52:55], v[116:119]
    ds_read_b128 a[24:27], v11 offset:22528
    s_waitcnt lgkmcnt(15)
    v_mfma_f32_16x16x32_bf16 v[120:123], a[28:31], a[48:51], v[120:123]
    v_mfma_f32_16x16x32_bf16 v[124:127], a[28:31], a[52:55], v[124:127]
    ds_read_b128 a[28:31], v11 offset:29696
    s_waitcnt lgkmcnt(6)
    v_mfma_f32_16x16x32_bf16 v[16:19], a[0:3], a[32:35], v[16:19]
    s_barrier
    v_mfma_f32_16x16x32_bf16 v[20:23], a[0:3], a[36:39], v[20:23]
    ds_read_b64_tr_b16 a[48:49], v5 offset:45056
    v_mfma_f32_16x16x32_bf16 v[24:27], a[0:3], a[40:43], v[24:27]
    ds_read_b64_tr_b16 a[50:51], v5 offset:45568
    v_mfma_f32_16x16x32_bf16 v[28:31], a[0:3], a[44:47], v[28:31]
    ds_read_b128 a[0:3], v8 offset:45056
    s_waitcnt lgkmcnt(12)
    v_mfma_f32_16x16x32_bf16 v[32:35], a[4:7], a[32:35], v[32:35]
    ds_read_b64_tr_b16 a[52:53], v5 offset:46080
    v_mfma_f32_16x16x32_bf16 v[36:39], a[4:7], a[36:39], v[36:39]
    ds_read_b64_tr_b16 a[54:55], v5 offset:46592
    v_mfma_f32_16x16x32_bf16 v[40:43], a[4:7], a[40:43], v[40:43]
    ds_read_b64_tr_b16 a[56:57], v1 offset:45056
    v_mfma_f32_16x16x32_bf16 v[44:47], a[4:7], a[44:47], v[44:47]
    ds_read_b128 a[4:7], v8 offset:46080
    s_waitcnt lgkmcnt(12)
    v_mfma_f32_16x16x32_bf16 v[48:51], a[8:11], a[32:35], v[48:51]
    ds_read_b64_tr_b16 a[58:59], v1 offset:45568
    v_mfma_f32_16x16x32_bf16 v[52:55], a[8:11], a[36:39], v[52:55]
    ds_read_b64_tr_b16 a[60:61], v1 offset:46080
    v_mfma_f32_16x16x32_bf16 v[56:59], a[8:11], a[40:43], v[56:59]
    ds_read_b64_tr_b16 a[62:63], v1 offset:46592
    v_mfma_f32_16x16x32_bf16 v[60:63], a[8:11], a[44:47], v[60:63]
    ds_read_b128 a[8:11], v8 offset:47104
    s_waitcnt lgkmcnt(15)
    v_mfma_f32_16x16x32_bf16 v[64:67], a[12:15], a[32:35], v[64:67]
    v_mfma_f32_16x16x32_bf16 v[68:71], a[12:15], a[36:39], v[68:71]
    buffer_load_dwordx4 a[120:123], v2, s[24:27], s36 offen offset:2048 sc1
    v_mfma_f32_16x16x32_bf16 v[72:75], a[12:15], a[40:43], v[72:75]
    v_mfma_f32_16x16x32_bf16 v[76:79], a[12:15], a[44:47], v[76:79]
    ds_read_b128 a[12:15], v8 offset:48128
    s_waitcnt lgkmcnt(15)
    v_mfma_f32_16x16x32_bf16 v[80:83], a[16:19], a[32:35], v[80:83]
    v_mfma_f32_16x16x32_bf16 v[84:87], a[16:19], a[36:39], v[84:87]
    v_mfma_f32_16x16x32_bf16 v[88:91], a[16:19], a[40:43], v[88:91]
    v_mfma_f32_16x16x32_bf16 v[92:95], a[16:19], a[44:47], v[92:95]
    ds_read_b128 a[16:19], v8 offset:49152
    s_waitcnt lgkmcnt(15)
    v_mfma_f32_16x16x32_bf16 v[96:99], a[20:23], a[32:35], v[96:99]
    v_mfma_f32_16x16x32_bf16 v[100:103], a[20:23], a[36:39], v[100:103]
    v_mfma_f32_16x16x32_bf16 v[104:107], a[20:23], a[40:43], v[104:107]
    v_mfma_f32_16x16x32_bf16 v[108:111], a[20:23], a[44:47], v[108:111]
    ds_read_b128 a[20:23], v8 offset:50176
    s_waitcnt lgkmcnt(15)
    v_mfma_f32_16x16x32_bf16 v[112:115], a[24:27], a[32:35], v[112:115]
    v_mfma_f32_16x16x32_bf16 v[116:119], a[24:27], a[36:39], v[116:119]
    ds_read_b128 a[24:27], v11 offset:45056
    s_waitcnt lgkmcnt(15)
    v_mfma_f32_16x16x32_bf16 v[120:123], a[28:31], a[32:35], v[120:123]
    v_mfma_f32_16x16x32_bf16 v[124:127], a[28:31], a[36:39], v[124:127]
    ds_read_b128 a[28:31], v11 offset:52224
    s_waitcnt lgkmcnt(6)
    v_mfma_f32_16x16x32_bf16 v[16:19], a[0:3], a[48:51], v[16:19]
    s_barrier
    v_mfma_f32_16x16x32_bf16 v[20:23], a[0:3], a[52:55], v[20:23]
    ds_read_b64_tr_b16 a[32:33], v6 offset:0
    v_mfma_f32_16x16x32_bf16 v[24:27], a[0:3], a[56:59], v[24:27]
    ds_read_b64_tr_b16 a[34:35], v6 offset:512
    v_mfma_f32_16x16x32_bf16 v[28:31], a[0:3], a[60:63], v[28:31]
    ds_read_b128 a[0:3], v9 offset:0
    s_waitcnt lgkmcnt(12)
    v_mfma_f32_16x16x32_bf16 v[32:35], a[4:7], a[48:51], v[32:35]
    ds_read_b64_tr_b16 a[36:37], v6 offset:1024
    v_mfma_f32_16x16x32_bf16 v[36:39], a[4:7], a[52:55], v[36:39]
    ds_read_b64_tr_b16 a[38:39], v6 offset:1536
    v_mfma_f32_16x16x32_bf16 v[40:43], a[4:7], a[56:59], v[40:43]
    ds_read_b64_tr_b16 a[40:41], v14 offset:0
    v_mfma_f32_16x16x32_bf16 v[44:47], a[4:7], a[60:63], v[44:47]
    ds_read_b128 a[4:7], v9 offset:1024
    s_waitcnt lgkmcnt(12)
    v_mfma_f32_16x16x32_bf16 v[48:51], a[8:11], a[48:51], v[48:51]
    ds_read_b64_tr_b16 a[42:43], v14 offset:512
    v_mfma_f32_16x16x32_bf16 v[52:55], a[8:11], a[52:55], v[52:55]
    ds_read_b64_tr_b16 a[44:45], v14 offset:1024
    v_mfma_f32_16x16x32_bf16 v[56:59], a[8:11], a[56:59], v[56:59]
    ds_read_b64_tr_b16 a[46:47], v14 offset:1536
    v_mfma_f32_16x16x32_bf16 v[60:63], a[8:11], a[60:63], v[60:63]
    ds_read_b128 a[8:11], v9 offset:2048
    s_waitcnt lgkmcnt(15)
    v_mfma_f32_16x16x32_bf16 v[64:67], a[12:15], a[48:51], v[64:67]
    v_mfma_f32_16x16x32_bf16 v[68:71], a[12:15], a[52:55], v[68:71]
    buffer_load_dwordx4 a[124:127], v2, s[24:27], s36 offen offset:3072 sc1
    s_add_u32 s36, s36, 4096
    v_mfma_f32_16x16x32_bf16 v[72:75], a[12:15], a[56:59], v[72:75]
    v_mfma_f32_16x16x32_bf16 v[76:79], a[12:15], a[60:63], v[76:79]
    ds_read_b128 a[12:15], v9 offset:3072
    s_waitcnt lgkmcnt(15)
    v_mfma_f32_16x16x32_bf16 v[80:83], a[16:19], a[48:51], v[80:83]
    v_mfma_f32_16x16x32_bf16 v[84:87], a[16:19], a[52:55], v[84:87]
    v_mfma_f32_16x16x32_bf16 v[88:91], a[16:19], a[56:59], v[88:91]
    v_mfma_f32_16x16x32_bf16 v[92:95], a[16:19], a[60:63], v[92:95]
    ds_read_b128 a[16:19], v9 offset:4096
    s_waitcnt lgkmcnt(15)
    v_mfma_f32_16x16x32_bf16 v[96:99], a[20:23], a[48:51], v[96:99]
    v_mfma_f32_16x16x32_bf16 v[100:103], a[20:23], a[52:55], v[100:103]
    v_mfma_f32_16x16x32_bf16 v[104:107], a[20:23], a[56:59], v[104:107]
    v_mfma_f32_16x16x32_bf16 v[108:111], a[20:23], a[60:63], v[108:111]
    ds_read_b128 a[20:23], v9 offset:5120
    s_waitcnt lgkmcnt(15)
    v_mfma_f32_16x16x32_bf16 v[112:115], a[24:27], a[48:51], v[112:115]
    v_mfma_f32_16x16x32_bf16 v[116:119], a[24:27], a[52:55], v[116:119]
    ds_read_b128 a[24:27], v12 offset:0
    s_waitcnt lgkmcnt(15)
    v_mfma_f32_16x16x32_bf16 v[120:123], a[28:31], a[48:51], v[120:123]
    v_mfma_f32_16x16x32_bf16 v[124:127], a[28:31], a[52:55], v[124:127]
    ds_read_b128 a[28:31], v12 offset:7168
    s_waitcnt lgkmcnt(6)
    v_mfma_f32_16x16x32_bf16 v[16:19], a[0:3], a[32:35], v[16:19]
    s_barrier
    v_mfma_f32_16x16x32_bf16 v[20:23], a[0:3], a[36:39], v[20:23]
    ds_read_b64_tr_b16 a[48:49], v6 offset:22528
    v_mfma_f32_16x16x32_bf16 v[24:27], a[0:3], a[40:43], v[24:27]
    ds_read_b64_tr_b16 a[50:51], v6 offset:23040
    v_mfma_f32_16x16x32_bf16 v[28:31], a[0:3], a[44:47], v[28:31]
    ds_read_b128 a[0:3], v9 offset:22528
    s_waitcnt lgkmcnt(12)
    v_mfma_f32_16x16x32_bf16 v[32:35], a[4:7], a[32:35], v[32:35]
    ds_read_b64_tr_b16 a[52:53], v6 offset:23552
    v_mfma_f32_16x16x32_bf16 v[36:39], a[4:7], a[36:39], v[36:39]
    ds_read_b64_tr_b16 a[54:55], v6 offset:24064
    v_mfma_f32_16x16x32_bf16 v[40:43], a[4:7], a[40:43], v[40:43]
    ds_read_b64_tr_b16 a[56:57], v14 offset:22528
    v_mfma_f32_16x16x32_bf16 v[44:47], a[4:7], a[44:47], v[44:47]
    ds_read_b128 a[4:7], v9 offset:23552
    s_waitcnt lgkmcnt(12)
    v_mfma_f32_16x16x32_bf16 v[48:51], a[8:11], a[32:35], v[48:51]
    ds_read_b64_tr_b16 a[58:59], v14 offset:23040
    v_mfma_f32_16x16x32_bf16 v[52:55], a[8:11], a[36:39], v[52:55]
    ds_read_b64_tr_b16 a[60:61], v14 offset:23552
    v_mfma_f32_16x16x32_bf16 v[56:59], a[8:11], a[40:43], v[56:59]
    ds_read_b64_tr_b16 a[62:63], v14 offset:24064
    v_mfma_f32_16x16x32_bf16 v[60:63], a[8:11], a[44:47], v[60:63]
    ds_read_b128 a[8:11], v9 offset:24576
    s_waitcnt lgkmcnt(15)
    v_mfma_f32_16x16x32_bf16 v[64:67], a[12:15], a[32:35], v[64:67]
    v_mfma_f32_16x16x32_bf16 v[68:71], a[12:15], a[36:39], v[68:71]
    v_mfma_f32_16x16x32_bf16 v[72:75], a[12:15], a[40:43], v[72:75]
    v_mfma_f32_16x16x32_bf16 v[76:79], a[12:15], a[44:47], v[76:79]
    ds_read_b128 a[12:15], v9 offset:25600
    s_waitcnt lgkmcnt(15)
    v_mfma_f32_16x16x32_bf16 v[80:83], a[16:19], a[32:35], v[80:83]
    v_mfma_f32_16x16x32_bf16 v[84:87], a[16:19], a[36:39], v[84:87]
    v_mfma_f32_16x16x32_bf16 v[88:91], a[16:19], a[40:43], v[88:91]
    v_mfma_f32_16x16x32_bf16 v[92:95], a[16:19], a[44:47], v[92:95]
    ds_read_b128 a[16:19], v9 offset:26624
    s_waitcnt lgkmcnt(15)
    v_mfma_f32_16x16x32_bf16 v[96:99], a[20:23], a[32:35], v[96:99]
    v_mfma_f32_16x16x32_bf16 v[100:103], a[20:23], a[36:39], v[100:103]
    v_mfma_f32_16x16x32_bf16 v[104:107], a[20:23], a[40:43], v[104:107]
    v_mfma_f32_16x16x32_bf16 v[108:111], a[20:23], a[44:47], v[108:111]
    ds_read_b128 a[20:23], v9 offset:27648
    s_waitcnt lgkmcnt(15)
    v_mfma_f32_16x16x32_bf16 v[112:115], a[24:27], a[32:35], v[112:115]
    v_mfma_f32_16x16x32_bf16 v[116:119], a[24:27], a[36:39], v[116:119]
    ds_read_b128 a[24:27], v12 offset:22528
    s_waitcnt lgkmcnt(15)
    v_mfma_f32_16x16x32_bf16 v[120:123], a[28:31], a[32:35], v[120:123]
    v_mfma_f32_16x16x32_bf16 v[124:127], a[28:31], a[36:39], v[124:127]
    ds_read_b128 a[28:31], v12 offset:29696
    s_waitcnt lgkmcnt(6)
    v_mfma_f32_16x16x32_bf16 v[16:19], a[0:3], a[48:51], v[16:19]
    v_mfma_f32_16x16x32_bf16 v[20:23], a[0:3], a[52:55], v[20:23]
    v_mfma_f32_16x16x32_bf16 v[24:27], a[0:3], a[56:59], v[24:27]
    v_mfma_f32_16x16x32_bf16 v[28:31], a[0:3], a[60:63], v[28:31]
    s_nop 4
    v_max_f32 v16, 0, v16
    v_max_f32 v17, 0, v17
    v_max_f32 v18, 0, v18
    v_max_f32 v19, 0, v19
    s_waitcnt lgkmcnt(9)
    v_mfma_f32_16x16x32_bf16 v[32:35], a[4:7], a[48:51], v[32:35]
    v_max_f32 v20, 0, v20
    v_max_f32 v21, 0, v21
    v_max_f32 v22, 0, v22
    v_max_f32 v23, 0, v23
    v_mfma_f32_16x16x32_bf16 v[36:39], a[4:7], a[52:55], v[36:39]
    v_max_f32 v24, 0, v24
    v_max_f32 v25, 0, v25
    v_max_f32 v26, 0, v26
    v_max_f32 v27, 0, v27
    v_mfma_f32_16x16x32_bf16 v[40:43], a[4:7], a[56:59], v[40:43]
    v_max_f32 v28, 0, v28
    v_max_f32 v29, 0, v29
    v_max_f32 v30, 0, v30
    v_max_f32 v31, 0, v31
    v_mfma_f32_16x16x32_bf16 v[44:47], a[4:7], a[60:63], v[44:47]
    v_mul_f32 v16, v16, v32
    v_mul_f32 v17, v17, v33
    v_mul_f32 v18, v18, v34
    v_mul_f32 v19, v19, v35
    s_waitcnt lgkmcnt(5)
    v_mfma_f32_16x16x32_bf16 v[48:51], a[8:11], a[48:51], v[48:51]
    v_mul_f32 v20, v20, v36
    v_mul_f32 v21, v21, v37
    v_mul_f32 v22, v22, v38
    v_mul_f32 v23, v23, v39
    v_mfma_f32_16x16x32_bf16 v[52:55], a[8:11], a[52:55], v[52:55]
    v_cvt_pk_bf16_f32 v32, v16, v17
    v_cvt_pk_bf16_f32 v33, v18, v19
    v_cvt_pk_bf16_f32 v34, v20, v21
    v_cvt_pk_bf16_f32 v35, v22, v23
    v_mfma_f32_16x16x32_bf16 v[56:59], a[8:11], a[56:59], v[56:59]
    buffer_store_dwordx4 v[32:35], v2, s[20:23], s28 offen offset:0 sc1
    v_mul_f32 v24, v24, v40
    v_mul_f32 v25, v25, v41
    v_mul_f32 v26, v26, v42
    v_mfma_f32_16x16x32_bf16 v[60:63], a[8:11], a[60:63], v[60:63]
    v_mul_f32 v27, v27, v43
    v_mul_f32 v28, v28, v44
    v_mul_f32 v29, v29, v45
    v_mul_f32 v30, v30, v46
    s_waitcnt lgkmcnt(4)
    v_mfma_f32_16x16x32_bf16 v[64:67], a[12:15], a[48:51], v[64:67]
    v_mul_f32 v31, v31, v47
    v_cvt_pk_bf16_f32 v40, v24, v25
    v_cvt_pk_bf16_f32 v41, v26, v27
    v_cvt_pk_bf16_f32 v42, v28, v29
    v_mfma_f32_16x16x32_bf16 v[68:71], a[12:15], a[52:55], v[68:71]
    v_cvt_pk_bf16_f32 v43, v30, v31
    buffer_store_dwordx4 v[40:43], v2, s[20:23], s29 offen offset:0 sc1
    v_max_f32 v48, 0, v48
    v_max_f32 v49, 0, v49
    v_mfma_f32_16x16x32_bf16 v[72:75], a[12:15], a[56:59], v[72:75]
    v_max_f32 v50, 0, v50
    v_max_f32 v51, 0, v51
    v_max_f32 v52, 0, v52
    v_max_f32 v53, 0, v53
    v_mfma_f32_16x16x32_bf16 v[76:79], a[12:15], a[60:63], v[76:79]
    v_max_f32 v54, 0, v54
    v_max_f32 v55, 0, v55
    v_max_f32 v56, 0, v56
    v_max_f32 v57, 0, v57
    s_waitcnt lgkmcnt(3)
    v_mfma_f32_16x16x32_bf16 v[80:83], a[16:19], a[48:51], v[80:83]
    v_max_f32 v58, 0, v58
    v_max_f32 v59, 0, v59
    v_max_f32 v60, 0, v60
    v_max_f32 v61, 0, v61
    v_mfma_f32_16x16x32_bf16 v[84:87], a[16:19], a[52:55], v[84:87]
    v_max_f32 v62, 0, v62
    v_max_f32 v63, 0, v63
    v_mul_f32 v48, v48, v64
    v_mul_f32 v49, v49, v65
    v_mfma_f32_16x16x32_bf16 v[88:91], a[16:19], a[56:59], v[88:91]
    v_mul_f32 v50, v50, v66
    v_mul_f32 v51, v51, v67
    v_mul_f32 v52, v52, v68
    v_mul_f32 v53, v53, v69
    v_mfma_f32_16x16x32_bf16 v[92:95], a[16:19], a[60:63], v[92:95]
    v_mul_f32 v54, v54, v70
    v_mul_f32 v55, v55, v71
    v_cvt_pk_bf16_f32 v64, v48, v49
    v_cvt_pk_bf16_f32 v65, v50, v51
    s_waitcnt lgkmcnt(2)
    v_mfma_f32_16x16x32_bf16 v[96:99], a[20:23], a[48:51], v[96:99]
    v_cvt_pk_bf16_f32 v66, v52, v53
    v_cvt_pk_bf16_f32 v67, v54, v55
    buffer_store_dwordx4 v[64:67], v2, s[20:23], s28 offen offset:2048 sc1
    v_mul_f32 v56, v56, v72
    v_mfma_f32_16x16x32_bf16 v[100:103], a[20:23], a[52:55], v[100:103]
    v_mul_f32 v57, v57, v73
    v_mul_f32 v58, v58, v74
    v_mul_f32 v59, v59, v75
    v_mul_f32 v60, v60, v76
    v_mfma_f32_16x16x32_bf16 v[104:107], a[20:23], a[56:59], v[104:107]
    v_mul_f32 v61, v61, v77
    v_mul_f32 v62, v62, v78
    v_mul_f32 v63, v63, v79
    v_cvt_pk_bf16_f32 v72, v56, v57
    v_mfma_f32_16x16x32_bf16 v[108:111], a[20:23], a[60:63], v[108:111]
    v_cvt_pk_bf16_f32 v73, v58, v59
    v_cvt_pk_bf16_f32 v74, v60, v61
    v_cvt_pk_bf16_f32 v75, v62, v63
    buffer_store_dwordx4 v[72:75], v2, s[20:23], s29 offen offset:2048 sc1
    s_waitcnt lgkmcnt(1)
    v_mfma_f32_16x16x32_bf16 v[112:115], a[24:27], a[48:51], v[112:115]
    s_add_u32 s28, s28, 4096
    s_add_u32 s29, s29, 4096
    v_max_f32 v80, 0, v80
    v_max_f32 v81, 0, v81
    v_mfma_f32_16x16x32_bf16 v[116:119], a[24:27], a[52:55], v[116:119]
    v_max_f32 v82, 0, v82
    v_max_f32 v83, 0, v83
    v_max_f32 v84, 0, v84
    v_max_f32 v85, 0, v85
    s_waitcnt lgkmcnt(0)
    v_mfma_f32_16x16x32_bf16 v[120:123], a[28:31], a[48:51], v[120:123]
    v_max_f32 v86, 0, v86
    v_max_f32 v87, 0, v87
    v_max_f32 v88, 0, v88
    v_max_f32 v89, 0, v89
    v_mfma_f32_16x16x32_bf16 v[124:127], a[28:31], a[52:55], v[124:127]
    v_max_f32 v90, 0, v90
    v_max_f32 v91, 0, v91
    v_max_f32 v92, 0, v92
    v_max_f32 v93, 0, v93
    v_max_f32 v94, 0, v94
    v_max_f32 v95, 0, v95
    v_mul_f32 v80, v80, v96
    v_mul_f32 v81, v81, v97
    v_mul_f32 v82, v82, v98
    v_mul_f32 v83, v83, v99
    v_mul_f32 v84, v84, v100
    v_mul_f32 v85, v85, v101
    v_mul_f32 v86, v86, v102
    v_mul_f32 v87, v87, v103
    v_cvt_pk_bf16_f32 v96, v80, v81
    v_cvt_pk_bf16_f32 v97, v82, v83
    v_cvt_pk_bf16_f32 v98, v84, v85
    v_cvt_pk_bf16_f32 v99, v86, v87
    buffer_store_dwordx4 v[96:99], v2, s[20:23], s28 offen offset:0 sc1
    v_mul_f32 v88, v88, v104
    v_mul_f32 v89, v89, v105
    v_mul_f32 v90, v90, v106
    v_mul_f32 v91, v91, v107
    v_mul_f32 v92, v92, v108
    v_mul_f32 v93, v93, v109
    v_mul_f32 v94, v94, v110
    v_mul_f32 v95, v95, v111
    v_cvt_pk_bf16_f32 v104, v88, v89
    v_cvt_pk_bf16_f32 v105, v90, v91
    v_cvt_pk_bf16_f32 v106, v92, v93
    v_cvt_pk_bf16_f32 v107, v94, v95
    buffer_store_dwordx4 v[104:107], v2, s[20:23], s29 offen offset:0 sc1
    s_cmp_eq_u32 s5, 15
    s_cbranch_scc1 K2_P2
    v_max_f32 v112, 0, v112
    v_max_f32 v113, 0, v113
    v_max_f32 v114, 0, v114
    v_max_f32 v115, 0, v115
    v_max_f32 v116, 0, v116
    v_max_f32 v117, 0, v117
    v_max_f32 v118, 0, v118
    v_max_f32 v119, 0, v119
    v_mul_f32 v112, v112, v120
    v_mul_f32 v113, v113, v121
    v_mul_f32 v114, v114, v122
    v_mul_f32 v115, v115, v123
    v_mul_f32 v116, v116, v124
    v_mul_f32 v117, v117, v125
    v_mul_f32 v118, v118, v126
    v_mul_f32 v119, v119, v127
    v_cvt_pk_bf16_f32 v120, v112, v113
    v_cvt_pk_bf16_f32 v121, v114, v115
    v_cvt_pk_bf16_f32 v122, v116, v117
    v_cvt_pk_bf16_f32 v123, v118, v119
    buffer_store_dwordx4 v[120:123], v2, s[20:23], s31 offen sc1
K2_P2:
    s_setprio 3
    v_mov_b32 v5, 1
    s_lshl_b32 s34, s3, 2
    s_add_u32 s34, s34, 161792
    v_mov_b32 v1, s34
    ds_write_b32 v1, v5 offset:16
    s_mul_i32 s34, s3, 12288
    s_add_u32 s34, s34, 112640
    v_add_u32 v108, s34, v2
    s_mul_i32 s34, s3, 5120
    v_add_u32 v109, s34, v2
    s_mul_i32 s34, s3, 3072
    s_add_u32 s34, s34, 22528
    v_add_u32 v110, s34, v2
    s_lshl_b32 s38, s56, 2
    s_add_u32 s38, s38, s3
    s_mul_i32 s38, s38, 20480
    s_mul_i32 s35, s57, 2560
    s_add_u32 s38, s38, s35
    s_mul_i32 s39, s3, 2560
    s_add_u32 s39, s39, 34816
    s_cmp_ge_u32 s3, 2
    s_cbranch_scc1 K2_C7
    buffer_load_dwordx4 v[92:95], v2, s[24:27], s36 offen offset:0 sc1
    buffer_load_dwordx4 v[96:99], v2, s[24:27], s36 offen offset:1024 sc1
    buffer_load_dwordx4 v[100:103], v2, s[24:27], s36 offen offset:2048 sc1
    buffer_load_dwordx4 v[104:107], v2, s[24:27], s36 offen offset:3072 sc1
    s_add_u32 s36, s36, 4096
    s_waitcnt vmcnt(4)
    ds_write_b32 v1, v5 offset:32
    buffer_load_dwordx4 v[8:11], v2, s[20:23], s40 offen offset:0 sc1
    buffer_load_dwordx4 v[16:19], v2, s[20:23], s40 offen offset:1024 sc1
    buffer_load_dwordx4 v[12:15], v2, s[20:23], s40 offen offset:2048 sc1
    buffer_load_dwordx4 v[20:23], v2, s[20:23], s40 offen offset:3072 sc1
    s_add_u32 s40, s40, 4096
    buffer_load_dwordx4 v[24:27], v2, s[20:23], s40 offen offset:0 sc1
    buffer_load_dwordx4 v[32:35], v2, s[20:23], s40 offen offset:1024 sc1
    buffer_load_dwordx4 v[28:31], v2, s[20:23], s40 offen offset:2048 sc1
    buffer_load_dwordx4 v[36:39], v2, s[20:23], s40 offen offset:3072 sc1
    s_add_u32 s40, s40, 4096
    buffer_load_dwordx4 v[40:43], v2, s[20:23], s40 offen offset:0 sc1
    buffer_load_dwordx4 v[48:51], v2, s[20:23], s40 offen offset:1024 sc1
    buffer_load_dwordx4 v[44:47], v2, s[20:23], s40 offen offset:2048 sc1
    buffer_load_dwordx4 v[52:55], v2, s[20:23], s40 offen offset:3072 sc1
    s_add_u32 s40, s40, 4096
    s_lshl_b32 s34, s56, 2
    s_add_u32 s34, s34, s3
    s_lshl_b32 s42, s34, 6
    v_and_b32 v5, 15, v3
    v_lshlrev_b32 v5, 2, v5
    s_mul_i32 s43, s34, 20480
    s_mul_i32 s35, s57, 160
    s_add_u32 s43, s43, s35
    s_mov_b32 s34, 0
K2_CW8:
    ds_read_b32 v7, v1 offset:0
    s_add_u32 s34, s34, 1
    s_cmp_gt_u32 s34, 256000
    s_cbranch_scc1 K2_CW8_X
    s_waitcnt lgkmcnt(0)
    v_cmp_gt_u32 vcc, 1, v7
    s_nop 1
    s_cbranch_vccnz K2_CW8
K2_CW8_X:
    s_waitcnt lgkmcnt(0)
    ds_read_b128 v[72:75], v108 offset:0
    ds_read_b128 v[76:79], v108 offset:1024
    ds_read_b128 v[80:83], v108 offset:2048
    ds_read_b128 v[84:87], v108 offset:3072
    ds_read_b128 v[88:91], v108 offset:4096
    s_waitcnt vmcnt(8)
    v_max3_u32 v4, v8, v12, v16
    v_max_u32 v4, v4, v20
    v_cmp_eq_u32 vcc, -1, v4
    s_nop 1
    s_cbranch_vccnz K2_HC8_0_R
K2_HC8_0_B:
    s_mov_b32 m0, s39
    s_nop 0
    buffer_load_dwordx4 v2, s[8:11], s38 offen offset:0 sc1 lds
    buffer_load_dwordx4 v2, s[8:11], s38 offen offset:1024 sc1 lds
    s_mov_b64 exec, 0xffffffff
    buffer_load_dwordx4 v2, s[8:11], s38 offen offset:2048 sc1 lds
    s_mov_b64 exec, -1
    v_swap_b32 v10, v12
    v_swap_b32 v11, v13
    v_swap_b32 v18, v20
    v_swap_b32 v19, v21
    s_waitcnt lgkmcnt(4)
    v_mfma_f32_16x16x32_bf16 a[0:3], v[72:75], v[8:11], 0
    buffer_load_dwordx4 v[112:115], v2, s[20:23], s40 offen offset:0 sc1
    v_mfma_f32_16x16x32_bf16 a[20:23], v[72:75], v[12:15], 0
    buffer_load_dwordx4 v[120:123], v2, s[20:23], s40 offen offset:1024 sc1
    v_mfma_f32_16x16x32_bf16 a[40:43], v[72:75], v[16:19], 0
    buffer_load_dwordx4 v[116:119], v2, s[20:23], s40 offen offset:2048 sc1
    v_mfma_f32_16x16x32_bf16 a[60:63], v[72:75], v[20:23], 0
    ds_read_b128 v[72:75], v108 offset:5120
    s_waitcnt lgkmcnt(4)
    v_mfma_f32_16x16x32_bf16 a[4:7], v[76:79], v[8:11], 0
    buffer_load_dwordx4 v[124:127], v2, s[20:23], s40 offen offset:3072 sc1
    s_add_u32 s40, s40, 4096
    v_mfma_f32_16x16x32_bf16 a[24:27], v[76:79], v[12:15], 0
    v_mfma_f32_16x16x32_bf16 a[44:47], v[76:79], v[16:19], 0
    v_mfma_f32_16x16x32_bf16 v[56:59], v[76:79], v[20:23], 0
    ds_read_b128 v[76:79], v108 offset:6144
    s_waitcnt lgkmcnt(4)
    v_mfma_f32_16x16x32_bf16 a[8:11], v[80:83], v[8:11], 0
    v_mfma_f32_16x16x32_bf16 a[28:31], v[80:83], v[12:15], 0
    s_waitcnt vmcnt(11)
    v_max3_u32 v4, v24, v28, v32
    v_mfma_f32_16x16x32_bf16 a[48:51], v[80:83], v[16:19], 0
    v_max_u32 v4, v4, v36
    v_mfma_f32_16x16x32_bf16 v[60:63], v[80:83], v[20:23], 0
    ds_read_b128 v[80:83], v108 offset:7168
    s_waitcnt lgkmcnt(4)
    v_mfma_f32_16x16x32_bf16 a[12:15], v[84:87], v[8:11], 0
    v_cmp_eq_u32 vcc, -1, v4
    s_nop 1
    s_cbranch_vccnz K2_HC8_1_R
K2_HC8_1_B:
    v_mfma_f32_16x16x32_bf16 a[32:35], v[84:87], v[12:15], 0
    v_swap_b32 v26, v28
    v_mfma_f32_16x16x32_bf16 a[52:55], v[84:87], v[16:19], 0
    v_swap_b32 v27, v29
    v_mfma_f32_16x16x32_bf16 v[64:67], v[84:87], v[20:23], 0
    ds_read_b128 v[84:87], v108 offset:8192
    s_waitcnt lgkmcnt(4)
    v_mfma_f32_16x16x32_bf16 a[16:19], v[88:91], v[8:11], 0
    v_swap_b32 v34, v36
    v_mfma_f32_16x16x32_bf16 a[36:39], v[88:91], v[12:15], 0
    v_swap_b32 v35, v37
    v_mfma_f32_16x16x32_bf16 a[56:59], v[88:91], v[16:19], 0
    v_mfma_f32_16x16x32_bf16 v[68:71], v[88:91], v[20:23], 0
    ds_read_b128 v[88:91], v108 offset:9216
    s_waitcnt lgkmcnt(4)
    v_mfma_f32_16x16x32_bf16 a[0:3], v[72:75], v[24:27], a[0:3]
    buffer_load_dwordx4 v[8:11], v2, s[20:23], s40 offen offset:0 sc1
    v_mfma_f32_16x16x32_bf16 a[20:23], v[72:75], v[28:31], a[20:23]
    buffer_load_dwordx4 v[16:19], v2, s[20:23], s40 offen offset:1024 sc1
    v_mfma_f32_16x16x32_bf16 a[40:43], v[72:75], v[32:35], a[40:43]
    buffer_load_dwordx4 v[12:15], v2, s[20:23], s40 offen offset:2048 sc1
    v_mfma_f32_16x16x32_bf16 a[60:63], v[72:75], v[36:39], a[60:63]
    ds_read_b128 v[72:75], v108 offset:10240
    s_waitcnt lgkmcnt(4)
    v_mfma_f32_16x16x32_bf16 a[4:7], v[76:79], v[24:27], a[4:7]
    buffer_load_dwordx4 v[20:23], v2, s[20:23], s40 offen offset:3072 sc1
    s_add_u32 s40, s40, 4096
    v_mfma_f32_16x16x32_bf16 a[24:27], v[76:79], v[28:31], a[24:27]
    v_mfma_f32_16x16x32_bf16 a[44:47], v[76:79], v[32:35], a[44:47]
    v_mfma_f32_16x16x32_bf16 v[56:59], v[76:79], v[36:39], v[56:59]
    ds_read_b128 v[76:79], v108 offset:11264
    s_waitcnt lgkmcnt(4)
    v_mfma_f32_16x16x32_bf16 a[8:11], v[80:83], v[24:27], a[8:11]
    v_mfma_f32_16x16x32_bf16 a[28:31], v[80:83], v[28:31], a[28:31]
    s_waitcnt vmcnt(11)
    v_max3_u32 v4, v40, v44, v48
    v_mfma_f32_16x16x32_bf16 a[48:51], v[80:83], v[32:35], a[48:51]
    v_max_u32 v4, v4, v52
    v_mfma_f32_16x16x32_bf16 v[60:63], v[80:83], v[36:39], v[60:63]
    ds_read_b128 v[80:83], v109 offset:0
    s_waitcnt lgkmcnt(4)
    v_mfma_f32_16x16x32_bf16 a[12:15], v[84:87], v[24:27], a[12:15]
    v_cmp_eq_u32 vcc, -1, v4
    s_nop 1
    s_cbranch_vccnz K2_HC8_2_R
K2_HC8_2_B:
    v_mfma_f32_16x16x32_bf16 a[32:35], v[84:87], v[28:31], a[32:35]
    v_swap_b32 v42, v44
    v_mfma_f32_16x16x32_bf16 a[52:55], v[84:87], v[32:35], a[52:55]
    v_swap_b32 v43, v45
    v_mfma_f32_16x16x32_bf16 v[64:67], v[84:87], v[36:39], v[64:67]
    ds_read_b128 v[84:87], v109 offset:1024
    s_waitcnt lgkmcnt(4)
    v_mfma_f32_16x16x32_bf16 a[16:19], v[88:91], v[24:27], a[16:19]
    v_swap_b32 v50, v52
    v_mfma_f32_16x16x32_bf16 a[36:39], v[88:91], v[28:31], a[36:39]
    v_swap_b32 v51, v53
    v_mfma_f32_16x16x32_bf16 a[56:59], v[88:91], v[32:35], a[56:59]
    v_mfma_f32_16x16x32_bf16 v[68:71], v[88:91], v[36:39], v[68:71]
    ds_read_b128 v[88:91], v109 offset:2048
    s_waitcnt lgkmcnt(4)
    v_mfma_f32_16x16x32_bf16 a[0:3], v[72:75], v[40:43], a[0:3]
    buffer_load_dwordx4 v[24:27], v2, s[20:23], s40 offen offset:0 sc1
    v_mfma_f32_16x16x32_bf16 a[20:23], v[72:75], v[44:47], a[20:23]
    buffer_load_dwordx4 v[32:35], v2, s[20:23], s40 offen offset:1024 sc1
    v_mfma_f32_16x16x32_bf16 a[40:43], v[72:75], v[48:51], a[40:43]
    buffer_load_dwordx4 v[28:31], v2, s[20:23], s40 offen offset:2048 sc1
    v_mfma_f32_16x16x32_bf16 a[60:63], v[72:75], v[52:55], a[60:63]
    ds_read_b128 v[72:75], v109 offset:3072
    s_waitcnt lgkmcnt(4)
    v_mfma_f32_16x16x32_bf16 a[4:7], v[76:79], v[40:43], a[4:7]
    buffer_load_dwordx4 v[36:39], v2, s[20:23], s40 offen offset:3072 sc1
    s_add_u32 s40, s40, 4096
    v_mfma_f32_16x16x32_bf16 a[24:27], v[76:79], v[44:47], a[24:27]
    v_mfma_f32_16x16x32_bf16 a[44:47], v[76:79], v[48:51], a[44:47]
    v_mfma_f32_16x16x32_bf16 v[56:59], v[76:79], v[52:55], v[56:59]
    ds_read_b128 v[76:79], v109 offset:4096
    s_waitcnt lgkmcnt(4)
    v_mfma_f32_16x16x32_bf16 a[8:11], v[80:83], v[40:43], a[8:11]
    v_mfma_f32_16x16x32_bf16 a[28:31], v[80:83], v[44:47], a[28:31]
    s_waitcnt vmcnt(8)
    v_max3_u32 v4, v112, v116, v120
    v_mfma_f32_16x16x32_bf16 a[48:51], v[80:83], v[48:51], a[48:51]
    v_max_u32 v4, v4, v124
    v_mfma_f32_16x16x32_bf16 v[60:63], v[80:83], v[52:55], v[60:63]
    ds_read_b128 v[80:83], v110 offset:0
    s_waitcnt lgkmcnt(4)
    v_mfma_f32_16x16x32_bf16 a[12:15], v[84:87], v[40:43], a[12:15]
    v_cmp_eq_u32 vcc, -1, v4
    s_nop 1
    s_cbranch_vccnz K2_HC8_3_R
K2_HC8_3_B:
    v_mfma_f32_16x16x32_bf16 a[32:35], v[84:87], v[44:47], a[32:35]
    v_swap_b32 v114, v116
    v_mfma_f32_16x16x32_bf16 a[52:55], v[84:87], v[48:51], a[52:55]
    v_swap_b32 v115, v117
    v_mfma_f32_16x16x32_bf16 v[64:67], v[84:87], v[52:55], v[64:67]
    ds_read_b128 v[84:87], v110 offset:1024
    s_waitcnt lgkmcnt(4)
    v_mfma_f32_16x16x32_bf16 a[16:19], v[88:91], v[40:43], a[16:19]
    v_swap_b32 v122, v124
    v_mfma_f32_16x16x32_bf16 a[36:39], v[88:91], v[44:47], a[36:39]
    v_swap_b32 v123, v125
    v_mfma_f32_16x16x32_bf16 a[56:59], v[88:91], v[48:51], a[56:59]
    v_mfma_f32_16x16x32_bf16 v[68:71], v[88:91], v[52:55], v[68:71]
    ds_read_b128 v[88:91], v110 offset:2048
    s_waitcnt lgkmcnt(4)
    v_mfma_f32_16x16x32_bf16 a[0:3], v[72:75], v[112:115], a[0:3]
    buffer_load_dwordx4 v[40:43], v2, s[20:23], s40 offen offset:0 sc1
    v_mfma_f32_16x16x32_bf16 a[20:23], v[72:75], v[116:119], a[20:23]
    buffer_load_dwordx4 v[48:51], v2, s[20:23], s40 offen offset:1024 sc1
    v_mfma_f32_16x16x32_bf16 a[40:43], v[72:75], v[120:123], a[40:43]
    buffer_load_dwordx4 v[44:47], v2, s[20:23], s40 offen offset:2048 sc1
    v_mfma_f32_16x16x32_bf16 a[60:63], v[72:75], v[124:127], a[60:63]
    buffer_load_dwordx4 v[52:55], v2, s[20:23], s40 offen offset:3072 sc1
    s_add_u32 s40, s40, 4096
    s_waitcnt lgkmcnt(3)
    v_mfma_f32_16x16x32_bf16 a[4:7], v[76:79], v[112:115], a[4:7]
    buffer_load_dword v6, v5, s[16:19], s42 offen sc1
    v_mfma_f32_16x16x32_bf16 a[24:27], v[76:79], v[116:119], a[24:27]
    v_mfma_f32_16x16x32_bf16 a[44:47], v[76:79], v[120:123], a[44:47]
    v_mfma_f32_16x16x32_bf16 v[56:59], v[76:79], v[124:127], v[56:59]
    s_waitcnt lgkmcnt(2)
    v_mfma_f32_16x16x32_bf16 a[8:11], v[80:83], v[112:115], a[8:11]
    v_mfma_f32_16x16x32_bf16 a[28:31], v[80:83], v[116:119], a[28:31]
    s_waitcnt vmcnt(9)
    v_max3_u32 v4, v8, v12, v16
    v_mfma_f32_16x16x32_bf16 a[48:51], v[80:83], v[120:123], a[48:51]
    v_max_u32 v4, v4, v20
    v_mfma_f32_16x16x32_bf16 v[60:63], v[80:83], v[124:127], v[60:63]
    v_cmp_eq_u32 vcc, -1, v4
    s_nop 1
    s_cbranch_vccnz K2_HC8_4_R
K2_HC8_4_B:
    s_waitcnt lgkmcnt(1)
    v_mfma_f32_16x16x32_bf16 a[12:15], v[84:87], v[112:115], a[12:15]
    v_swap_b32 v10, v12
    v_mfma_f32_16x16x32_bf16 a[32:35], v[84:87], v[116:119], a[32:35]
    v_swap_b32 v11, v13
    v_mfma_f32_16x16x32_bf16 a[52:55], v[84:87], v[120:123], a[52:55]
    v_swap_b32 v18, v20
    v_mfma_f32_16x16x32_bf16 v[64:67], v[84:87], v[124:127], v[64:67]
    v_swap_b32 v19, v21
    s_waitcnt lgkmcnt(0)
    v_mfma_f32_16x16x32_bf16 a[16:19], v[88:91], v[112:115], a[16:19]
    v_mfma_f32_16x16x32_bf16 a[36:39], v[88:91], v[116:119], a[36:39]
    v_mfma_f32_16x16x32_bf16 a[56:59], v[88:91], v[120:123], a[56:59]
    v_mfma_f32_16x16x32_bf16 v[68:71], v[88:91], v[124:127], v[68:71]
    v_mfma_f32_16x16x32_bf16 a[0:3], a[64:67], v[8:11], a[0:3]
    buffer_load_dwordx4 v[112:115], v2, s[20:23], s40 offen offset:0 sc1
    v_mfma_f32_16x16x32_bf16 a[20:23], a[64:67], v[12:15], a[20:23]
    buffer_load_dwordx4 v[120:123], v2, s[20:23], s40 offen offset:1024 sc1
    v_mfma_f32_16x16x32_bf16 a[40:43], a[64:67], v[16:19], a[40:43]
    buffer_load_dwordx4 v[116:119], v2, s[20:23], s40 offen offset:2048 sc1
    v_mfma_f32_16x16x32_bf16 a[60:63], a[64:67], v[20:23], a[60:63]
    buffer_load_dwordx4 v[124:127], v2, s[20:23], s40 offen offset:3072 sc1
    s_add_u32 s40, s40, 4096
    v_mfma_f32_16x16x32_bf16 a[4:7], a[68:71], v[8:11], a[4:7]
    v_add_u32 v109, 0x10000, v2
    v_mfma_f32_16x16x32_bf16 a[24:27], a[68:71], v[12:15], a[24:27]
    v_add_u32 v110, 0x20000, v2
    v_mfma_f32_16x16x32_bf16 a[44:47], a[68:71], v[16:19], a[44:47]
    v_mfma_f32_16x16x32_bf16 v[56:59], a[68:71], v[20:23], v[56:59]
    v_mfma_f32_16x16x32_bf16 a[8:11], a[72:75], v[8:11], a[8:11]
    v_mfma_f32_16x16x32_bf16 a[28:31], a[72:75], v[12:15], a[28:31]
    v_mfma_f32_16x16x32_bf16 a[48:51], a[72:75], v[16:19], a[48:51]
    v_mfma_f32_16x16x32_bf16 v[60:63], a[72:75], v[20:23], v[60:63]
    v_mfma_f32_16x16x32_bf16 a[12:15], a[76:79], v[8:11], a[12:15]
    s_waitcnt vmcnt(9)
    v_max3_u32 v4, v24, v28, v32
    v_mfma_f32_16x16x32_bf16 a[32:35], a[76:79], v[12:15], a[32:35]
    v_max_u32 v4, v4, v36
    v_mfma_f32_16x16x32_bf16 a[52:55], a[76:79], v[16:19], a[52:55]
    v_cmp_eq_u32 vcc, -1, v4
    s_nop 1
    s_cbranch_vccnz K2_HC8_5_R
K2_HC8_5_B:
    v_mfma_f32_16x16x32_bf16 v[64:67], a[76:79], v[20:23], v[64:67]
    v_swap_b32 v26, v28
    v_mfma_f32_16x16x32_bf16 a[16:19], a[80:83], v[8:11], a[16:19]
    v_swap_b32 v27, v29
    v_mfma_f32_16x16x32_bf16 a[36:39], a[80:83], v[12:15], a[36:39]
    v_swap_b32 v34, v36
    v_mfma_f32_16x16x32_bf16 a[56:59], a[80:83], v[16:19], a[56:59]
    v_swap_b32 v35, v37
    v_mfma_f32_16x16x32_bf16 v[68:71], a[80:83], v[20:23], v[68:71]
    v_mfma_f32_16x16x32_bf16 a[0:3], a[84:87], v[24:27], a[0:3]
    v_mfma_f32_16x16x32_bf16 a[20:23], a[84:87], v[28:31], a[20:23]
    v_mfma_f32_16x16x32_bf16 a[40:43], a[84:87], v[32:35], a[40:43]
    v_mfma_f32_16x16x32_bf16 a[60:63], a[84:87], v[36:39], a[60:63]
    v_mfma_f32_16x16x32_bf16 a[4:7], a[88:91], v[24:27], a[4:7]
    s_waitcnt vmcnt(5)
    v_max3_u32 v4, v40, v44, v48
    v_mfma_f32_16x16x32_bf16 a[24:27], a[88:91], v[28:31], a[24:27]
    v_max_u32 v4, v4, v52
    v_mfma_f32_16x16x32_bf16 a[44:47], a[88:91], v[32:35], a[44:47]
    v_cmp_eq_u32 vcc, -1, v4
    s_nop 1
    s_cbranch_vccnz K2_HC8_6_R
K2_HC8_6_B:
    v_mfma_f32_16x16x32_bf16 v[56:59], a[88:91], v[36:39], v[56:59]
    v_swap_b32 v42, v44
    v_mfma_f32_16x16x32_bf16 a[8:11], a[92:95], v[24:27], a[8:11]
    v_swap_b32 v43, v45
    v_mfma_f32_16x16x32_bf16 a[28:31], a[92:95], v[28:31], a[28:31]
    v_swap_b32 v50, v52
    v_mfma_f32_16x16x32_bf16 a[48:51], a[92:95], v[32:35], a[48:51]
    v_swap_b32 v51, v53
    v_mfma_f32_16x16x32_bf16 v[60:63], a[92:95], v[36:39], v[60:63]
    v_mfma_f32_16x16x32_bf16 a[12:15], a[96:99], v[24:27], a[12:15]
    s_waitcnt vmcnt(0)
    v_max3_u32 v4, v112, v116, v120
    v_mfma_f32_16x16x32_bf16 a[32:35], a[96:99], v[28:31], a[32:35]
    v_max_u32 v4, v4, v124
    v_mfma_f32_16x16x32_bf16 a[52:55], a[96:99], v[32:35], a[52:55]
    v_cmp_eq_u32 vcc, -1, v4
    s_nop 1
    s_cbranch_vccnz K2_HC8_7_R
K2_HC8_7_B:
    v_mfma_f32_16x16x32_bf16 v[64:67], a[96:99], v[36:39], v[64:67]
    v_swap_b32 v114, v116
    v_mfma_f32_16x16x32_bf16 a[16:19], a[100:103], v[24:27], a[16:19]
    v_swap_b32 v115, v117
    v_mfma_f32_16x16x32_bf16 a[36:39], a[100:103], v[28:31], a[36:39]
    v_swap_b32 v122, v124
    v_mfma_f32_16x16x32_bf16 a[56:59], a[100:103], v[32:35], a[56:59]
    v_swap_b32 v123, v125
    v_mfma_f32_16x16x32_bf16 v[68:71], a[100:103], v[36:39], v[68:71]
    s_cmp_lg_u32 s3, 0
    s_cbranch_scc1 K2_CF1
    s_setprio 3
    v_mfma_f32_16x16x32_bf16 a[8:11], a[112:115], v[40:43], a[8:11]
    v_mfma_f32_16x16x32_bf16 a[28:31], a[112:115], v[44:47], a[28:31]
    v_mfma_f32_16x16x32_bf16 a[48:51], a[112:115], v[48:51], a[48:51]
    v_mfma_f32_16x16x32_bf16 v[60:63], a[112:115], v[52:55], v[60:63]
    v_mfma_f32_16x16x32_bf16 a[8:11], v[96:99], v[112:115], a[8:11]
    v_mfma_f32_16x16x32_bf16 a[28:31], v[96:99], v[116:119], a[28:31]
    v_mfma_f32_16x16x32_bf16 a[48:51], v[96:99], v[120:123], a[48:51]
    v_mfma_f32_16x16x32_bf16 v[60:63], v[96:99], v[124:127], v[60:63]
    v_mfma_f32_16x16x32_bf16 a[12:15], a[116:119], v[40:43], a[12:15]
    v_mfma_f32_16x16x32_bf16 a[32:35], a[116:119], v[44:47], a[32:35]
    v_mfma_f32_16x16x32_bf16 a[52:55], a[116:119], v[48:51], a[52:55]
    v_mfma_f32_16x16x32_bf16 v[64:67], a[116:119], v[52:55], v[64:67]
    v_mfma_f32_16x16x32_bf16 a[12:15], v[100:103], v[112:115], a[12:15]
    ds_write_b128 v109, a[8:11] offset:47104
    v_mfma_f32_16x16x32_bf16 a[32:35], v[100:103], v[116:119], a[32:35]
    ds_write_b128 v109, a[28:31] offset:52224
    v_mfma_f32_16x16x32_bf16 a[52:55], v[100:103], v[120:123], a[52:55]
    ds_write_b128 v109, a[48:51] offset:57344
    v_mfma_f32_16x16x32_bf16 v[64:67], v[100:103], v[124:127], v[64:67]
    ds_write_b128 v2, v[60:63] offset:3072
    v_mfma_f32_16x16x32_bf16 a[16:19], a[120:123], v[40:43], a[16:19]
    v_mfma_f32_16x16x32_bf16 a[36:39], a[120:123], v[44:47], a[36:39]
    v_mfma_f32_16x16x32_bf16 a[56:59], a[120:123], v[48:51], a[56:59]
    v_mfma_f32_16x16x32_bf16 v[68:71], a[120:123], v[52:55], v[68:71]
    v_mfma_f32_16x16x32_bf16 a[16:19], v[104:107], v[112:115], a[16:19]
    ds_write_b128 v109, a[12:15] offset:48128
    v_mfma_f32_16x16x32_bf16 a[36:39], v[104:107], v[116:119], a[36:39]
    ds_write_b128 v109, a[32:35] offset:53248
    v_mfma_f32_16x16x32_bf16 a[56:59], v[104:107], v[120:123], a[56:59]
    ds_write_b128 v109, a[52:55] offset:58368
    v_mfma_f32_16x16x32_bf16 v[68:71], v[104:107], v[124:127], v[68:71]
    ds_write_b128 v2, v[64:67] offset:4096
    v_mfma_f32_16x16x32_bf16 a[20:23], a[104:107], v[44:47], a[20:23]
    v_mfma_f32_16x16x32_bf16 a[40:43], a[104:107], v[48:51], a[40:43]
    v_mfma_f32_16x16x32_bf16 a[60:63], a[104:107], v[52:55], a[60:63]
    v_mfma_f32_16x16x32_bf16 a[0:3], a[104:107], v[40:43], a[0:3]
    v_mfma_f32_16x16x32_bf16 a[20:23], a[124:127], v[116:119], a[20:23]
    ds_write_b128 v109, a[16:19] offset:49152
    v_mfma_f32_16x16x32_bf16 a[40:43], a[124:127], v[120:123], a[40:43]
    ds_write_b128 v109, a[36:39] offset:54272
    v_mfma_f32_16x16x32_bf16 a[60:63], a[124:127], v[124:127], a[60:63]
    ds_write_b128 v2, a[56:59] offset:0
    v_mfma_f32_16x16x32_bf16 a[0:3], a[124:127], v[112:115], a[0:3]
    ds_write_b128 v2, v[68:71] offset:22528
    v_mfma_f32_16x16x32_bf16 a[24:27], a[108:111], v[44:47], a[24:27]
    v_mfma_f32_16x16x32_bf16 a[44:47], a[108:111], v[48:51], a[44:47]
    v_mfma_f32_16x16x32_bf16 v[56:59], a[108:111], v[52:55], v[56:59]
    v_mfma_f32_16x16x32_bf16 a[4:7], a[108:111], v[40:43], a[4:7]
    v_mfma_f32_16x16x32_bf16 a[24:27], v[92:95], v[116:119], a[24:27]
    ds_write_b128 v109, a[20:23] offset:50176
    v_mfma_f32_16x16x32_bf16 a[44:47], v[92:95], v[120:123], a[44:47]
    ds_write_b128 v109, a[40:43] offset:55296
    v_mfma_f32_16x16x32_bf16 v[56:59], v[92:95], v[124:127], v[56:59]
    ds_write_b128 v2, a[60:63] offset:1024
    v_mfma_f32_16x16x32_bf16 a[4:7], v[92:95], v[112:115], a[4:7]
    v_lshlrev_b32 v1, 3, v3
    v_add_u32 v1, 34816, v1
    v_and_b32 v7, 15, v3
    v_mul_u32_u24 v7, 1280, v7
    v_lshrrev_b32 v4, 4, v3
    v_lshl_add_u32 v7, v4, 3, v7
    ds_write_b128 v109, a[24:27] offset:51200
    ds_write_b128 v109, a[44:47] offset:56320
    ds_write_b128 v2, v[56:59] offset:2048
    v_accvgpr_read_b32 v92, a0
    v_accvgpr_read_b32 v93, a1
    v_accvgpr_read_b32 v94, a2
    v_accvgpr_read_b32 v95, a3
    v_accvgpr_read_b32 v96, a4
    v_accvgpr_read_b32 v97, a5
    v_accvgpr_read_b32 v98, a6
    v_accvgpr_read_b32 v99, a7
    s_waitcnt vmcnt(0)
    v_cmp_eq_u32 vcc, -1, v6
    s_nop 1
    s_cbranch_vccnz K2_R2R0
K2_R2B0:
    s_waitcnt lgkmcnt(0)
    s_barrier
    ds_read_b128 v[8:11], v109 offset:59392
    ds_read_b128 v[12:15], v110 offset:6144
    ds_read_b128 v[16:19], v110 offset:18432
    ds_read_b128 v[20:23], v2 offset:45056
    ds_read_b128 v[24:27], v2 offset:62464
    ds_read_b128 v[28:31], v109 offset:14336
    ds_read_b128 v[32:35], v109 offset:31744
    ds_read_b64_tr_b16 v[104:105], v1 offset:0
    ds_read_b128 v[36:39], v109 offset:60416
    ds_read_b128 v[40:43], v110 offset:7168
    ds_read_b128 v[44:47], v110 offset:19456
    ds_read_b128 v[48:51], v2 offset:46080
    ds_read_b128 v[52:55], v2 offset:63488
    ds_read_b128 v[56:59], v109 offset:15360
    ds_read_b128 v[60:63], v109 offset:32768
    s_waitcnt lgkmcnt(14)
    ds_read_b64_tr_b16 v[106:107], v1 offset:512
    v_pk_add_f32 v[92:93], v[92:93], v[8:9]
    v_pk_add_f32 v[94:95], v[94:95], v[10:11]
    s_waitcnt lgkmcnt(14)
    v_pk_add_f32 v[92:93], v[92:93], v[12:13]
    v_pk_add_f32 v[94:95], v[94:95], v[14:15]
    s_waitcnt lgkmcnt(13)
    v_pk_add_f32 v[92:93], v[92:93], v[16:17]
    v_pk_add_f32 v[94:95], v[94:95], v[18:19]
    s_waitcnt lgkmcnt(12)
    v_pk_add_f32 v[92:93], v[92:93], v[20:21]
    v_pk_add_f32 v[94:95], v[94:95], v[22:23]
    s_waitcnt lgkmcnt(11)
    v_pk_add_f32 v[92:93], v[92:93], v[24:25]
    v_pk_add_f32 v[94:95], v[94:95], v[26:27]
    s_waitcnt lgkmcnt(10)
    v_pk_add_f32 v[92:93], v[92:93], v[28:29]
    v_pk_add_f32 v[94:95], v[94:95], v[30:31]
    s_waitcnt lgkmcnt(9)
    v_pk_add_f32 v[92:93], v[92:93], v[32:33]
    v_pk_add_f32 v[94:95], v[94:95], v[34:35]
    s_waitcnt lgkmcnt(8)
    v_lshlrev_b32 v8, 16, v104
    v_and_b32 v9, 0xffff0000, v104
    v_lshlrev_b32 v10, 16, v105
    v_and_b32 v11, 0xffff0000, v105
    v_fma_f32 v92, v92, v6, v8
    v_fma_f32 v93, v93, v6, v9
    v_fma_f32 v94, v94, v6, v10
    v_fma_f32 v95, v95, v6, v11
    v_cvt_pk_bf16_f32 v92, v92, v93
    v_cvt_pk_bf16_f32 v93, v94, v95
    buffer_store_dwordx2 v[92:93], v7, s[52:55], s43 offen offset:0
    s_waitcnt lgkmcnt(7)
    v_pk_add_f32 v[96:97], v[96:97], v[36:37]
    v_pk_add_f32 v[98:99], v[98:99], v[38:39]
    s_waitcnt lgkmcnt(6)
    v_pk_add_f32 v[96:97], v[96:97], v[40:41]
    v_pk_add_f32 v[98:99], v[98:99], v[42:43]
    s_waitcnt lgkmcnt(5)
    v_pk_add_f32 v[96:97], v[96:97], v[44:45]
    v_pk_add_f32 v[98:99], v[98:99], v[46:47]
    s_waitcnt lgkmcnt(4)
    v_pk_add_f32 v[96:97], v[96:97], v[48:49]
    v_pk_add_f32 v[98:99], v[98:99], v[50:51]
    s_waitcnt lgkmcnt(3)
    v_pk_add_f32 v[96:97], v[96:97], v[52:53]
    v_pk_add_f32 v[98:99], v[98:99], v[54:55]
    s_waitcnt lgkmcnt(2)
    v_pk_add_f32 v[96:97], v[96:97], v[56:57]
    v_pk_add_f32 v[98:99], v[98:99], v[58:59]
    s_waitcnt lgkmcnt(1)
    v_pk_add_f32 v[96:97], v[96:97], v[60:61]
    v_pk_add_f32 v[98:99], v[98:99], v[62:63]
    s_waitcnt lgkmcnt(0)
    v_lshlrev_b32 v36, 16, v106
    v_and_b32 v37, 0xffff0000, v106
    v_lshlrev_b32 v38, 16, v107
    v_and_b32 v39, 0xffff0000, v107
    v_fma_f32 v96, v96, v6, v36
    v_fma_f32 v97, v97, v6, v37
    v_fma_f32 v98, v98, v6, v38
    v_fma_f32 v99, v99, v6, v39
    v_cvt_pk_bf16_f32 v96, v96, v97
    v_cvt_pk_bf16_f32 v97, v98, v99
    buffer_store_dwordx2 v[96:97], v7, s[52:55], s43 offen offset:32
    s_endpgm
K2_HC8_0_R:
    s_mov_b32 s35, 0
K2_HC8_0_L:
    s_sub_u32 s34, s40, 12288
    buffer_load_dwordx4 v[8:11], v2, s[20:23], s34 offen offset:0 sc1
    buffer_load_dwordx4 v[16:19], v2, s[20:23], s34 offen offset:1024 sc1
    buffer_load_dwordx4 v[12:15], v2, s[20:23], s34 offen offset:2048 sc1
    buffer_load_dwordx4 v[20:23], v2, s[20:23], s34 offen offset:3072 sc1
    s_sub_u32 s34, s40, 8192
    buffer_load_dwordx4 v[24:27], v2, s[20:23], s34 offen offset:0 sc1
    buffer_load_dwordx4 v[32:35], v2, s[20:23], s34 offen offset:1024 sc1
    buffer_load_dwordx4 v[28:31], v2, s[20:23], s34 offen offset:2048 sc1
    buffer_load_dwordx4 v[36:39], v2, s[20:23], s34 offen offset:3072 sc1
    s_sub_u32 s34, s40, 4096
    buffer_load_dwordx4 v[40:43], v2, s[20:23], s34 offen offset:0 sc1
    buffer_load_dwordx4 v[48:51], v2, s[20:23], s34 offen offset:1024 sc1
    buffer_load_dwordx4 v[44:47], v2, s[20:23], s34 offen offset:2048 sc1
    buffer_load_dwordx4 v[52:55], v2, s[20:23], s34 offen offset:3072 sc1
    s_add_u32 s35, s35, 1
    s_cmp_gt_u32 s35, 4000
    s_waitcnt vmcnt(8)
    s_cbranch_scc1 K2_HC8_0_B
    v_max3_u32 v4, v8, v12, v16
    v_max_u32 v4, v4, v20
    v_cmp_eq_u32 vcc, -1, v4
    s_nop 1
    s_cbranch_vccnz K2_HC8_0_L
    s_branch K2_HC8_0_B
K2_HC8_1_R:
    s_mov_b32 s35, 0
K2_HC8_1_L:
    s_sub_u32 s34, s40, 12288
    buffer_load_dwordx4 v[24:27], v2, s[20:23], s34 offen offset:0 sc1
    buffer_load_dwordx4 v[32:35], v2, s[20:23], s34 offen offset:1024 sc1
    buffer_load_dwordx4 v[28:31], v2, s[20:23], s34 offen offset:2048 sc1
    buffer_load_dwordx4 v[36:39], v2, s[20:23], s34 offen offset:3072 sc1
    s_add_u32 s35, s35, 1
    s_cmp_gt_u32 s35, 4000
    s_waitcnt vmcnt(0)
    s_cbranch_scc1 K2_HC8_1_B
    v_max3_u32 v4, v24, v28, v32
    v_max_u32 v4, v4, v36
    v_cmp_eq_u32 vcc, -1, v4
    s_nop 1
    s_cbranch_vccnz K2_HC8_1_L
    s_branch K2_HC8_1_B
K2_HC8_2_R:
    s_mov_b32 s35, 0
K2_HC8_2_L:
    s_sub_u32 s34, s40, 12288
    buffer_load_dwordx4 v[40:43], v2, s[20:23], s34 offen offset:0 sc1
    buffer_load_dwordx4 v[48:51], v2, s[20:23], s34 offen offset:1024 sc1
    buffer_load_dwordx4 v[44:47], v2, s[20:23], s34 offen offset:2048 sc1
    buffer_load_dwordx4 v[52:55], v2, s[20:23], s34 offen offset:3072 sc1
    s_add_u32 s35, s35, 1
    s_cmp_gt_u32 s35, 4000
    s_waitcnt vmcnt(0)
    s_cbranch_scc1 K2_HC8_2_B
    v_max3_u32 v4, v40, v44, v48
    v_max_u32 v4, v4, v52
    v_cmp_eq_u32 vcc, -1, v4
    s_nop 1
    s_cbranch_vccnz K2_HC8_2_L
    s_branch K2_HC8_2_B
K2_HC8_3_R:
    s_mov_b32 s35, 0
K2_HC8_3_L:
    s_sub_u32 s34, s40, 12288
    buffer_load_dwordx4 v[112:115], v2, s[20:23], s34 offen offset:0 sc1
    buffer_load_dwordx4 v[120:123], v2, s[20:23], s34 offen offset:1024 sc1
    buffer_load_dwordx4 v[116:119], v2, s[20:23], s34 offen offset:2048 sc1
    buffer_load_dwordx4 v[124:127], v2, s[20:23], s34 offen offset:3072 sc1
    s_add_u32 s35, s35, 1
    s_cmp_gt_u32 s35, 4000
    s_waitcnt vmcnt(0)
    s_cbranch_scc1 K2_HC8_3_B
    v_max3_u32 v4, v112, v116, v120
    v_max_u32 v4, v4, v124
    v_cmp_eq_u32 vcc, -1, v4
    s_nop 1
    s_cbranch_vccnz K2_HC8_3_L
    s_branch K2_HC8_3_B
K2_HC8_4_R:
    s_mov_b32 s35, 0
K2_HC8_4_L:
    s_sub_u32 s34, s40, 12288
    buffer_load_dwordx4 v[8:11], v2, s[20:23], s34 offen offset:0 sc1
    buffer_load_dwordx4 v[16:19], v2, s[20:23], s34 offen offset:1024 sc1
    buffer_load_dwordx4 v[12:15], v2, s[20:23], s34 offen offset:2048 sc1
    buffer_load_dwordx4 v[20:23], v2, s[20:23], s34 offen offset:3072 sc1
    s_add_u32 s35, s35, 1
    s_cmp_gt_u32 s35, 4000
    s_waitcnt vmcnt(0)
    s_cbranch_scc1 K2_HC8_4_B
    v_max3_u32 v4, v8, v12, v16
    v_max_u32 v4, v4, v20
    v_cmp_eq_u32 vcc, -1, v4
    s_nop 1
    s_cbranch_vccnz K2_HC8_4_L
    s_branch K2_HC8_4_B
K2_HC8_5_R:
    s_mov_b32 s35, 0
K2_HC8_5_L:
    s_sub_u32 s34, s40, 12288
    buffer_load_dwordx4 v[24:27], v2, s[20:23], s34 offen offset:0 sc1
    buffer_load_dwordx4 v[32:35], v2, s[20:23], s34 offen offset:1024 sc1
    buffer_load_dwordx4 v[28:31], v2, s[20:23], s34 offen offset:2048 sc1
    buffer_load_dwordx4 v[36:39], v2, s[20:23], s34 offen offset:3072 sc1
    s_add_u32 s35, s35, 1
    s_cmp_gt_u32 s35, 4000
    s_waitcnt vmcnt(0)
    s_cbranch_scc1 K2_HC8_5_B
    v_max3_u32 v4, v24, v28, v32
    v_max_u32 v4, v4, v36
    v_cmp_eq_u32 vcc, -1, v4
    s_nop 1
    s_cbranch_vccnz K2_HC8_5_L
    s_branch K2_HC8_5_B
K2_HC8_6_R:
    s_mov_b32 s35, 0
K2_HC8_6_L:
    s_sub_u32 s34, s40, 8192
    buffer_load_dwordx4 v[40:43], v2, s[20:23], s34 offen offset:0 sc1
    buffer_load_dwordx4 v[48:51], v2, s[20:23], s34 offen offset:1024 sc1
    buffer_load_dwordx4 v[44:47], v2, s[20:23], s34 offen offset:2048 sc1
    buffer_load_dwordx4 v[52:55], v2, s[20:23], s34 offen offset:3072 sc1
    s_add_u32 s35, s35, 1
    s_cmp_gt_u32 s35, 4000
    s_waitcnt vmcnt(0)
    s_cbranch_scc1 K2_HC8_6_B
    v_max3_u32 v4, v40, v44, v48
    v_max_u32 v4, v4, v52
    v_cmp_eq_u32 vcc, -1, v4
    s_nop 1
    s_cbranch_vccnz K2_HC8_6_L
    s_branch K2_HC8_6_B
K2_HC8_7_R:
    s_mov_b32 s35, 0
K2_HC8_7_L:
    s_sub_u32 s34, s40, 4096
    buffer_load_dwordx4 v[112:115], v2, s[20:23], s34 offen offset:0 sc1
    buffer_load_dwordx4 v[120:123], v2, s[20:23], s34 offen offset:1024 sc1
    buffer_load_dwordx4 v[116:119], v2, s[20:23], s34 offen offset:2048 sc1
    buffer_load_dwordx4 v[124:127], v2, s[20:23], s34 offen offset:3072 sc1
    s_add_u32 s35, s35, 1
    s_cmp_gt_u32 s35, 4000
    s_waitcnt vmcnt(0)
    s_cbranch_scc1 K2_HC8_7_B
    v_max3_u32 v4, v112, v116, v120
    v_max_u32 v4, v4, v124
    v_cmp_eq_u32 vcc, -1, v4
    s_nop 1
    s_cbranch_vccnz K2_HC8_7_L
    s_branch K2_HC8_7_B
K2_R2R0:
    s_mov_b32 s35, 0
K2_R2L0:
    buffer_load_dword v6, v5, s[16:19], s42 offen sc1
    s_add_u32 s35, s35, 1
    s_cmp_gt_u32 s35, 4000
    s_waitcnt vmcnt(0)
    s_cbranch_scc1 K2_R2B0
    v_cmp_eq_u32 vcc, -1, v6
    s_nop 1
    s_cbranch_vccnz K2_R2L0
    s_branch K2_R2B0
K2_CF1:
    s_setprio 3
    v_mfma_f32_16x16x32_bf16 a[8:11], a[112:115], v[40:43], a[8:11]
    v_mfma_f32_16x16x32_bf16 a[28:31], a[112:115], v[44:47], a[28:31]
    v_mfma_f32_16x16x32_bf16 a[48:51], a[112:115], v[48:51], a[48:51]
    v_mfma_f32_16x16x32_bf16 v[60:63], a[112:115], v[52:55], v[60:63]
    v_mfma_f32_16x16x32_bf16 a[8:11], v[96:99], v[112:115], a[8:11]
    v_mfma_f32_16x16x32_bf16 a[28:31], v[96:99], v[116:119], a[28:31]
    v_mfma_f32_16x16x32_bf16 a[48:51], v[96:99], v[120:123], a[48:51]
    v_mfma_f32_16x16x32_bf16 v[60:63], v[96:99], v[124:127], v[60:63]
    v_mfma_f32_16x16x32_bf16 a[12:15], a[116:119], v[40:43], a[12:15]
    v_mfma_f32_16x16x32_bf16 a[32:35], a[116:119], v[44:47], a[32:35]
    v_mfma_f32_16x16x32_bf16 a[52:55], a[116:119], v[48:51], a[52:55]
    v_mfma_f32_16x16x32_bf16 v[64:67], a[116:119], v[52:55], v[64:67]
    v_mfma_f32_16x16x32_bf16 a[12:15], v[100:103], v[112:115], a[12:15]
    ds_write_b128 v109, a[8:11] offset:61440
    v_mfma_f32_16x16x32_bf16 a[32:35], v[100:103], v[116:119], a[32:35]
    ds_write_b128 v109, a[28:31] offset:64512
    v_mfma_f32_16x16x32_bf16 a[52:55], v[100:103], v[120:123], a[52:55]
    ds_write_b128 v110, a[48:51] offset:4096
    v_mfma_f32_16x16x32_bf16 v[64:67], v[100:103], v[124:127], v[64:67]
    ds_write_b128 v2, v[60:63] offset:8192
    v_mfma_f32_16x16x32_bf16 a[16:19], a[120:123], v[40:43], a[16:19]
    v_mfma_f32_16x16x32_bf16 a[36:39], a[120:123], v[44:47], a[36:39]
    v_mfma_f32_16x16x32_bf16 a[56:59], a[120:123], v[48:51], a[56:59]
    v_mfma_f32_16x16x32_bf16 v[68:71], a[120:123], v[52:55], v[68:71]
    v_mfma_f32_16x16x32_bf16 a[16:19], v[104:107], v[112:115], a[16:19]
    ds_write_b128 v109, a[12:15] offset:62464
    v_mfma_f32_16x16x32_bf16 a[36:39], v[104:107], v[116:119], a[36:39]
    ds_write_b128 v110, a[32:35] offset:0
    v_mfma_f32_16x16x32_bf16 a[56:59], v[104:107], v[120:123], a[56:59]
    ds_write_b128 v110, a[52:55] offset:5120
    v_mfma_f32_16x16x32_bf16 v[68:71], v[104:107], v[124:127], v[68:71]
    ds_write_b128 v2, v[64:67] offset:9216
    v_mfma_f32_16x16x32_bf16 a[0:3], a[104:107], v[40:43], a[0:3]
    v_mfma_f32_16x16x32_bf16 a[40:43], a[104:107], v[48:51], a[40:43]
    v_mfma_f32_16x16x32_bf16 a[60:63], a[104:107], v[52:55], a[60:63]
    v_mfma_f32_16x16x32_bf16 a[20:23], a[104:107], v[44:47], a[20:23]
    v_mfma_f32_16x16x32_bf16 a[0:3], a[124:127], v[112:115], a[0:3]
    ds_write_b128 v109, a[16:19] offset:63488
    v_mfma_f32_16x16x32_bf16 a[40:43], a[124:127], v[120:123], a[40:43]
    ds_write_b128 v110, a[36:39] offset:1024
    v_mfma_f32_16x16x32_bf16 a[60:63], a[124:127], v[124:127], a[60:63]
    ds_write_b128 v2, a[56:59] offset:5120
    v_mfma_f32_16x16x32_bf16 a[20:23], a[124:127], v[116:119], a[20:23]
    ds_write_b128 v2, v[68:71] offset:25600
    v_mfma_f32_16x16x32_bf16 a[4:7], a[108:111], v[40:43], a[4:7]
    v_mfma_f32_16x16x32_bf16 a[44:47], a[108:111], v[48:51], a[44:47]
    v_mfma_f32_16x16x32_bf16 v[56:59], a[108:111], v[52:55], v[56:59]
    v_mfma_f32_16x16x32_bf16 a[24:27], a[108:111], v[44:47], a[24:27]
    v_mfma_f32_16x16x32_bf16 a[4:7], v[92:95], v[112:115], a[4:7]
    ds_write_b128 v109, a[0:3] offset:59392
    v_mfma_f32_16x16x32_bf16 a[44:47], v[92:95], v[120:123], a[44:47]
    ds_write_b128 v110, a[40:43] offset:2048
    v_mfma_f32_16x16x32_bf16 v[56:59], v[92:95], v[124:127], v[56:59]
    ds_write_b128 v2, a[60:63] offset:6144
    v_mfma_f32_16x16x32_bf16 a[24:27], v[92:95], v[116:119], a[24:27]
    v_lshlrev_b32 v1, 3, v3
    v_add_u32 v1, 37376, v1
    v_and_b32 v7, 15, v3
    v_mul_u32_u24 v7, 1280, v7
    v_lshrrev_b32 v4, 4, v3
    v_lshl_add_u32 v7, v4, 3, v7
    ds_write_b128 v109, a[4:7] offset:60416
    ds_write_b128 v110, a[44:47] offset:3072
    ds_write_b128 v2, v[56:59] offset:7168
    v_accvgpr_read_b32 v92, a20
    v_accvgpr_read_b32 v93, a21
    v_accvgpr_read_b32 v94, a22
    v_accvgpr_read_b32 v95, a23
    v_accvgpr_read_b32 v96, a24
    v_accvgpr_read_b32 v97, a25
    v_accvgpr_read_b32 v98, a26
    v_accvgpr_read_b32 v99, a27
    s_waitcnt vmcnt(0)
    v_cmp_eq_u32 vcc, -1, v6
    s_nop 1
    s_cbranch_vccnz K2_R2R1
K2_R2B1:
    s_waitcnt lgkmcnt(0)
    s_barrier
    ds_read_b128 v[8:11], v109 offset:50176
    ds_read_b128 v[12:15], v110 offset:11264
    ds_read_b128 v[16:19], v110 offset:23552
    ds_read_b128 v[20:23], v2 offset:47104
    ds_read_b128 v[24:27], v109 offset:2048
    ds_read_b128 v[28:31], v109 offset:19456
    ds_read_b128 v[32:35], v109 offset:36864
    ds_read_b64_tr_b16 v[104:105], v1 offset:0
    ds_read_b128 v[36:39], v109 offset:51200
    ds_read_b128 v[40:43], v110 offset:12288
    ds_read_b128 v[44:47], v110 offset:24576
    ds_read_b128 v[48:51], v2 offset:48128
    ds_read_b128 v[52:55], v109 offset:3072
    ds_read_b128 v[56:59], v109 offset:20480
    ds_read_b128 v[60:63], v109 offset:37888
    s_waitcnt lgkmcnt(14)
    ds_read_b64_tr_b16 v[106:107], v1 offset:512
    v_pk_add_f32 v[92:93], v[92:93], v[8:9]
    v_pk_add_f32 v[94:95], v[94:95], v[10:11]
    s_waitcnt lgkmcnt(14)
    v_pk_add_f32 v[92:93], v[92:93], v[12:13]
    v_pk_add_f32 v[94:95], v[94:95], v[14:15]
    s_waitcnt lgkmcnt(13)
    v_pk_add_f32 v[92:93], v[92:93], v[16:17]
    v_pk_add_f32 v[94:95], v[94:95], v[18:19]
    s_waitcnt lgkmcnt(12)
    v_pk_add_f32 v[92:93], v[92:93], v[20:21]
    v_pk_add_f32 v[94:95], v[94:95], v[22:23]
    s_waitcnt lgkmcnt(11)
    v_pk_add_f32 v[92:93], v[92:93], v[24:25]
    v_pk_add_f32 v[94:95], v[94:95], v[26:27]
    s_waitcnt lgkmcnt(10)
    v_pk_add_f32 v[92:93], v[92:93], v[28:29]
    v_pk_add_f32 v[94:95], v[94:95], v[30:31]
    s_waitcnt lgkmcnt(9)
    v_pk_add_f32 v[92:93], v[92:93], v[32:33]
    v_pk_add_f32 v[94:95], v[94:95], v[34:35]
    s_waitcnt lgkmcnt(8)
    v_lshlrev_b32 v8, 16, v104
    v_and_b32 v9, 0xffff0000, v104
    v_lshlrev_b32 v10, 16, v105
    v_and_b32 v11, 0xffff0000, v105
    v_fma_f32 v92, v92, v6, v8
    v_fma_f32 v93, v93, v6, v9
    v_fma_f32 v94, v94, v6, v10
    v_fma_f32 v95, v95, v6, v11
    v_cvt_pk_bf16_f32 v92, v92, v93
    v_cvt_pk_bf16_f32 v93, v94, v95
    buffer_store_dwordx2 v[92:93], v7, s[52:55], s43 offen offset:0
    s_waitcnt lgkmcnt(7)
    v_pk_add_f32 v[96:97], v[96:97], v[36:37]
    v_pk_add_f32 v[98:99], v[98:99], v[38:39]
    s_waitcnt lgkmcnt(6)
    v_pk_add_f32 v[96:97], v[96:97], v[40:41]
    v_pk_add_f32 v[98:99], v[98:99], v[42:43]
    s_waitcnt lgkmcnt(5)
    v_pk_add_f32 v[96:97], v[96:97], v[44:45]
    v_pk_add_f32 v[98:99], v[98:99], v[46:47]
    s_waitcnt lgkmcnt(4)
    v_pk_add_f32 v[96:97], v[96:97], v[48:49]
    v_pk_add_f32 v[98:99], v[98:99], v[50:51]
    s_waitcnt lgkmcnt(3)
    v_pk_add_f32 v[96:97], v[96:97], v[52:53]
    v_pk_add_f32 v[98:99], v[98:99], v[54:55]
    s_waitcnt lgkmcnt(2)
    v_pk_add_f32 v[96:97], v[96:97], v[56:57]
    v_pk_add_f32 v[98:99], v[98:99], v[58:59]
    s_waitcnt lgkmcnt(1)
    v_pk_add_f32 v[96:97], v[96:97], v[60:61]
    v_pk_add_f32 v[98:99], v[98:99], v[62:63]
    s_waitcnt lgkmcnt(0)
    v_lshlrev_b32 v36, 16, v106
    v_and_b32 v37, 0xffff0000, v106
    v_lshlrev_b32 v38, 16, v107
    v_and_b32 v39, 0xffff0000, v107
    v_fma_f32 v96, v96, v6, v36
    v_fma_f32 v97, v97, v6, v37
    v_fma_f32 v98, v98, v6, v38
    v_fma_f32 v99, v99, v6, v39
    v_cvt_pk_bf16_f32 v96, v96, v97
    v_cvt_pk_bf16_f32 v97, v98, v99
    buffer_store_dwordx2 v[96:97], v7, s[52:55], s43 offen offset:32
    s_endpgm
K2_R2R1:
    s_mov_b32 s35, 0
K2_R2L1:
    buffer_load_dword v6, v5, s[16:19], s42 offen sc1
    s_add_u32 s35, s35, 1
    s_cmp_gt_u32 s35, 4000
    s_waitcnt vmcnt(0)
    s_cbranch_scc1 K2_R2B1
    v_cmp_eq_u32 vcc, -1, v6
    s_nop 1
    s_cbranch_vccnz K2_R2L1
    s_branch K2_R2B1
K2_C7:
    s_waitcnt vmcnt(0)
    ds_write_b32 v1, v5 offset:32
    buffer_load_dwordx4 v[8:11], v2, s[20:23], s40 offen offset:0 sc1
    buffer_load_dwordx4 v[16:19], v2, s[20:23], s40 offen offset:1024 sc1
    buffer_load_dwordx4 v[12:15], v2, s[20:23], s40 offen offset:2048 sc1
    buffer_load_dwordx4 v[20:23], v2, s[20:23], s40 offen offset:3072 sc1
    s_add_u32 s40, s40, 4096
    buffer_load_dwordx4 v[24:27], v2, s[20:23], s40 offen offset:0 sc1
    buffer_load_dwordx4 v[32:35], v2, s[20:23], s40 offen offset:1024 sc1
    buffer_load_dwordx4 v[28:31], v2, s[20:23], s40 offen offset:2048 sc1
    buffer_load_dwordx4 v[36:39], v2, s[20:23], s40 offen offset:3072 sc1
    s_add_u32 s40, s40, 4096
    buffer_load_dwordx4 v[40:43], v2, s[20:23], s40 offen offset:0 sc1
    buffer_load_dwordx4 v[48:51], v2, s[20:23], s40 offen offset:1024 sc1
    buffer_load_dwordx4 v[44:47], v2, s[20:23], s40 offen offset:2048 sc1
    buffer_load_dwordx4 v[52:55], v2, s[20:23], s40 offen offset:3072 sc1
    s_add_u32 s40, s40, 4096
    s_lshl_b32 s34, s56, 2
    s_add_u32 s34, s34, s3
    s_lshl_b32 s42, s34, 6
    v_and_b32 v5, 15, v3
    v_lshlrev_b32 v5, 2, v5
    s_mul_i32 s43, s34, 20480
    s_mul_i32 s35, s57, 160
    s_add_u32 s43, s43, s35
    s_mov_b32 s34, 0
K2_CW7:
    ds_read_b32 v7, v1 offset:0
    s_add_u32 s34, s34, 1
    s_cmp_gt_u32 s34, 256000
    s_cbranch_scc1 K2_CW7_X
    s_waitcnt lgkmcnt(0)
    v_cmp_gt_u32 vcc, 1, v7
    s_nop 1
    s_cbranch_vccnz K2_CW7
K2_CW7_X:
    s_waitcnt lgkmcnt(0)
    ds_read_b128 v[72:75], v108 offset:0
    ds_read_b128 v[76:79], v108 offset:1024
    ds_read_b128 v[80:83], v108 offset:2048
    ds_read_b128 v[84:87], v108 offset:3072
    ds_read_b128 v[88:91], v108 offset:4096
    s_waitcnt vmcnt(8)
    v_max3_u32 v4, v8, v12, v16
    v_max_u32 v4, v4, v20
    v_cmp_eq_u32 vcc, -1, v4
    s_nop 1
    s_cbranch_vccnz K2_HC7_0_R
K2_HC7_0_B:
    s_mov_b32 m0, s39
    s_nop 0
    buffer_load_dwordx4 v2, s[8:11], s38 offen offset:0 sc1 lds
    buffer_load_dwordx4 v2, s[8:11], s38 offen offset:1024 sc1 lds
    s_mov_b64 exec, 0xffffffff
    buffer_load_dwordx4 v2, s[8:11], s38 offen offset:2048 sc1 lds
    s_mov_b64 exec, -1
    v_swap_b32 v10, v12
    v_swap_b32 v11, v13
    v_swap_b32 v18, v20
    v_swap_b32 v19, v21
    s_waitcnt lgkmcnt(4)
    v_mfma_f32_16x16x32_bf16 a[0:3], v[72:75], v[8:11], 0
    buffer_load_dwordx4 v[112:115], v2, s[20:23], s40 offen offset:0 sc1
    v_mfma_f32_16x16x32_bf16 a[20:23], v[72:75], v[12:15], 0
    buffer_load_dwordx4 v[120:123], v2, s[20:23], s40 offen offset:1024 sc1
    v_mfma_f32_16x16x32_bf16 a[40:43], v[72:75], v[16:19], 0
    buffer_load_dwordx4 v[116:119], v2, s[20:23], s40 offen offset:2048 sc1
    v_mfma_f32_16x16x32_bf16 a[60:63], v[72:75], v[20:23], 0
    ds_read_b128 v[72:75], v108 offset:5120
    s_waitcnt lgkmcnt(4)
    v_mfma_f32_16x16x32_bf16 a[4:7], v[76:79], v[8:11], 0
    buffer_load_dwordx4 v[124:127], v2, s[20:23], s40 offen offset:3072 sc1
    s_add_u32 s40, s40, 4096
    v_mfma_f32_16x16x32_bf16 a[24:27], v[76:79], v[12:15], 0
    v_mfma_f32_16x16x32_bf16 a[44:47], v[76:79], v[16:19], 0
    v_mfma_f32_16x16x32_bf16 v[56:59], v[76:79], v[20:23], 0
    ds_read_b128 v[76:79], v108 offset:6144
    s_waitcnt lgkmcnt(4)
    v_mfma_f32_16x16x32_bf16 a[8:11], v[80:83], v[8:11], 0
    v_mfma_f32_16x16x32_bf16 a[28:31], v[80:83], v[12:15], 0
    s_waitcnt vmcnt(11)
    v_max3_u32 v4, v24, v28, v32
    v_mfma_f32_16x16x32_bf16 a[48:51], v[80:83], v[16:19], 0
    v_max_u32 v4, v4, v36
    v_mfma_f32_16x16x32_bf16 v[60:63], v[80:83], v[20:23], 0
    ds_read_b128 v[80:83], v108 offset:7168
    s_waitcnt lgkmcnt(4)
    v_mfma_f32_16x16x32_bf16 a[12:15], v[84:87], v[8:11], 0
    v_cmp_eq_u32 vcc, -1, v4
    s_nop 1
    s_cbranch_vccnz K2_HC7_1_R
K2_HC7_1_B:
    v_mfma_f32_16x16x32_bf16 a[32:35], v[84:87], v[12:15], 0
    v_swap_b32 v26, v28
    v_mfma_f32_16x16x32_bf16 a[52:55], v[84:87], v[16:19], 0
    v_swap_b32 v27, v29
    v_mfma_f32_16x16x32_bf16 v[64:67], v[84:87], v[20:23], 0
    ds_read_b128 v[84:87], v108 offset:8192
    s_waitcnt lgkmcnt(4)
    v_mfma_f32_16x16x32_bf16 a[16:19], v[88:91], v[8:11], 0
    v_swap_b32 v34, v36
    v_mfma_f32_16x16x32_bf16 a[36:39], v[88:91], v[12:15], 0
    v_swap_b32 v35, v37
    v_mfma_f32_16x16x32_bf16 a[56:59], v[88:91], v[16:19], 0
    v_mfma_f32_16x16x32_bf16 v[68:71], v[88:91], v[20:23], 0
    ds_read_b128 v[88:91], v108 offset:9216
    s_waitcnt lgkmcnt(4)
    v_mfma_f32_16x16x32_bf16 a[0:3], v[72:75], v[24:27], a[0:3]
    buffer_load_dwordx4 v[8:11], v2, s[20:23], s40 offen offset:0 sc1
    v_mfma_f32_16x16x32_bf16 a[20:23], v[72:75], v[28:31], a[20:23]
    buffer_load_dwordx4 v[16:19], v2, s[20:23], s40 offen offset:1024 sc1
    v_mfma_f32_16x16x32_bf16 a[40:43], v[72:75], v[32:35], a[40:43]
    buffer_load_dwordx4 v[12:15], v2, s[20:23], s40 offen offset:2048 sc1
    v_mfma_f32_16x16x32_bf16 a[60:63], v[72:75], v[36:39], a[60:63]
    ds_read_b128 v[72:75], v108 offset:10240
    s_waitcnt lgkmcnt(4)
    v_mfma_f32_16x16x32_bf16 a[4:7], v[76:79], v[24:27], a[4:7]
    buffer_load_dwordx4 v[20:23], v2, s[20:23], s40 offen offset:3072 sc1
    s_add_u32 s40, s40, 4096
    v_mfma_f32_16x16x32_bf16 a[24:27], v[76:79], v[28:31], a[24:27]
    v_mfma_f32_16x16x32_bf16 a[44:47], v[76:79], v[32:35], a[44:47]
    v_mfma_f32_16x16x32_bf16 v[56:59], v[76:79], v[36:39], v[56:59]
    ds_read_b128 v[76:79], v108 offset:11264
    s_waitcnt lgkmcnt(4)
    v_mfma_f32_16x16x32_bf16 a[8:11], v[80:83], v[24:27], a[8:11]
    v_mfma_f32_16x16x32_bf16 a[28:31], v[80:83], v[28:31], a[28:31]
    s_waitcnt vmcnt(11)
    v_max3_u32 v4, v40, v44, v48
    v_mfma_f32_16x16x32_bf16 a[48:51], v[80:83], v[32:35], a[48:51]
    v_max_u32 v4, v4, v52
    v_mfma_f32_16x16x32_bf16 v[60:63], v[80:83], v[36:39], v[60:63]
    ds_read_b128 v[80:83], v109 offset:0
    s_waitcnt lgkmcnt(4)
    v_mfma_f32_16x16x32_bf16 a[12:15], v[84:87], v[24:27], a[12:15]
    v_cmp_eq_u32 vcc, -1, v4
    s_nop 1
    s_cbranch_vccnz K2_HC7_2_R
K2_HC7_2_B:
    v_mfma_f32_16x16x32_bf16 a[32:35], v[84:87], v[28:31], a[32:35]
    v_swap_b32 v42, v44
    v_mfma_f32_16x16x32_bf16 a[52:55], v[84:87], v[32:35], a[52:55]
    v_swap_b32 v43, v45
    v_mfma_f32_16x16x32_bf16 v[64:67], v[84:87], v[36:39], v[64:67]
    ds_read_b128 v[84:87], v109 offset:1024
    s_waitcnt lgkmcnt(4)
    v_mfma_f32_16x16x32_bf16 a[16:19], v[88:91], v[24:27], a[16:19]
    v_swap_b32 v50, v52
    v_mfma_f32_16x16x32_bf16 a[36:39], v[88:91], v[28:31], a[36:39]
    v_swap_b32 v51, v53
    v_mfma_f32_16x16x32_bf16 a[56:59], v[88:91], v[32:35], a[56:59]
    v_mfma_f32_16x16x32_bf16 v[68:71], v[88:91], v[36:39], v[68:71]
    ds_read_b128 v[88:91], v109 offset:2048
    s_waitcnt lgkmcnt(4)
    v_mfma_f32_16x16x32_bf16 a[0:3], v[72:75], v[40:43], a[0:3]
    buffer_load_dwordx4 v[24:27], v2, s[20:23], s40 offen offset:0 sc1
    v_mfma_f32_16x16x32_bf16 a[20:23], v[72:75], v[44:47], a[20:23]
    buffer_load_dwordx4 v[32:35], v2, s[20:23], s40 offen offset:1024 sc1
    v_mfma_f32_16x16x32_bf16 a[40:43], v[72:75], v[48:51], a[40:43]
    buffer_load_dwordx4 v[28:31], v2, s[20:23], s40 offen offset:2048 sc1
    v_mfma_f32_16x16x32_bf16 a[60:63], v[72:75], v[52:55], a[60:63]
    ds_read_b128 v[72:75], v109 offset:3072
    s_waitcnt lgkmcnt(4)
    v_mfma_f32_16x16x32_bf16 a[4:7], v[76:79], v[40:43], a[4:7]
    buffer_load_dwordx4 v[36:39], v2, s[20:23], s40 offen offset:3072 sc1
    s_add_u32 s40, s40, 4096
    v_mfma_f32_16x16x32_bf16 a[24:27], v[76:79], v[44:47], a[24:27]
    v_mfma_f32_16x16x32_bf16 a[44:47], v[76:79], v[48:51], a[44:47]
    v_mfma_f32_16x16x32_bf16 v[56:59], v[76:79], v[52:55], v[56:59]
    ds_read_b128 v[76:79], v109 offset:4096
    s_waitcnt lgkmcnt(4)
    v_mfma_f32_16x16x32_bf16 a[8:11], v[80:83], v[40:43], a[8:11]
    v_mfma_f32_16x16x32_bf16 a[28:31], v[80:83], v[44:47], a[28:31]
    s_waitcnt vmcnt(8)
    v_max3_u32 v4, v112, v116, v120
    v_mfma_f32_16x16x32_bf16 a[48:51], v[80:83], v[48:51], a[48:51]
    v_max_u32 v4, v4, v124
    v_mfma_f32_16x16x32_bf16 v[60:63], v[80:83], v[52:55], v[60:63]
    ds_read_b128 v[80:83], v110 offset:0
    s_waitcnt lgkmcnt(4)
    v_mfma_f32_16x16x32_bf16 a[12:15], v[84:87], v[40:43], a[12:15]
    v_cmp_eq_u32 vcc, -1, v4
    s_nop 1
    s_cbranch_vccnz K2_HC7_3_R
K2_HC7_3_B:
    v_mfma_f32_16x16x32_bf16 a[32:35], v[84:87], v[44:47], a[32:35]
    v_swap_b32 v114, v116
    v_mfma_f32_16x16x32_bf16 a[52:55], v[84:87], v[48:51], a[52:55]
    v_swap_b32 v115, v117
    v_mfma_f32_16x16x32_bf16 v[64:67], v[84:87], v[52:55], v[64:67]
    ds_read_b128 v[84:87], v110 offset:1024
    s_waitcnt lgkmcnt(4)
    v_mfma_f32_16x16x32_bf16 a[16:19], v[88:91], v[40:43], a[16:19]
    v_swap_b32 v122, v124
    v_mfma_f32_16x16x32_bf16 a[36:39], v[88:91], v[44:47], a[36:39]
    v_swap_b32 v123, v125
    v_mfma_f32_16x16x32_bf16 a[56:59], v[88:91], v[48:51], a[56:59]
    v_mfma_f32_16x16x32_bf16 v[68:71], v[88:91], v[52:55], v[68:71]
    ds_read_b128 v[88:91], v110 offset:2048
    s_waitcnt lgkmcnt(4)
    v_mfma_f32_16x16x32_bf16 a[0:3], v[72:75], v[112:115], a[0:3]
    buffer_load_dwordx4 v[40:43], v2, s[20:23], s40 offen offset:0 sc1
    v_mfma_f32_16x16x32_bf16 a[20:23], v[72:75], v[116:119], a[20:23]
    buffer_load_dwordx4 v[48:51], v2, s[20:23], s40 offen offset:1024 sc1
    v_mfma_f32_16x16x32_bf16 a[40:43], v[72:75], v[120:123], a[40:43]
    buffer_load_dwordx4 v[44:47], v2, s[20:23], s40 offen offset:2048 sc1
    v_mfma_f32_16x16x32_bf16 a[60:63], v[72:75], v[124:127], a[60:63]
    buffer_load_dwordx4 v[52:55], v2, s[20:23], s40 offen offset:3072 sc1
    s_add_u32 s40, s40, 4096
    s_waitcnt lgkmcnt(3)
    v_mfma_f32_16x16x32_bf16 a[4:7], v[76:79], v[112:115], a[4:7]
    buffer_load_dword v6, v5, s[16:19], s42 offen sc1
    v_mfma_f32_16x16x32_bf16 a[24:27], v[76:79], v[116:119], a[24:27]
    v_mfma_f32_16x16x32_bf16 a[44:47], v[76:79], v[120:123], a[44:47]
    v_mfma_f32_16x16x32_bf16 v[56:59], v[76:79], v[124:127], v[56:59]
    s_waitcnt lgkmcnt(2)
    v_mfma_f32_16x16x32_bf16 a[8:11], v[80:83], v[112:115], a[8:11]
    v_mfma_f32_16x16x32_bf16 a[28:31], v[80:83], v[116:119], a[28:31]
    s_waitcnt vmcnt(9)
    v_max3_u32 v4, v8, v12, v16
    v_mfma_f32_16x16x32_bf16 a[48:51], v[80:83], v[120:123], a[48:51]
    v_max_u32 v4, v4, v20
    v_mfma_f32_16x16x32_bf16 v[60:63], v[80:83], v[124:127], v[60:63]
    v_cmp_eq_u32 vcc, -1, v4
    s_nop 1
    s_cbranch_vccnz K2_HC7_4_R
K2_HC7_4_B:
    s_waitcnt lgkmcnt(1)
    v_mfma_f32_16x16x32_bf16 a[12:15], v[84:87], v[112:115], a[12:15]
    v_swap_b32 v10, v12
    v_mfma_f32_16x16x32_bf16 a[32:35], v[84:87], v[116:119], a[32:35]
    v_swap_b32 v11, v13
    v_mfma_f32_16x16x32_bf16 a[52:55], v[84:87], v[120:123], a[52:55]
    v_swap_b32 v18, v20
    v_mfma_f32_16x16x32_bf16 v[64:67], v[84:87], v[124:127], v[64:67]
    v_swap_b32 v19, v21
    s_waitcnt lgkmcnt(0)
    v_mfma_f32_16x16x32_bf16 a[16:19], v[88:91], v[112:115], a[16:19]
    v_mfma_f32_16x16x32_bf16 a[36:39], v[88:91], v[116:119], a[36:39]
    v_mfma_f32_16x16x32_bf16 a[56:59], v[88:91], v[120:123], a[56:59]
    v_mfma_f32_16x16x32_bf16 v[68:71], v[88:91], v[124:127], v[68:71]
    v_mfma_f32_16x16x32_bf16 a[0:3], a[64:67], v[8:11], a[0:3]
    v_add_u32 v109, 0x10000, v2
    v_mfma_f32_16x16x32_bf16 a[20:23], a[64:67], v[12:15], a[20:23]
    v_add_u32 v110, 0x20000, v2
    v_mfma_f32_16x16x32_bf16 a[40:43], a[64:67], v[16:19], a[40:43]
    v_mfma_f32_16x16x32_bf16 a[60:63], a[64:67], v[20:23], a[60:63]
    v_mfma_f32_16x16x32_bf16 a[4:7], a[68:71], v[8:11], a[4:7]
    s_waitcnt vmcnt(5)
    v_max3_u32 v4, v24, v28, v32
    v_mfma_f32_16x16x32_bf16 a[24:27], a[68:71], v[12:15], a[24:27]
    v_max_u32 v4, v4, v36
    v_mfma_f32_16x16x32_bf16 a[44:47], a[68:71], v[16:19], a[44:47]
    v_cmp_eq_u32 vcc, -1, v4
    s_nop 1
    s_cbranch_vccnz K2_HC7_5_R
K2_HC7_5_B:
    v_mfma_f32_16x16x32_bf16 v[56:59], a[68:71], v[20:23], v[56:59]
    v_swap_b32 v26, v28
    v_mfma_f32_16x16x32_bf16 a[8:11], a[72:75], v[8:11], a[8:11]
    v_swap_b32 v27, v29
    v_mfma_f32_16x16x32_bf16 a[28:31], a[72:75], v[12:15], a[28:31]
    v_swap_b32 v34, v36
    v_mfma_f32_16x16x32_bf16 a[48:51], a[72:75], v[16:19], a[48:51]
    v_swap_b32 v35, v37
    v_mfma_f32_16x16x32_bf16 v[60:63], a[72:75], v[20:23], v[60:63]
    v_mfma_f32_16x16x32_bf16 a[12:15], a[76:79], v[8:11], a[12:15]
    s_waitcnt vmcnt(1)
    v_max3_u32 v4, v40, v44, v48
    v_mfma_f32_16x16x32_bf16 a[32:35], a[76:79], v[12:15], a[32:35]
    v_max_u32 v4, v4, v52
    v_mfma_f32_16x16x32_bf16 a[52:55], a[76:79], v[16:19], a[52:55]
    v_cmp_eq_u32 vcc, -1, v4
    s_nop 1
    s_cbranch_vccnz K2_HC7_6_R
K2_HC7_6_B:
    v_mfma_f32_16x16x32_bf16 v[64:67], a[76:79], v[20:23], v[64:67]
    v_swap_b32 v42, v44
    v_mfma_f32_16x16x32_bf16 a[16:19], a[80:83], v[8:11], a[16:19]
    v_swap_b32 v43, v45
    v_mfma_f32_16x16x32_bf16 a[36:39], a[80:83], v[12:15], a[36:39]
    v_swap_b32 v50, v52
    v_mfma_f32_16x16x32_bf16 a[56:59], a[80:83], v[16:19], a[56:59]
    v_swap_b32 v51, v53
    v_mfma_f32_16x16x32_bf16 v[68:71], a[80:83], v[20:23], v[68:71]
    s_cmp_lg_u32 s3, 2
    s_cbranch_scc1 K2_CF3
    s_setprio 3
    v_mfma_f32_16x16x32_bf16 a[8:11], a[92:95], v[24:27], a[8:11]
    v_mfma_f32_16x16x32_bf16 a[28:31], a[92:95], v[28:31], a[28:31]
    v_mfma_f32_16x16x32_bf16 a[48:51], a[92:95], v[32:35], a[48:51]
    v_mfma_f32_16x16x32_bf16 v[60:63], a[92:95], v[36:39], v[60:63]
    v_mfma_f32_16x16x32_bf16 a[8:11], a[112:115], v[40:43], a[8:11]
    v_mfma_f32_16x16x32_bf16 a[28:31], a[112:115], v[44:47], a[28:31]
    v_mfma_f32_16x16x32_bf16 a[48:51], a[112:115], v[48:51], a[48:51]
    v_mfma_f32_16x16x32_bf16 v[60:63], a[112:115], v[52:55], v[60:63]
    v_mfma_f32_16x16x32_bf16 a[12:15], a[96:99], v[24:27], a[12:15]
    v_mfma_f32_16x16x32_bf16 a[32:35], a[96:99], v[28:31], a[32:35]
    v_mfma_f32_16x16x32_bf16 a[52:55], a[96:99], v[32:35], a[52:55]
    v_mfma_f32_16x16x32_bf16 v[64:67], a[96:99], v[36:39], v[64:67]
    v_mfma_f32_16x16x32_bf16 a[12:15], a[116:119], v[40:43], a[12:15]
    ds_write_b128 v110, a[8:11] offset:8192
    v_mfma_f32_16x16x32_bf16 a[32:35], a[116:119], v[44:47], a[32:35]
    ds_write_b128 v110, a[28:31] offset:13312
    v_mfma_f32_16x16x32_bf16 a[52:55], a[116:119], v[48:51], a[52:55]
    ds_write_b128 v110, a[48:51] offset:16384
    v_mfma_f32_16x16x32_bf16 v[64:67], a[116:119], v[52:55], v[64:67]
    ds_write_b128 v2, v[60:63] offset:13312
    v_mfma_f32_16x16x32_bf16 a[16:19], a[100:103], v[24:27], a[16:19]
    v_mfma_f32_16x16x32_bf16 a[36:39], a[100:103], v[28:31], a[36:39]
    v_mfma_f32_16x16x32_bf16 a[56:59], a[100:103], v[32:35], a[56:59]
    v_mfma_f32_16x16x32_bf16 v[68:71], a[100:103], v[36:39], v[68:71]
    v_mfma_f32_16x16x32_bf16 a[16:19], a[120:123], v[40:43], a[16:19]
    ds_write_b128 v110, a[12:15] offset:9216
    v_mfma_f32_16x16x32_bf16 a[36:39], a[120:123], v[44:47], a[36:39]
    ds_write_b128 v110, a[32:35] offset:14336
    v_mfma_f32_16x16x32_bf16 a[56:59], a[120:123], v[48:51], a[56:59]
    ds_write_b128 v110, a[52:55] offset:17408
    v_mfma_f32_16x16x32_bf16 v[68:71], a[120:123], v[52:55], v[68:71]
    ds_write_b128 v2, v[64:67] offset:14336
    v_mfma_f32_16x16x32_bf16 a[0:3], a[84:87], v[24:27], a[0:3]
    v_mfma_f32_16x16x32_bf16 a[20:23], a[84:87], v[28:31], a[20:23]
    v_mfma_f32_16x16x32_bf16 a[60:63], a[84:87], v[36:39], a[60:63]
    v_mfma_f32_16x16x32_bf16 a[40:43], a[84:87], v[32:35], a[40:43]
    v_mfma_f32_16x16x32_bf16 a[0:3], a[104:107], v[40:43], a[0:3]
    ds_write_b128 v110, a[16:19] offset:10240
    v_mfma_f32_16x16x32_bf16 a[20:23], a[104:107], v[44:47], a[20:23]
    ds_write_b128 v110, a[36:39] offset:15360
    v_mfma_f32_16x16x32_bf16 a[60:63], a[104:107], v[52:55], a[60:63]
    ds_write_b128 v2, a[56:59] offset:10240
    v_mfma_f32_16x16x32_bf16 a[40:43], a[104:107], v[48:51], a[40:43]
    ds_write_b128 v2, v[68:71] offset:28672
    v_mfma_f32_16x16x32_bf16 a[4:7], a[88:91], v[24:27], a[4:7]
    v_mfma_f32_16x16x32_bf16 a[24:27], a[88:91], v[28:31], a[24:27]
    v_mfma_f32_16x16x32_bf16 v[56:59], a[88:91], v[36:39], v[56:59]
    v_mfma_f32_16x16x32_bf16 a[44:47], a[88:91], v[32:35], a[44:47]
    v_mfma_f32_16x16x32_bf16 a[4:7], a[108:111], v[40:43], a[4:7]
    ds_write_b128 v110, a[0:3] offset:6144
    v_mfma_f32_16x16x32_bf16 a[24:27], a[108:111], v[44:47], a[24:27]
    ds_write_b128 v110, a[20:23] offset:11264
    v_mfma_f32_16x16x32_bf16 v[56:59], a[108:111], v[52:55], v[56:59]
    ds_write_b128 v2, a[60:63] offset:11264
    v_mfma_f32_16x16x32_bf16 a[44:47], a[108:111], v[48:51], a[44:47]
    v_lshlrev_b32 v1, 3, v3
    v_add_u32 v1, 39936, v1
    v_and_b32 v7, 15, v3
    v_mul_u32_u24 v7, 1280, v7
    v_lshrrev_b32 v4, 4, v3
    v_lshl_add_u32 v7, v4, 3, v7
    ds_write_b128 v110, a[4:7] offset:7168
    ds_write_b128 v110, a[24:27] offset:12288
    ds_write_b128 v2, v[56:59] offset:12288
    v_accvgpr_read_b32 v92, a40
    v_accvgpr_read_b32 v93, a41
    v_accvgpr_read_b32 v94, a42
    v_accvgpr_read_b32 v95, a43
    v_accvgpr_read_b32 v96, a44
    v_accvgpr_read_b32 v97, a45
    v_accvgpr_read_b32 v98, a46
    v_accvgpr_read_b32 v99, a47
    s_waitcnt vmcnt(0)
    v_cmp_eq_u32 vcc, -1, v6
    s_nop 1
    s_cbranch_vccnz K2_R2R2
K2_R2B2:
    s_waitcnt lgkmcnt(0)
    s_barrier
    ds_read_b128 v[8:11], v109 offset:55296
    ds_read_b128 v[12:15], v110 offset:2048
    ds_read_b128 v[16:19], v110 offset:28672
    ds_read_b128 v[20:23], v2 offset:52224
    ds_read_b128 v[24:27], v109 offset:4096
    ds_read_b128 v[28:31], v109 offset:24576
    ds_read_b128 v[32:35], v109 offset:41984
    ds_read_b64_tr_b16 v[104:105], v1 offset:0
    ds_read_b128 v[36:39], v109 offset:56320
    ds_read_b128 v[40:43], v110 offset:3072
    ds_read_b128 v[44:47], v110 offset:29696
    ds_read_b128 v[48:51], v2 offset:53248
    ds_read_b128 v[52:55], v109 offset:5120
    ds_read_b128 v[56:59], v109 offset:25600
    ds_read_b128 v[60:63], v109 offset:43008
    s_waitcnt lgkmcnt(14)
    ds_read_b64_tr_b16 v[106:107], v1 offset:512
    v_pk_add_f32 v[92:93], v[92:93], v[8:9]
    v_pk_add_f32 v[94:95], v[94:95], v[10:11]
    s_waitcnt lgkmcnt(14)
    v_pk_add_f32 v[92:93], v[92:93], v[12:13]
    v_pk_add_f32 v[94:95], v[94:95], v[14:15]
    s_waitcnt lgkmcnt(13)
    v_pk_add_f32 v[92:93], v[92:93], v[16:17]
    v_pk_add_f32 v[94:95], v[94:95], v[18:19]
    s_waitcnt lgkmcnt(12)
    v_pk_add_f32 v[92:93], v[92:93], v[20:21]
    v_pk_add_f32 v[94:95], v[94:95], v[22:23]
    s_waitcnt lgkmcnt(11)
    v_pk_add_f32 v[92:93], v[92:93], v[24:25]
    v_pk_add_f32 v[94:95], v[94:95], v[26:27]
    s_waitcnt lgkmcnt(10)
    v_pk_add_f32 v[92:93], v[92:93], v[28:29]
    v_pk_add_f32 v[94:95], v[94:95], v[30:31]
    s_waitcnt lgkmcnt(9)
    v_pk_add_f32 v[92:93], v[92:93], v[32:33]
    v_pk_add_f32 v[94:95], v[94:95], v[34:35]
    s_waitcnt lgkmcnt(8)
    v_lshlrev_b32 v8, 16, v104
    v_and_b32 v9, 0xffff0000, v104
    v_lshlrev_b32 v10, 16, v105
    v_and_b32 v11, 0xffff0000, v105
    v_fma_f32 v92, v92, v6, v8
    v_fma_f32 v93, v93, v6, v9
    v_fma_f32 v94, v94, v6, v10
    v_fma_f32 v95, v95, v6, v11
    v_cvt_pk_bf16_f32 v92, v92, v93
    v_cvt_pk_bf16_f32 v93, v94, v95
    buffer_store_dwordx2 v[92:93], v7, s[52:55], s43 offen offset:0
    s_waitcnt lgkmcnt(7)
    v_pk_add_f32 v[96:97], v[96:97], v[36:37]
    v_pk_add_f32 v[98:99], v[98:99], v[38:39]
    s_waitcnt lgkmcnt(6)
    v_pk_add_f32 v[96:97], v[96:97], v[40:41]
    v_pk_add_f32 v[98:99], v[98:99], v[42:43]
    s_waitcnt lgkmcnt(5)
    v_pk_add_f32 v[96:97], v[96:97], v[44:45]
    v_pk_add_f32 v[98:99], v[98:99], v[46:47]
    s_waitcnt lgkmcnt(4)
    v_pk_add_f32 v[96:97], v[96:97], v[48:49]
    v_pk_add_f32 v[98:99], v[98:99], v[50:51]
    s_waitcnt lgkmcnt(3)
    v_pk_add_f32 v[96:97], v[96:97], v[52:53]
    v_pk_add_f32 v[98:99], v[98:99], v[54:55]
    s_waitcnt lgkmcnt(2)
    v_pk_add_f32 v[96:97], v[96:97], v[56:57]
    v_pk_add_f32 v[98:99], v[98:99], v[58:59]
    s_waitcnt lgkmcnt(1)
    v_pk_add_f32 v[96:97], v[96:97], v[60:61]
    v_pk_add_f32 v[98:99], v[98:99], v[62:63]
    s_waitcnt lgkmcnt(0)
    v_lshlrev_b32 v36, 16, v106
    v_and_b32 v37, 0xffff0000, v106
    v_lshlrev_b32 v38, 16, v107
    v_and_b32 v39, 0xffff0000, v107
    v_fma_f32 v96, v96, v6, v36
    v_fma_f32 v97, v97, v6, v37
    v_fma_f32 v98, v98, v6, v38
    v_fma_f32 v99, v99, v6, v39
    v_cvt_pk_bf16_f32 v96, v96, v97
    v_cvt_pk_bf16_f32 v97, v98, v99
    buffer_store_dwordx2 v[96:97], v7, s[52:55], s43 offen offset:32
    s_endpgm
K2_HC7_0_R:
    s_mov_b32 s35, 0
K2_HC7_0_L:
    s_sub_u32 s34, s40, 12288
    buffer_load_dwordx4 v[8:11], v2, s[20:23], s34 offen offset:0 sc1
    buffer_load_dwordx4 v[16:19], v2, s[20:23], s34 offen offset:1024 sc1
    buffer_load_dwordx4 v[12:15], v2, s[20:23], s34 offen offset:2048 sc1
    buffer_load_dwordx4 v[20:23], v2, s[20:23], s34 offen offset:3072 sc1
    s_sub_u32 s34, s40, 8192
    buffer_load_dwordx4 v[24:27], v2, s[20:23], s34 offen offset:0 sc1
    buffer_load_dwordx4 v[32:35], v2, s[20:23], s34 offen offset:1024 sc1
    buffer_load_dwordx4 v[28:31], v2, s[20:23], s34 offen offset:2048 sc1
    buffer_load_dwordx4 v[36:39], v2, s[20:23], s34 offen offset:3072 sc1
    s_sub_u32 s34, s40, 4096
    buffer_load_dwordx4 v[40:43], v2, s[20:23], s34 offen offset:0 sc1
    buffer_load_dwordx4 v[48:51], v2, s[20:23], s34 offen offset:1024 sc1
    buffer_load_dwordx4 v[44:47], v2, s[20:23], s34 offen offset:2048 sc1
    buffer_load_dwordx4 v[52:55], v2, s[20:23], s34 offen offset:3072 sc1
    s_add_u32 s35, s35, 1
    s_cmp_gt_u32 s35, 4000
    s_waitcnt vmcnt(8)
    s_cbranch_scc1 K2_HC7_0_B
    v_max3_u32 v4, v8, v12, v16
    v_max_u32 v4, v4, v20
    v_cmp_eq_u32 vcc, -1, v4
    s_nop 1
    s_cbranch_vccnz K2_HC7_0_L
    s_branch K2_HC7_0_B
K2_HC7_1_R:
    s_mov_b32 s35, 0
K2_HC7_1_L:
    s_sub_u32 s34, s40, 12288
    buffer_load_dwordx4 v[24:27], v2, s[20:23], s34 offen offset:0 sc1
    buffer_load_dwordx4 v[32:35], v2, s[20:23], s34 offen offset:1024 sc1
    buffer_load_dwordx4 v[28:31], v2, s[20:23], s34 offen offset:2048 sc1
    buffer_load_dwordx4 v[36:39], v2, s[20:23], s34 offen offset:3072 sc1
    s_add_u32 s35, s35, 1
    s_cmp_gt_u32 s35, 4000
    s_waitcnt vmcnt(0)
    s_cbranch_scc1 K2_HC7_1_B
    v_max3_u32 v4, v24, v28, v32
    v_max_u32 v4, v4, v36
    v_cmp_eq_u32 vcc, -1, v4
    s_nop 1
    s_cbranch_vccnz K2_HC7_1_L
    s_branch K2_HC7_1_B
K2_HC7_2_R:
    s_mov_b32 s35, 0
K2_HC7_2_L:
    s_sub_u32 s34, s40, 12288
    buffer_load_dwordx4 v[40:43], v2, s[20:23], s34 offen offset:0 sc1
    buffer_load_dwordx4 v[48:51], v2, s[20:23], s34 offen offset:1024 sc1
    buffer_load_dwordx4 v[44:47], v2, s[20:23], s34 offen offset:2048 sc1
    buffer_load_dwordx4 v[52:55], v2, s[20:23], s34 offen offset:3072 sc1
    s_add_u32 s35, s35, 1
    s_cmp_gt_u32 s35, 4000
    s_waitcnt vmcnt(0)
    s_cbranch_scc1 K2_HC7_2_B
    v_max3_u32 v4, v40, v44, v48
    v_max_u32 v4, v4, v52
    v_cmp_eq_u32 vcc, -1, v4
    s_nop 1
    s_cbranch_vccnz K2_HC7_2_L
    s_branch K2_HC7_2_B
K2_HC7_3_R:
    s_mov_b32 s35, 0
K2_HC7_3_L:
    s_sub_u32 s34, s40, 12288
    buffer_load_dwordx4 v[112:115], v2, s[20:23], s34 offen offset:0 sc1
    buffer_load_dwordx4 v[120:123], v2, s[20:23], s34 offen offset:1024 sc1
    buffer_load_dwordx4 v[116:119], v2, s[20:23], s34 offen offset:2048 sc1
    buffer_load_dwordx4 v[124:127], v2, s[20:23], s34 offen offset:3072 sc1
    s_add_u32 s35, s35, 1
    s_cmp_gt_u32 s35, 4000
    s_waitcnt vmcnt(0)
    s_cbranch_scc1 K2_HC7_3_B
    v_max3_u32 v4, v112, v116, v120
    v_max_u32 v4, v4, v124
    v_cmp_eq_u32 vcc, -1, v4
    s_nop 1
    s_cbranch_vccnz K2_HC7_3_L
    s_branch K2_HC7_3_B
K2_HC7_4_R:
    s_mov_b32 s35, 0
K2_HC7_4_L:
    s_sub_u32 s34, s40, 12288
    buffer_load_dwordx4 v[8:11], v2, s[20:23], s34 offen offset:0 sc1
    buffer_load_dwordx4 v[16:19], v2, s[20:23], s34 offen offset:1024 sc1
    buffer_load_dwordx4 v[12:15], v2, s[20:23], s34 offen offset:2048 sc1
    buffer_load_dwordx4 v[20:23], v2, s[20:23], s34 offen offset:3072 sc1
    s_add_u32 s35, s35, 1
    s_cmp_gt_u32 s35, 4000
    s_waitcnt vmcnt(0)
    s_cbranch_scc1 K2_HC7_4_B
    v_max3_u32 v4, v8, v12, v16
    v_max_u32 v4, v4, v20
    v_cmp_eq_u32 vcc, -1, v4
    s_nop 1
    s_cbranch_vccnz K2_HC7_4_L
    s_branch K2_HC7_4_B
K2_HC7_5_R:
    s_mov_b32 s35, 0
K2_HC7_5_L:
    s_sub_u32 s34, s40, 8192
    buffer_load_dwordx4 v[24:27], v2, s[20:23], s34 offen offset:0 sc1
    buffer_load_dwordx4 v[32:35], v2, s[20:23], s34 offen offset:1024 sc1
    buffer_load_dwordx4 v[28:31], v2, s[20:23], s34 offen offset:2048 sc1
    buffer_load_dwordx4 v[36:39], v2, s[20:23], s34 offen offset:3072 sc1
    s_add_u32 s35, s35, 1
    s_cmp_gt_u32 s35, 4000
    s_waitcnt vmcnt(0)
    s_cbranch_scc1 K2_HC7_5_B
    v_max3_u32 v4, v24, v28, v32
    v_max_u32 v4, v4, v36
    v_cmp_eq_u32 vcc, -1, v4
    s_nop 1
    s_cbranch_vccnz K2_HC7_5_L
    s_branch K2_HC7_5_B
K2_HC7_6_R:
    s_mov_b32 s35, 0
K2_HC7_6_L:
    s_sub_u32 s34, s40, 4096
    buffer_load_dwordx4 v[40:43], v2, s[20:23], s34 offen offset:0 sc1
    buffer_load_dwordx4 v[48:51], v2, s[20:23], s34 offen offset:1024 sc1
    buffer_load_dwordx4 v[44:47], v2, s[20:23], s34 offen offset:2048 sc1
    buffer_load_dwordx4 v[52:55], v2, s[20:23], s34 offen offset:3072 sc1
    s_add_u32 s35, s35, 1
    s_cmp_gt_u32 s35, 4000
    s_waitcnt vmcnt(0)
    s_cbranch_scc1 K2_HC7_6_B
    v_max3_u32 v4, v40, v44, v48
    v_max_u32 v4, v4, v52
    v_cmp_eq_u32 vcc, -1, v4
    s_nop 1
    s_cbranch_vccnz K2_HC7_6_L
    s_branch K2_HC7_6_B
K2_R2R2:
    s_mov_b32 s35, 0
K2_R2L2:
    buffer_load_dword v6, v5, s[16:19], s42 offen sc1
    s_add_u32 s35, s35, 1
    s_cmp_gt_u32 s35, 4000
    s_waitcnt vmcnt(0)
    s_cbranch_scc1 K2_R2B2
    v_cmp_eq_u32 vcc, -1, v6
    s_nop 1
    s_cbranch_vccnz K2_R2L2
    s_branch K2_R2B2
K2_CF3:
    s_setprio 3
    v_mfma_f32_16x16x32_bf16 a[8:11], a[92:95], v[24:27], a[8:11]
    v_mfma_f32_16x16x32_bf16 a[28:31], a[92:95], v[28:31], a[28:31]
    v_mfma_f32_16x16x32_bf16 a[48:51], a[92:95], v[32:35], a[48:51]
    v_mfma_f32_16x16x32_bf16 v[60:63], a[92:95], v[36:39], v[60:63]
    v_mfma_f32_16x16x32_bf16 a[8:11], a[112:115], v[40:43], a[8:11]
    v_mfma_f32_16x16x32_bf16 a[28:31], a[112:115], v[44:47], a[28:31]
    v_mfma_f32_16x16x32_bf16 a[48:51], a[112:115], v[48:51], a[48:51]
    v_mfma_f32_16x16x32_bf16 v[60:63], a[112:115], v[52:55], v[60:63]
    v_mfma_f32_16x16x32_bf16 a[12:15], a[96:99], v[24:27], a[12:15]
    v_mfma_f32_16x16x32_bf16 a[32:35], a[96:99], v[28:31], a[32:35]
    v_mfma_f32_16x16x32_bf16 a[52:55], a[96:99], v[32:35], a[52:55]
    v_mfma_f32_16x16x32_bf16 v[64:67], a[96:99], v[36:39], v[64:67]
    v_mfma_f32_16x16x32_bf16 a[12:15], a[116:119], v[40:43], a[12:15]
    ds_write_b128 v110, a[8:11] offset:20480
    v_mfma_f32_16x16x32_bf16 a[32:35], a[116:119], v[44:47], a[32:35]
    ds_write_b128 v110, a[28:31] offset:25600
    v_mfma_f32_16x16x32_bf16 a[52:55], a[116:119], v[48:51], a[52:55]
    ds_write_b128 v2, a[48:51] offset:15360
    v_mfma_f32_16x16x32_bf16 v[64:67], a[116:119], v[52:55], v[64:67]
    ds_write_b128 v2, v[60:63] offset:18432
    v_mfma_f32_16x16x32_bf16 a[16:19], a[100:103], v[24:27], a[16:19]
    v_mfma_f32_16x16x32_bf16 a[36:39], a[100:103], v[28:31], a[36:39]
    v_mfma_f32_16x16x32_bf16 a[56:59], a[100:103], v[32:35], a[56:59]
    v_mfma_f32_16x16x32_bf16 v[68:71], a[100:103], v[36:39], v[68:71]
    v_mfma_f32_16x16x32_bf16 a[16:19], a[120:123], v[40:43], a[16:19]
    ds_write_b128 v110, a[12:15] offset:21504
    v_mfma_f32_16x16x32_bf16 a[36:39], a[120:123], v[44:47], a[36:39]
    ds_write_b128 v110, a[32:35] offset:26624
    v_mfma_f32_16x16x32_bf16 a[56:59], a[120:123], v[48:51], a[56:59]
    ds_write_b128 v2, a[52:55] offset:16384
    v_mfma_f32_16x16x32_bf16 v[68:71], a[120:123], v[52:55], v[68:71]
    ds_write_b128 v2, v[64:67] offset:19456
    v_mfma_f32_16x16x32_bf16 a[0:3], a[84:87], v[24:27], a[0:3]
    v_mfma_f32_16x16x32_bf16 a[20:23], a[84:87], v[28:31], a[20:23]
    v_mfma_f32_16x16x32_bf16 a[40:43], a[84:87], v[32:35], a[40:43]
    v_mfma_f32_16x16x32_bf16 a[60:63], a[84:87], v[36:39], a[60:63]
    v_mfma_f32_16x16x32_bf16 a[0:3], a[104:107], v[40:43], a[0:3]
    ds_write_b128 v110, a[16:19] offset:22528
    v_mfma_f32_16x16x32_bf16 a[20:23], a[104:107], v[44:47], a[20:23]
    ds_write_b128 v110, a[36:39] offset:27648
    v_mfma_f32_16x16x32_bf16 a[40:43], a[104:107], v[48:51], a[40:43]
    ds_write_b128 v2, a[56:59] offset:17408
    v_mfma_f32_16x16x32_bf16 a[60:63], a[104:107], v[52:55], a[60:63]
    ds_write_b128 v2, v[68:71] offset:31744
    v_mfma_f32_16x16x32_bf16 a[4:7], a[88:91], v[24:27], a[4:7]
    v_mfma_f32_16x16x32_bf16 a[24:27], a[88:91], v[28:31], a[24:27]
    v_mfma_f32_16x16x32_bf16 a[44:47], a[88:91], v[32:35], a[44:47]
    v_mfma_f32_16x16x32_bf16 v[56:59], a[88:91], v[36:39], v[56:59]
    v_mfma_f32_16x16x32_bf16 a[4:7], a[108:111], v[40:43], a[4:7]
    ds_write_b128 v110, a[0:3] offset:18432
    v_mfma_f32_16x16x32_bf16 a[24:27], a[108:111], v[44:47], a[24:27]
    ds_write_b128 v110, a[20:23] offset:23552
    v_mfma_f32_16x16x32_bf16 a[44:47], a[108:111], v[48:51], a[44:47]
    ds_write_b128 v110, a[40:43] offset:28672
    v_mfma_f32_16x16x32_bf16 v[56:59], a[108:111], v[52:55], v[56:59]
    v_lshlrev_b32 v1, 3, v3
    v_add_u32 v1, 42496, v1
    v_and_b32 v7, 15, v3
    v_mul_u32_u24 v7, 1280, v7
    v_lshrrev_b32 v4, 4, v3
    v_lshl_add_u32 v7, v4, 3, v7
    ds_write_b128 v110, a[4:7] offset:19456
    ds_write_b128 v110, a[24:27] offset:24576
    ds_write_b128 v110, a[44:47] offset:29696
    v_accvgpr_read_b32 v92, a60
    v_accvgpr_read_b32 v93, a61
    v_accvgpr_read_b32 v94, a62
    v_accvgpr_read_b32 v95, a63
    v_mov_b32 v96, v56
    v_mov_b32 v97, v57
    v_mov_b32 v98, v58
    v_mov_b32 v99, v59
    s_waitcnt vmcnt(0)
    v_cmp_eq_u32 vcc, -1, v6
    s_nop 1
    s_cbranch_vccnz K2_R2R3
K2_R2B3:
    s_waitcnt lgkmcnt(0)
    s_barrier
    ds_read_b128 v[8:11], v2 offset:1024
    ds_read_b128 v[12:15], v2 offset:6144
    ds_read_b128 v[16:19], v2 offset:11264
    ds_read_b128 v[20:23], v2 offset:57344
    ds_read_b128 v[24:27], v109 offset:9216
    ds_read_b128 v[28:31], v109 offset:26624
    ds_read_b128 v[32:35], v2 offset:20480
    ds_read_b64_tr_b16 v[104:105], v1 offset:0
    ds_read_b128 v[36:39], v2 offset:2048
    ds_read_b128 v[40:43], v2 offset:7168
    ds_read_b128 v[44:47], v2 offset:12288
    ds_read_b128 v[48:51], v2 offset:58368
    ds_read_b128 v[52:55], v109 offset:10240
    ds_read_b128 v[56:59], v109 offset:27648
    ds_read_b128 v[60:63], v2 offset:21504
    s_waitcnt lgkmcnt(14)
    ds_read_b64_tr_b16 v[106:107], v1 offset:512
    v_pk_add_f32 v[92:93], v[92:93], v[8:9]
    v_pk_add_f32 v[94:95], v[94:95], v[10:11]
    s_waitcnt lgkmcnt(14)
    v_pk_add_f32 v[92:93], v[92:93], v[12:13]
    v_pk_add_f32 v[94:95], v[94:95], v[14:15]
    s_waitcnt lgkmcnt(13)
    v_pk_add_f32 v[92:93], v[92:93], v[16:17]
    v_pk_add_f32 v[94:95], v[94:95], v[18:19]
    s_waitcnt lgkmcnt(12)
    v_pk_add_f32 v[92:93], v[92:93], v[20:21]
    v_pk_add_f32 v[94:95], v[94:95], v[22:23]
    s_waitcnt lgkmcnt(11)
    v_pk_add_f32 v[92:93], v[92:93], v[24:25]
    v_pk_add_f32 v[94:95], v[94:95], v[26:27]
    s_waitcnt lgkmcnt(10)
    v_pk_add_f32 v[92:93], v[92:93], v[28:29]
    v_pk_add_f32 v[94:95], v[94:95], v[30:31]
    s_waitcnt lgkmcnt(9)
    v_pk_add_f32 v[92:93], v[92:93], v[32:33]
    v_pk_add_f32 v[94:95], v[94:95], v[34:35]
    s_waitcnt lgkmcnt(8)
    v_lshlrev_b32 v8, 16, v104
    v_and_b32 v9, 0xffff0000, v104
    v_lshlrev_b32 v10, 16, v105
    v_and_b32 v11, 0xffff0000, v105
    v_fma_f32 v92, v92, v6, v8
    v_fma_f32 v93, v93, v6, v9
    v_fma_f32 v94, v94, v6, v10
    v_fma_f32 v95, v95, v6, v11
    v_cvt_pk_bf16_f32 v92, v92, v93
    v_cvt_pk_bf16_f32 v93, v94, v95
    buffer_store_dwordx2 v[92:93], v7, s[52:55], s43 offen offset:0
    s_waitcnt lgkmcnt(7)
    v_pk_add_f32 v[96:97], v[96:97], v[36:37]
    v_pk_add_f32 v[98:99], v[98:99], v[38:39]
    s_waitcnt lgkmcnt(6)
    v_pk_add_f32 v[96:97], v[96:97], v[40:41]
    v_pk_add_f32 v[98:99], v[98:99], v[42:43]
    s_waitcnt lgkmcnt(5)
    v_pk_add_f32 v[96:97], v[96:97], v[44:45]
    v_pk_add_f32 v[98:99], v[98:99], v[46:47]
    s_waitcnt lgkmcnt(4)
    v_pk_add_f32 v[96:97], v[96:97], v[48:49]
    v_pk_add_f32 v[98:99], v[98:99], v[50:51]
    s_waitcnt lgkmcnt(3)
    v_pk_add_f32 v[96:97], v[96:97], v[52:53]
    v_pk_add_f32 v[98:99], v[98:99], v[54:55]
    s_waitcnt lgkmcnt(2)
    v_pk_add_f32 v[96:97], v[96:97], v[56:57]
    v_pk_add_f32 v[98:99], v[98:99], v[58:59]
    s_waitcnt lgkmcnt(1)
    v_pk_add_f32 v[96:97], v[96:97], v[60:61]
    v_pk_add_f32 v[98:99], v[98:99], v[62:63]
    s_waitcnt lgkmcnt(0)
    v_lshlrev_b32 v36, 16, v106
    v_and_b32 v37, 0xffff0000, v106
    v_lshlrev_b32 v38, 16, v107
    v_and_b32 v39, 0xffff0000, v107
    v_fma_f32 v96, v96, v6, v36
    v_fma_f32 v97, v97, v6, v37
    v_fma_f32 v98, v98, v6, v38
    v_fma_f32 v99, v99, v6, v39
    v_cvt_pk_bf16_f32 v96, v96, v97
    v_cvt_pk_bf16_f32 v97, v98, v99
    buffer_store_dwordx2 v[96:97], v7, s[52:55], s43 offen offset:32
    s_endpgm
K2_R2R3:
    s_mov_b32 s35, 0
K2_R2L3:
    buffer_load_dword v6, v5, s[16:19], s42 offen sc1
    s_add_u32 s35, s35, 1
    s_cmp_gt_u32 s35, 4000
    s_waitcnt vmcnt(0)
    s_cbranch_scc1 K2_R2B3
    v_cmp_eq_u32 vcc, -1, v6
    s_nop 1
    s_cbranch_vccnz K2_R2L3
    s_branch K2_R2B3
K2_STATS:
    v_mov_b32 v48, 0x3f803f80
    v_mov_b32 v49, 0x3f803f80
    v_mov_b32 v50, 0x3f803f80
    v_mov_b32 v51, 0x3f803f80
    s_barrier
    ds_read_b64_tr_b16 a[32:33], v5 offset:0
    ds_read_b64_tr_b16 a[34:35], v5 offset:512
    ds_read_b64_tr_b16 a[36:37], v5 offset:1024
    ds_read_b64_tr_b16 a[38:39], v5 offset:1536
    ds_read_b64_tr_b16 a[40:41], v1 offset:0
    ds_read_b64_tr_b16 a[42:43], v1 offset:512
    ds_read_b64_tr_b16 a[44:45], v1 offset:1024
    ds_read_b64_tr_b16 a[46:47], v1 offset:1536
    s_waitcnt lgkmcnt(0)
    s_barrier
    ds_read_b64_tr_b16 a[48:49], v5 offset:22528
    ds_read_b64_tr_b16 a[50:51], v5 offset:23040
    ds_read_b64_tr_b16 a[52:53], v5 offset:23552
    ds_read_b64_tr_b16 a[54:55], v5 offset:24064
    ds_read_b64_tr_b16 a[56:57], v1 offset:22528
    ds_read_b64_tr_b16 a[58:59], v1 offset:23040
    ds_read_b64_tr_b16 a[60:61], v1 offset:23552
    ds_read_b64_tr_b16 a[62:63], v1 offset:24064
    v_mfma_f32_16x16x32_bf16 v[16:19], a[32:35], a[32:35], 0
    v_mfma_f32_16x16x32_bf16 v[32:35], v[48:51], a[32:35], 0
    v_mfma_f32_16x16x32_bf16 v[20:23], a[36:39], a[36:39], 0
    v_mfma_f32_16x16x32_bf16 v[36:39], v[48:51], a[36:39], 0
    v_mfma_f32_16x16x32_bf16 v[24:27], a[40:43], a[40:43], 0
    v_mfma_f32_16x16x32_bf16 v[40:43], v[48:51], a[40:43], 0
    v_mfma_f32_16x16x32_bf16 v[28:31], a[44:47], a[44:47], 0
    v_mfma_f32_16x16x32_bf16 v[44:47], v[48:51], a[44:47], 0
    s_waitcnt lgkmcnt(0)
    s_barrier
    ds_read_b64_tr_b16 a[32:33], v5 offset:45056
    ds_read_b64_tr_b16 a[34:35], v5 offset:45568
    ds_read_b64_tr_b16 a[36:37], v5 offset:46080
    ds_read_b64_tr_b16 a[38:39], v5 offset:46592
    ds_read_b64_tr_b16 a[40:41], v1 offset:45056
    ds_read_b64_tr_b16 a[42:43], v1 offset:45568
    ds_read_b64_tr_b16 a[44:45], v1 offset:46080
    ds_read_b64_tr_b16 a[46:47], v1 offset:46592
    v_mfma_f32_16x16x32_bf16 v[16:19], a[48:51], a[48:51], v[16:19]
    v_mfma_f32_16x16x32_bf16 v[32:35], v[48:51], a[48:51], v[32:35]
    v_mfma_f32_16x16x32_bf16 v[20:23], a[52:55], a[52:55], v[20:23]
    v_mfma_f32_16x16x32_bf16 v[36:39], v[48:51], a[52:55], v[36:39]
    v_mfma_f32_16x16x32_bf16 v[24:27], a[56:59], a[56:59], v[24:27]
    v_mfma_f32_16x16x32_bf16 v[40:43], v[48:51], a[56:59], v[40:43]
    v_mfma_f32_16x16x32_bf16 v[28:31], a[60:63], a[60:63], v[28:31]
    v_mfma_f32_16x16x32_bf16 v[44:47], v[48:51], a[60:63], v[44:47]
    s_waitcnt lgkmcnt(0)
    s_barrier
    ds_read_b64_tr_b16 a[48:49], v6 offset:0
    ds_read_b64_tr_b16 a[50:51], v6 offset:512
    ds_read_b64_tr_b16 a[52:53], v6 offset:1024
    ds_read_b64_tr_b16 a[54:55], v6 offset:1536
    ds_read_b64_tr_b16 a[56:57], v14 offset:0
    ds_read_b64_tr_b16 a[58:59], v14 offset:512
    ds_read_b64_tr_b16 a[60:61], v14 offset:1024
    ds_read_b64_tr_b16 a[62:63], v14 offset:1536
    v_mfma_f32_16x16x32_bf16 v[16:19], a[32:35], a[32:35], v[16:19]
    v_mfma_f32_16x16x32_bf16 v[32:35], v[48:51], a[32:35], v[32:35]
    v_mfma_f32_16x16x32_bf16 v[20:23], a[36:39], a[36:39], v[20:23]
    v_mfma_f32_16x16x32_bf16 v[36:39], v[48:51], a[36:39], v[36:39]
    v_mfma_f32_16x16x32_bf16 v[24:27], a[40:43], a[40:43], v[24:27]
    v_mfma_f32_16x16x32_bf16 v[40:43], v[48:51], a[40:43], v[40:43]
    v_mfma_f32_16x16x32_bf16 v[28:31], a[44:47], a[44:47], v[28:31]
    v_mfma_f32_16x16x32_bf16 v[44:47], v[48:51], a[44:47], v[44:47]
    buffer_load_dwordx4 a[64:67], v2, s[24:27], s36 offen offset:0 sc1
    s_waitcnt lgkmcnt(0)
    s_barrier
    ds_read_b64_tr_b16 a[32:33], v6 offset:22528
    ds_read_b64_tr_b16 a[34:35], v6 offset:23040
    ds_read_b64_tr_b16 a[36:37], v6 offset:23552
    ds_read_b64_tr_b16 a[38:39], v6 offset:24064
    ds_read_b64_tr_b16 a[40:41], v14 offset:22528
    ds_read_b64_tr_b16 a[42:43], v14 offset:23040
    ds_read_b64_tr_b16 a[44:45], v14 offset:23552
    ds_read_b64_tr_b16 a[46:47], v14 offset:24064
    v_mfma_f32_16x16x32_bf16 v[16:19], a[48:51], a[48:51], v[16:19]
    v_mfma_f32_16x16x32_bf16 v[32:35], v[48:51], a[48:51], v[32:35]
    v_mfma_f32_16x16x32_bf16 v[20:23], a[52:55], a[52:55], v[20:23]
    v_mfma_f32_16x16x32_bf16 v[36:39], v[48:51], a[52:55], v[36:39]
    v_mfma_f32_16x16x32_bf16 v[24:27], a[56:59], a[56:59], v[24:27]
    v_mfma_f32_16x16x32_bf16 v[40:43], v[48:51], a[56:59], v[40:43]
    v_mfma_f32_16x16x32_bf16 v[28:31], a[60:63], a[60:63], v[28:31]
    v_mfma_f32_16x16x32_bf16 v[44:47], v[48:51], a[60:63], v[44:47]
    buffer_load_dwordx4 a[68:71], v2, s[24:27], s36 offen offset:1024 sc1
    s_waitcnt lgkmcnt(0)
    s_barrier
    ds_read_b64_tr_b16 a[48:49], v5 offset:0
    ds_read_b64_tr_b16 a[50:51], v5 offset:512
    ds_read_b64_tr_b16 a[52:53], v5 offset:1024
    ds_read_b64_tr_b16 a[54:55], v5 offset:1536
    ds_read_b64_tr_b16 a[56:57], v1 offset:0
    ds_read_b64_tr_b16 a[58:59], v1 offset:512
    ds_read_b64_tr_b16 a[60:61], v1 offset:1024
    ds_read_b64_tr_b16 a[62:63], v1 offset:1536
    v_mfma_f32_16x16x32_bf16 v[16:19], a[32:35], a[32:35], v[16:19]
    v_mfma_f32_16x16x32_bf16 v[32:35], v[48:51], a[32:35], v[32:35]
    v_mfma_f32_16x16x32_bf16 v[20:23], a[36:39], a[36:39], v[20:23]
    v_mfma_f32_16x16x32_bf16 v[36:39], v[48:51], a[36:39], v[36:39]
    v_mfma_f32_16x16x32_bf16 v[24:27], a[40:43], a[40:43], v[24:27]
    v_mfma_f32_16x16x32_bf16 v[40:43], v[48:51], a[40:43], v[40:43]
    v_mfma_f32_16x16x32_bf16 v[28:31], a[44:47], a[44:47], v[28:31]
    v_mfma_f32_16x16x32_bf16 v[44:47], v[48:51], a[44:47], v[44:47]
    buffer_load_dwordx4 a[72:75], v2, s[24:27], s36 offen offset:2048 sc1
    s_waitcnt lgkmcnt(0)
    s_barrier
    ds_read_b64_tr_b16 a[32:33], v5 offset:22528
    ds_read_b64_tr_b16 a[34:35], v5 offset:23040
    ds_read_b64_tr_b16 a[36:37], v5 offset:23552
    ds_read_b64_tr_b16 a[38:39], v5 offset:24064
    ds_read_b64_tr_b16 a[40:41], v1 offset:22528
    ds_read_b64_tr_b16 a[42:43], v1 offset:23040
    ds_read_b64_tr_b16 a[44:45], v1 offset:23552
    ds_read_b64_tr_b16 a[46:47], v1 offset:24064
    v_mfma_f32_16x16x32_bf16 v[16:19], a[48:51], a[48:51], v[16:19]
    v_mfma_f32_16x16x32_bf16 v[32:35], v[48:51], a[48:51], v[32:35]
    v_mfma_f32_16x16x32_bf16 v[20:23], a[52:55], a[52:55], v[20:23]
    v_mfma_f32_16x16x32_bf16 v[36:39], v[48:51], a[52:55], v[36:39]
    v_mfma_f32_16x16x32_bf16 v[24:27], a[56:59], a[56:59], v[24:27]
    v_mfma_f32_16x16x32_bf16 v[40:43], v[48:51], a[56:59], v[40:43]
    v_mfma_f32_16x16x32_bf16 v[28:31], a[60:63], a[60:63], v[28:31]
    v_mfma_f32_16x16x32_bf16 v[44:47], v[48:51], a[60:63], v[44:47]
    buffer_load_dwordx4 a[76:79], v2, s[24:27], s36 offen offset:3072 sc1
    s_add_u32 s36, s36, 4096
    s_waitcnt lgkmcnt(0)
    s_barrier
    ds_read_b64_tr_b16 a[48:49], v5 offset:45056
    ds_read_b64_tr_b16 a[50:51], v5 offset:45568
    ds_read_b64_tr_b16 a[52:53], v5 offset:46080
    ds_read_b64_tr_b16 a[54:55], v5 offset:46592
    ds_read_b64_tr_b16 a[56:57], v1 offset:45056
    ds_read_b64_tr_b16 a[58:59], v1 offset:45568
    ds_read_b64_tr_b16 a[60:61], v1 offset:46080
    ds_read_b64_tr_b16 a[62:63], v1 offset:46592
    v_mfma_f32_16x16x32_bf16 v[16:19], a[32:35], a[32:35], v[16:19]
    v_mfma_f32_16x16x32_bf16 v[32:35], v[48:51], a[32:35], v[32:35]
    v_mfma_f32_16x16x32_bf16 v[20:23], a[36:39], a[36:39], v[20:23]
    v_mfma_f32_16x16x32_bf16 v[36:39], v[48:51], a[36:39], v[36:39]
    v_mfma_f32_16x16x32_bf16 v[24:27], a[40:43], a[40:43], v[24:27]
    v_mfma_f32_16x16x32_bf16 v[40:43], v[48:51], a[40:43], v[40:43]
    v_mfma_f32_16x16x32_bf16 v[28:31], a[44:47], a[44:47], v[28:31]
    v_mfma_f32_16x16x32_bf16 v[44:47], v[48:51], a[44:47], v[44:47]
    buffer_load_dwordx4 a[80:83], v2, s[24:27], s36 offen offset:0 sc1
    s_waitcnt lgkmcnt(0)
    s_barrier
    ds_read_b64_tr_b16 a[32:33], v6 offset:0
    ds_read_b64_tr_b16 a[34:35], v6 offset:512
    ds_read_b64_tr_b16 a[36:37], v6 offset:1024
    ds_read_b64_tr_b16 a[38:39], v6 offset:1536
    ds_read_b64_tr_b16 a[40:41], v14 offset:0
    ds_read_b64_tr_b16 a[42:43], v14 offset:512
    ds_read_b64_tr_b16 a[44:45], v14 offset:1024
    ds_read_b64_tr_b16 a[46:47], v14 offset:1536
    v_mfma_f32_16x16x32_bf16 v[16:19], a[48:51], a[48:51], v[16:19]
    v_mfma_f32_16x16x32_bf16 v[32:35], v[48:51], a[48:51], v[32:35]
    v_mfma_f32_16x16x32_bf16 v[20:23], a[52:55], a[52:55], v[20:23]
    v_mfma_f32_16x16x32_bf16 v[36:39], v[48:51], a[52:55], v[36:39]
    v_mfma_f32_16x16x32_bf16 v[24:27], a[56:59], a[56:59], v[24:27]
    v_mfma_f32_16x16x32_bf16 v[40:43], v[48:51], a[56:59], v[40:43]
    v_mfma_f32_16x16x32_bf16 v[28:31], a[60:63], a[60:63], v[28:31]
    v_mfma_f32_16x16x32_bf16 v[44:47], v[48:51], a[60:63], v[44:47]
    buffer_load_dwordx4 a[84:87], v2, s[24:27], s36 offen offset:1024 sc1
    s_waitcnt lgkmcnt(0)
    s_barrier
    ds_read_b64_tr_b16 a[48:49], v6 offset:22528
    ds_read_b64_tr_b16 a[50:51], v6 offset:23040
    ds_read_b64_tr_b16 a[52:53], v6 offset:23552
    ds_read_b64_tr_b16 a[54:55], v6 offset:24064
    ds_read_b64_tr_b16 a[56:57], v14 offset:22528
    ds_read_b64_tr_b16 a[58:59], v14 offset:23040
    ds_read_b64_tr_b16 a[60:61], v14 offset:23552
    ds_read_b64_tr_b16 a[62:63], v14 offset:24064
    v_mfma_f32_16x16x32_bf16 v[16:19], a[32:35], a[32:35], v[16:19]
    v_mfma_f32_16x16x32_bf16 v[32:35], v[48:51], a[32:35], v[32:35]
    v_mfma_f32_16x16x32_bf16 v[20:23], a[36:39], a[36:39], v[20:23]
    v_mfma_f32_16x16x32_bf16 v[36:39], v[48:51], a[36:39], v[36:39]
    v_mfma_f32_16x16x32_bf16 v[24:27], a[40:43], a[40:43], v[24:27]
    v_mfma_f32_16x16x32_bf16 v[40:43], v[48:51], a[40:43], v[40:43]
    v_mfma_f32_16x16x32_bf16 v[28:31], a[44:47], a[44:47], v[28:31]
    v_mfma_f32_16x16x32_bf16 v[44:47], v[48:51], a[44:47], v[44:47]
    buffer_load_dwordx4 a[88:91], v2, s[24:27], s36 offen offset:2048 sc1
    s_waitcnt lgkmcnt(0)
    s_barrier
    ds_read_b64_tr_b16 a[32:33], v5 offset:0
    ds_read_b64_tr_b16 a[34:35], v5 offset:512
    ds_read_b64_tr_b16 a[36:37], v5 offset:1024
    ds_read_b64_tr_b16 a[38:39], v5 offset:1536
    ds_read_b64_tr_b16 a[40:41], v1 offset:0
    ds_read_b64_tr_b16 a[42:43], v1 offset:512
    ds_read_b64_tr_b16 a[44:45], v1 offset:1024
    ds_read_b64_tr_b16 a[46:47], v1 offset:1536
    v_mfma_f32_16x16x32_bf16 v[16:19], a[48:51], a[48:51], v[16:19]
    v_mfma_f32_16x16x32_bf16 v[32:35], v[48:51], a[48:51], v[32:35]
    v_mfma_f32_16x16x32_bf16 v[20:23], a[52:55], a[52:55], v[20:23]
    v_mfma_f32_16x16x32_bf16 v[36:39], v[48:51], a[52:55], v[36:39]
    v_mfma_f32_16x16x32_bf16 v[24:27], a[56:59], a[56:59], v[24:27]
    v_mfma_f32_16x16x32_bf16 v[40:43], v[48:51], a[56:59], v[40:43]
    v_mfma_f32_16x16x32_bf16 v[28:31], a[60:63], a[60:63], v[28:31]
    v_mfma_f32_16x16x32_bf16 v[44:47], v[48:51], a[60:63], v[44:47]
    buffer_load_dwordx4 a[92:95], v2, s[24:27], s36 offen offset:3072 sc1
    s_add_u32 s36, s36, 4096
    s_waitcnt lgkmcnt(0)
    s_barrier
    ds_read_b64_tr_b16 a[48:49], v5 offset:22528
    ds_read_b64_tr_b16 a[50:51], v5 offset:23040
    ds_read_b64_tr_b16 a[52:53], v5 offset:23552
    ds_read_b64_tr_b16 a[54:55], v5 offset:24064
    ds_read_b64_tr_b16 a[56:57], v1 offset:22528
    ds_read_b64_tr_b16 a[58:59], v1 offset:23040
    ds_read_b64_tr_b16 a[60:61], v1 offset:23552
    ds_read_b64_tr_b16 a[62:63], v1 offset:24064
    v_mfma_f32_16x16x32_bf16 v[16:19], a[32:35], a[32:35], v[16:19]
    v_mfma_f32_16x16x32_bf16 v[32:35], v[48:51], a[32:35], v[32:35]
    v_mfma_f32_16x16x32_bf16 v[20:23], a[36:39], a[36:39], v[20:23]
    v_mfma_f32_16x16x32_bf16 v[36:39], v[48:51], a[36:39], v[36:39]
    v_mfma_f32_16x16x32_bf16 v[24:27], a[40:43], a[40:43], v[24:27]
    v_mfma_f32_16x16x32_bf16 v[40:43], v[48:51], a[40:43], v[40:43]
    v_mfma_f32_16x16x32_bf16 v[28:31], a[44:47], a[44:47], v[28:31]
    v_mfma_f32_16x16x32_bf16 v[44:47], v[48:51], a[44:47], v[44:47]
    buffer_load_dwordx4 a[96:99], v2, s[24:27], s36 offen offset:0 sc1
    s_waitcnt lgkmcnt(0)
    s_barrier
    ds_read_b64_tr_b16 a[32:33], v5 offset:45056
    ds_read_b64_tr_b16 a[34:35], v5 offset:45568
    ds_read_b64_tr_b16 a[36:37], v5 offset:46080
    ds_read_b64_tr_b16 a[38:39], v5 offset:46592
    ds_read_b64_tr_b16 a[40:41], v1 offset:45056
    ds_read_b64_tr_b16 a[42:43], v1 offset:45568
    ds_read_b64_tr_b16 a[44:45], v1 offset:46080
    ds_read_b64_tr_b16 a[46:47], v1 offset:46592
    v_mfma_f32_16x16x32_bf16 v[16:19], a[48:51], a[48:51], v[16:19]
    v_mfma_f32_16x16x32_bf16 v[32:35], v[48:51], a[48:51], v[32:35]
    v_mfma_f32_16x16x32_bf16 v[20:23], a[52:55], a[52:55], v[20:23]
    v_mfma_f32_16x16x32_bf16 v[36:39], v[48:51], a[52:55], v[36:39]
    v_mfma_f32_16x16x32_bf16 v[24:27], a[56:59], a[56:59], v[24:27]
    v_mfma_f32_16x16x32_bf16 v[40:43], v[48:51], a[56:59], v[40:43]
    v_mfma_f32_16x16x32_bf16 v[28:31], a[60:63], a[60:63], v[28:31]
    v_mfma_f32_16x16x32_bf16 v[44:47], v[48:51], a[60:63], v[44:47]
    buffer_load_dwordx4 a[100:103], v2, s[24:27], s36 offen offset:1024 sc1
    s_waitcnt lgkmcnt(0)
    s_barrier
    ds_read_b64_tr_b16 a[48:49], v6 offset:0
    ds_read_b64_tr_b16 a[50:51], v6 offset:512
    ds_read_b64_tr_b16 a[52:53], v6 offset:1024
    ds_read_b64_tr_b16 a[54:55], v6 offset:1536
    ds_read_b64_tr_b16 a[56:57], v14 offset:0
    ds_read_b64_tr_b16 a[58:59], v14 offset:512
    ds_read_b64_tr_b16 a[60:61], v14 offset:1024
    ds_read_b64_tr_b16 a[62:63], v14 offset:1536
    v_mfma_f32_16x16x32_bf16 v[16:19], a[32:35], a[32:35], v[16:19]
    v_mfma_f32_16x16x32_bf16 v[32:35], v[48:51], a[32:35], v[32:35]
    v_mfma_f32_16x16x32_bf16 v[20:23], a[36:39], a[36:39], v[20:23]
    v_mfma_f32_16x16x32_bf16 v[36:39], v[48:51], a[36:39], v[36:39]
    v_mfma_f32_16x16x32_bf16 v[24:27], a[40:43], a[40:43], v[24:27]
    v_mfma_f32_16x16x32_bf16 v[40:43], v[48:51], a[40:43], v[40:43]
    v_mfma_f32_16x16x32_bf16 v[28:31], a[44:47], a[44:47], v[28:31]
    v_mfma_f32_16x16x32_bf16 v[44:47], v[48:51], a[44:47], v[44:47]
    buffer_load_dwordx4 a[104:107], v2, s[24:27], s36 offen offset:2048 sc1
    s_waitcnt lgkmcnt(0)
    s_barrier
    ds_read_b64_tr_b16 a[32:33], v6 offset:22528
    ds_read_b64_tr_b16 a[34:35], v6 offset:23040
    ds_read_b64_tr_b16 a[36:37], v6 offset:23552
    ds_read_b64_tr_b16 a[38:39], v6 offset:24064
    ds_read_b64_tr_b16 a[40:41], v14 offset:22528
    ds_read_b64_tr_b16 a[42:43], v14 offset:23040
    ds_read_b64_tr_b16 a[44:45], v14 offset:23552
    ds_read_b64_tr_b16 a[46:47], v14 offset:24064
    v_mfma_f32_16x16x32_bf16 v[16:19], a[48:51], a[48:51], v[16:19]
    v_mfma_f32_16x16x32_bf16 v[32:35], v[48:51], a[48:51], v[32:35]
    v_mfma_f32_16x16x32_bf16 v[20:23], a[52:55], a[52:55], v[20:23]
    v_mfma_f32_16x16x32_bf16 v[36:39], v[48:51], a[52:55], v[36:39]
    v_mfma_f32_16x16x32_bf16 v[24:27], a[56:59], a[56:59], v[24:27]
    v_mfma_f32_16x16x32_bf16 v[40:43], v[48:51], a[56:59], v[40:43]
    v_mfma_f32_16x16x32_bf16 v[28:31], a[60:63], a[60:63], v[28:31]
    v_mfma_f32_16x16x32_bf16 v[44:47], v[48:51], a[60:63], v[44:47]
    buffer_load_dwordx4 a[108:111], v2, s[24:27], s36 offen offset:3072 sc1
    s_add_u32 s36, s36, 4096
    s_waitcnt lgkmcnt(0)
    s_barrier
    ds_read_b64_tr_b16 a[48:49], v5 offset:0
    ds_read_b64_tr_b16 a[50:51], v5 offset:512
    ds_read_b64_tr_b16 a[52:53], v5 offset:1024
    ds_read_b64_tr_b16 a[54:55], v5 offset:1536
    ds_read_b64_tr_b16 a[56:57], v1 offset:0
    ds_read_b64_tr_b16 a[58:59], v1 offset:512
    ds_read_b64_tr_b16 a[60:61], v1 offset:1024
    ds_read_b64_tr_b16 a[62:63], v1 offset:1536
    v_mfma_f32_16x16x32_bf16 v[16:19], a[32:35], a[32:35], v[16:19]
    v_mfma_f32_16x16x32_bf16 v[32:35], v[48:51], a[32:35], v[32:35]
    v_mfma_f32_16x16x32_bf16 v[20:23], a[36:39], a[36:39], v[20:23]
    v_mfma_f32_16x16x32_bf16 v[36:39], v[48:51], a[36:39], v[36:39]
    v_mfma_f32_16x16x32_bf16 v[24:27], a[40:43], a[40:43], v[24:27]
    v_mfma_f32_16x16x32_bf16 v[40:43], v[48:51], a[40:43], v[40:43]
    v_mfma_f32_16x16x32_bf16 v[28:31], a[44:47], a[44:47], v[28:31]
    v_mfma_f32_16x16x32_bf16 v[44:47], v[48:51], a[44:47], v[44:47]
    buffer_load_dwordx4 a[112:115], v2, s[24:27], s36 offen offset:0 sc1
    s_waitcnt lgkmcnt(0)
    s_barrier
    ds_read_b64_tr_b16 a[32:33], v5 offset:22528
    ds_read_b64_tr_b16 a[34:35], v5 offset:23040
    ds_read_b64_tr_b16 a[36:37], v5 offset:23552
    ds_read_b64_tr_b16 a[38:39], v5 offset:24064
    ds_read_b64_tr_b16 a[40:41], v1 offset:22528
    ds_read_b64_tr_b16 a[42:43], v1 offset:23040
    ds_read_b64_tr_b16 a[44:45], v1 offset:23552
    ds_read_b64_tr_b16 a[46:47], v1 offset:24064
    v_mfma_f32_16x16x32_bf16 v[16:19], a[48:51], a[48:51], v[16:19]
    v_mfma_f32_16x16x32_bf16 v[32:35], v[48:51], a[48:51], v[32:35]
    v_mfma_f32_16x16x32_bf16 v[20:23], a[52:55], a[52:55], v[20:23]
    v_mfma_f32_16x16x32_bf16 v[36:39], v[48:51], a[52:55], v[36:39]
    v_mfma_f32_16x16x32_bf16 v[24:27], a[56:59], a[56:59], v[24:27]
    v_mfma_f32_16x16x32_bf16 v[40:43], v[48:51], a[56:59], v[40:43]
    v_mfma_f32_16x16x32_bf16 v[28:31], a[60:63], a[60:63], v[28:31]
    v_mfma_f32_16x16x32_bf16 v[44:47], v[48:51], a[60:63], v[44:47]
    buffer_load_dwordx4 a[116:119], v2, s[24:27], s36 offen offset:1024 sc1
    s_waitcnt lgkmcnt(0)
    s_barrier
    ds_read_b64_tr_b16 a[48:49], v5 offset:45056
    ds_read_b64_tr_b16 a[50:51], v5 offset:45568
    ds_read_b64_tr_b16 a[52:53], v5 offset:46080
    ds_read_b64_tr_b16 a[54:55], v5 offset:46592
    ds_read_b64_tr_b16 a[56:57], v1 offset:45056
    ds_read_b64_tr_b16 a[58:59], v1 offset:45568
    ds_read_b64_tr_b16 a[60:61], v1 offset:46080
    ds_read_b64_tr_b16 a[62:63], v1 offset:46592
    v_mfma_f32_16x16x32_bf16 v[16:19], a[32:35], a[32:35], v[16:19]
    v_mfma_f32_16x16x32_bf16 v[32:35], v[48:51], a[32:35], v[32:35]
    v_mfma_f32_16x16x32_bf16 v[20:23], a[36:39], a[36:39], v[20:23]
    v_mfma_f32_16x16x32_bf16 v[36:39], v[48:51], a[36:39], v[36:39]
    v_mfma_f32_16x16x32_bf16 v[24:27], a[40:43], a[40:43], v[24:27]
    v_mfma_f32_16x16x32_bf16 v[40:43], v[48:51], a[40:43], v[40:43]
    v_mfma_f32_16x16x32_bf16 v[28:31], a[44:47], a[44:47], v[28:31]
    v_mfma_f32_16x16x32_bf16 v[44:47], v[48:51], a[44:47], v[44:47]
    buffer_load_dwordx4 a[120:123], v2, s[24:27], s36 offen offset:2048 sc1
    s_waitcnt lgkmcnt(0)
    s_barrier
    ds_read_b64_tr_b16 a[32:33], v6 offset:0
    ds_read_b64_tr_b16 a[34:35], v6 offset:512
    ds_read_b64_tr_b16 a[36:37], v6 offset:1024
    ds_read_b64_tr_b16 a[38:39], v6 offset:1536
    ds_read_b64_tr_b16 a[40:41], v14 offset:0
    ds_read_b64_tr_b16 a[42:43], v14 offset:512
    ds_read_b64_tr_b16 a[44:45], v14 offset:1024
    ds_read_b64_tr_b16 a[46:47], v14 offset:1536
    v_mfma_f32_16x16x32_bf16 v[16:19], a[48:51], a[48:51], v[16:19]
    v_mfma_f32_16x16x32_bf16 v[32:35], v[48:51], a[48:51], v[32:35]
    v_mfma_f32_16x16x32_bf16 v[20:23], a[52:55], a[52:55], v[20:23]
    v_mfma_f32_16x16x32_bf16 v[36:39], v[48:51], a[52:55], v[36:39]
    v_mfma_f32_16x16x32_bf16 v[24:27], a[56:59], a[56:59], v[24:27]
    v_mfma_f32_16x16x32_bf16 v[40:43], v[48:51], a[56:59], v[40:43]
    v_mfma_f32_16x16x32_bf16 v[28:31], a[60:63], a[60:63], v[28:31]
    v_mfma_f32_16x16x32_bf16 v[44:47], v[48:51], a[60:63], v[44:47]
    buffer_load_dwordx4 a[124:127], v2, s[24:27], s36 offen offset:3072 sc1
    s_add_u32 s36, s36, 4096
    s_waitcnt lgkmcnt(0)
    s_barrier
    ds_read_b64_tr_b16 a[48:49], v6 offset:22528
    ds_read_b64_tr_b16 a[50:51], v6 offset:23040
    ds_read_b64_tr_b16 a[52:53], v6 offset:23552
    ds_read_b64_tr_b16 a[54:55], v6 offset:24064
    ds_read_b64_tr_b16 a[56:57], v14 offset:22528
    ds_read_b64_tr_b16 a[58:59], v14 offset:23040
    ds_read_b64_tr_b16 a[60:61], v14 offset:23552
    ds_read_b64_tr_b16 a[62:63], v14 offset:24064
    v_mfma_f32_16x16x32_bf16 v[16:19], a[32:35], a[32:35], v[16:19]
    v_mfma_f32_16x16x32_bf16 v[32:35], v[48:51], a[32:35], v[32:35]
    v_mfma_f32_16x16x32_bf16 v[20:23], a[36:39], a[36:39], v[20:23]
    v_mfma_f32_16x16x32_bf16 v[36:39], v[48:51], a[36:39], v[36:39]
    v_mfma_f32_16x16x32_bf16 v[24:27], a[40:43], a[40:43], v[24:27]
    v_mfma_f32_16x16x32_bf16 v[40:43], v[48:51], a[40:43], v[40:43]
    v_mfma_f32_16x16x32_bf16 v[28:31], a[44:47], a[44:47], v[28:31]
    v_mfma_f32_16x16x32_bf16 v[44:47], v[48:51], a[44:47], v[44:47]
    s_waitcnt lgkmcnt(0)
    v_mfma_f32_16x16x32_bf16 v[16:19], a[48:51], a[48:51], v[16:19]
    v_mfma_f32_16x16x32_bf16 v[32:35], v[48:51], a[48:51], v[32:35]
    v_mfma_f32_16x16x32_bf16 v[20:23], a[52:55], a[52:55], v[20:23]
    v_mfma_f32_16x16x32_bf16 v[36:39], v[48:51], a[52:55], v[36:39]
    v_mfma_f32_16x16x32_bf16 v[24:27], a[56:59], a[56:59], v[24:27]
    v_mfma_f32_16x16x32_bf16 v[40:43], v[48:51], a[56:59], v[40:43]
    v_mfma_f32_16x16x32_bf16 v[28:31], a[60:63], a[60:63], v[28:31]
    v_mfma_f32_16x16x32_bf16 v[44:47], v[48:51], a[60:63], v[44:47]
    v_and_b32 v9, 3, v3
    v_cmp_eq_u32 s[34:35], 1, v9
    v_cmp_eq_u32 s[38:39], 2, v9
    v_cmp_eq_u32 s[42:43], 3, v9
    v_and_b32 v9, 15, v3
    v_lshlrev_b32 v9, 2, v9
    s_lshl_b32 s32, s32, 8
    v_cndmask_b32 v16, v16, v17, s[34:35]
    v_cndmask_b32 v16, v16, v18, s[38:39]
    v_cndmask_b32 v16, v16, v19, s[42:43]
    v_cndmask_b32 v20, v20, v21, s[34:35]
    v_cndmask_b32 v20, v20, v22, s[38:39]
    v_cndmask_b32 v20, v20, v23, s[42:43]
    v_cndmask_b32 v24, v24, v25, s[34:35]
    v_cndmask_b32 v24, v24, v26, s[38:39]
    v_cndmask_b32 v24, v24, v27, s[42:43]
    v_cndmask_b32 v28, v28, v29, s[34:35]
    v_cndmask_b32 v28, v28, v30, s[38:39]
    v_cndmask_b32 v28, v28, v31, s[42:43]
    v_mul_f32 v19, 0x3acccccd, v32
    v_mul_f32 v16, 0x3acccccd, v16
    v_fma_f32 v16, -v19, v19, v16
    v_max_f32 v16, 0, v16
    v_cvt_pk_bf16_f32 v17, v19, v19
    v_and_b32 v17, 0xffff0000, v17
    v_cvt_pk_bf16_f32 v16, v16, v16
    v_and_b32 v16, 0xffff0000, v16
    v_add_f32 v16, 0x3727c5ac, v16
    v_cvt_pk_bf16_f32 v16, v16, v16
    v_and_b32 v16, 0xffff0000, v16
    v_sqrt_f32 v16, v16
    s_nop 0
    v_cvt_pk_bf16_f32 v16, v16, v16
    v_and_b32 v16, 0xffff0000, v16
    v_rcp_f32 v18, v16
    s_nop 0
    v_mul_f32 v18, v18, v18
    v_mul_f32 v23, 0x3acccccd, v36
    v_mul_f32 v20, 0x3acccccd, v20
    v_fma_f32 v20, -v23, v23, v20
    v_max_f32 v20, 0, v20
    v_cvt_pk_bf16_f32 v21, v23, v23
    v_and_b32 v21, 0xffff0000, v21
    v_cvt_pk_bf16_f32 v20, v20, v20
    v_and_b32 v20, 0xffff0000, v20
    v_add_f32 v20, 0x3727c5ac, v20
    v_cvt_pk_bf16_f32 v20, v20, v20
    v_and_b32 v20, 0xffff0000, v20
    v_sqrt_f32 v20, v20
    s_nop 0
    v_cvt_pk_bf16_f32 v20, v20, v20
    v_and_b32 v20, 0xffff0000, v20
    v_rcp_f32 v22, v20
    s_nop 0
    v_mul_f32 v22, v22, v22
    v_mul_f32 v27, 0x3acccccd, v40
    v_mul_f32 v24, 0x3acccccd, v24
    v_fma_f32 v24, -v27, v27, v24
    v_max_f32 v24, 0, v24
    v_cvt_pk_bf16_f32 v25, v27, v27
    v_and_b32 v25, 0xffff0000, v25
    v_cvt_pk_bf16_f32 v24, v24, v24
    v_and_b32 v24, 0xffff0000, v24
    v_add_f32 v24, 0x3727c5ac, v24
    v_cvt_pk_bf16_f32 v24, v24, v24
    v_and_b32 v24, 0xffff0000, v24
    v_sqrt_f32 v24, v24
    s_nop 0
    v_cvt_pk_bf16_f32 v24, v24, v24
    v_and_b32 v24, 0xffff0000, v24
    v_rcp_f32 v26, v24
    s_nop 0
    v_mul_f32 v26, v26, v26
    v_mul_f32 v31, 0x3acccccd, v44
    v_mul_f32 v28, 0x3acccccd, v28
    v_fma_f32 v28, -v31, v31, v28
    v_max_f32 v28, 0, v28
    v_cvt_pk_bf16_f32 v29, v31, v31
    v_and_b32 v29, 0xffff0000, v29
    v_cvt_pk_bf16_f32 v28, v28, v28
    v_and_b32 v28, 0xffff0000, v28
    v_add_f32 v28, 0x3727c5ac, v28
    v_cvt_pk_bf16_f32 v28, v28, v28
    v_and_b32 v28, 0xffff0000, v28
    v_sqrt_f32 v28, v28
    s_nop 0
    v_cvt_pk_bf16_f32 v28, v28, v28
    v_and_b32 v28, 0xffff0000, v28
    v_rcp_f32 v30, v28
    s_nop 0
    v_mul_f32 v30, v30, v30
    s_mov_b32 s34, 0x00f0000f
    s_mov_b32 s35, 0xf0000f00
    s_mov_b64 exec, s[34:35]
    buffer_store_dword v18, v9, s[16:19], s32 offen offset:128 sc1
    buffer_store_dword v22, v9, s[16:19], s32 offen offset:192 sc1
    buffer_store_dword v26, v9, s[16:19], s32 offen offset:0 sc1
    buffer_store_dword v30, v9, s[16:19], s32 offen offset:64 sc1
    s_mov_b64 exec, -1
    s_branch K2_P2
K_EXIT:
    s_endpgm
TEXT_END:
.section .rodata,"a"
.p2align 6
.amdhsa_kernel k1_all_kernel
  .amdhsa_next_free_vgpr 256
  .amdhsa_next_free_sgpr 95
  .amdhsa_accum_offset 128
  .amdhsa_group_segment_fixed_size 0
  .amdhsa_kernarg_size 104
  .amdhsa_user_sgpr_count 2
  .amdhsa_user_sgpr_kernarg_segment_ptr 1
  .amdhsa_system_sgpr_workgroup_id_x 1
  .amdhsa_float_denorm_mode_32 3
.end_amdhsa_kernel
```
